```python
import torch

def _softmax(x, axis=-1):
    return torch.softmax(x, dim=axis)
def _gelu(x):
    return torch.nn.functional.gelu(x, approximate="tanh")
def _silu(x):
    return torch.nn.functional.silu(x)
def _sigmoid(x):
    return torch.sigmoid(x)
def _layernorm(x, axis=-1, eps=1e-5):
    m = x.mean(dim=axis, keepdim=True)
    v = x.var(dim=axis, keepdim=True, unbiased=False)
    return (x - m) / torch.sqrt(v + eps)
def _scatter_add(tgt, idx, src, axis=0):
    return tgt.clone().index_add_(axis, idx, src)
def _segment_sum(src, seg, n):
    out = torch.zeros((n,) + src.shape[1:], dtype=src.dtype)
    return out.index_add_(0, seg, src)
def _pad(x, pw):
    flat = tuple(v for pair in reversed(pw) for v in pair)
    return torch.nn.functional.pad(x, flat)

kernel_name = 'sequential_preLN__softmax_full_mha__glu_gated_geglu__prompt'

def setup_inputs():

    _w = (lambda a: (lambda t: t.to(torch.bfloat16) if t.is_floating_point() else t)(torch.as_tensor(a)))
    def _A_setup():
        B, S, D = 1, 2048, 640
        return {
            "x": _w((lambda *s: torch.randn(*s, dtype=torch.bfloat16) * 0.05)(B, S, D)),
            "wqkv": _w((lambda *s: torch.randn(*s, dtype=torch.bfloat16) * 0.05)(D, 3 * D)),
            "wo": _w((lambda *s: torch.randn(*s, dtype=torch.bfloat16) * 0.05)(D, D)),
        }
    _A_in = _A_setup()

    def _B_setup():
        B, S, Dm, Df = 1, 2048, 640, 1536
        return {
            "x": _w((lambda *s: torch.randn(*s, dtype=torch.bfloat16) * 0.05)(B, S, Dm)),
            "w_gate": _w((lambda *s: torch.randn(*s, dtype=torch.bfloat16) * 0.8)(Dm, Df) * (Dm ** -0.5)),
            "w_up": _w((lambda *s: torch.randn(*s, dtype=torch.bfloat16) * 0.8)(Dm, Df) * (Dm ** -0.5)),
            "w_down": _w((lambda *s: torch.randn(*s, dtype=torch.bfloat16) * 0.8)(Df, Dm) * (Df ** -0.5)),
        }
    _B_in = _B_setup()

    return {
        "A_x": _A_in["x"],
        "A_wqkv": _A_in["wqkv"],
        "A_wo": _A_in["wo"],
        "B_x": _B_in["x"],
        "B_w_gate": _B_in["w_gate"],
        "B_w_up": _B_in["w_up"],
        "B_w_down": _B_in["w_down"],
    }

def reference(A_x, A_wqkv, A_wo, B_x, B_w_gate, B_w_up, B_w_down):
    def _A_ref(x, wqkv, wo):
        B, S, D = x.shape
        H = 32; Dh = D // H
        qkv = (lambda x, *d: x.permute(*d))((x @ wqkv).reshape(B, S, 3, H, Dh), 2, 0, 3, 1, 4)
        q, k, v = qkv[0], qkv[1], qkv[2]
        scale = Dh ** -0.5
        scores = torch.einsum("bhqd,bhkd->bhqk", q, k) * scale
        p = _softmax(scores, axis=-1)
        o = torch.einsum("bhqk,bhkd->bhqd", p, v)
        return (lambda x, *d: x.permute(*d))(o, 0, 2, 1, 3).reshape(B, S, D) @ wo

    def _B_ref(x, w_gate, w_up, w_down):
        g = torch.einsum("bsd,df->bsf", x, w_gate)
        u = torch.einsum("bsd,df->bsf", x, w_up)
        h = _gelu(g) * u
        return torch.einsum("bsf,fd->bsd", h, w_down)

    x = A_x
    h = x + _A_ref(_layernorm(x, axis=-1), A_wqkv, A_wo)
    h2 = h + _B_ref(_layernorm(h, axis=-1), B_w_gate, B_w_up, B_w_down)
    return h2
```

```asm
; @launch grid=(256,1,1) block=(512,1,1) lds=163840
.amdgcn_target "amdgcn-amd-amdhsa--gfx950"
.text
.globl sequential_preLN__softmax_full_mha__glu_gated_geglu__prompt_kernel
.p2align 8
.type sequential_preLN__softmax_full_mha__glu_gated_geglu__prompt_kernel,@function
sequential_preLN__softmax_full_mha__glu_gated_geglu__prompt_kernel:
    s_cmp_ge_u32 s2, 256
    s_cbranch_scc1 L_end
    s_load_dwordx2 s[4:5], s[0:1], 0
    s_load_dwordx2 s[8:9], s[0:1], 8
    s_load_dwordx2 s[32:33], s[0:1], 72
    s_load_dwordx2 s[12:13], s[0:1], 16
    s_load_dwordx2 s[16:17], s[0:1], 32
    s_load_dwordx2 s[20:21], s[0:1], 40
    s_load_dwordx2 s[24:25], s[0:1], 48
    s_load_dwordx2 s[28:29], s[0:1], 56
    v_lshrrev_b32 v2, 6, v0
    v_and_b32 v1, 63, v0
    v_readfirstlane_b32 s3, v2
    s_mov_b32 s6, 0x280000
    s_mov_b32 s7, 0x20000
    s_mov_b32 s10, 0x258000
    s_mov_b32 s11, 0x20000
    s_mov_b32 s14, 0xc8000
    s_mov_b32 s15, 0x20000
    s_mov_b32 s18, 0x1e0000
    s_mov_b32 s19, 0x20000
    s_mov_b32 s22, 0x1e0000
    s_mov_b32 s23, 0x20000
    s_mov_b32 s26, 0x1e0000
    s_mov_b32 s27, 0x20000
    s_mov_b32 s30, 0x280000
    s_mov_b32 s31, 0x20000
    s_mov_b32 s34, 0x3200000
    s_mov_b32 s35, 0x20000
    s_and_b32 s54, s2, 7
    s_lshr_b32 s55, s2, 3
    s_lshr_b32 s38, s54, 1
    s_lshl_b32 s38, s38, 2
    s_and_b32 s56, s55, 3
    s_add_u32 s38, s38, s56
    s_and_b32 s39, s54, 1
    s_lshl_b32 s39, s39, 3
    s_lshr_b32 s57, s55, 2
    s_add_u32 s39, s39, s57
    s_and_b32 s44, s3, 3
    s_cmp_lt_u32 s3, 4
    s_cbranch_scc1 P1_comp
    v_lshrrev_b32 v2, 3, v1
    v_mul_u32_u24 v2, 1280, v2
    v_and_b32 v3, 7, v1
    v_lshrrev_b32 v4, 4, v1
    v_xor_b32 v3, v3, v4
    v_lshl_add_u32 v10, v3, 4, v2
    v_xor_b32 v3, 4, v3
    v_lshl_add_u32 v11, v3, 4, v2
    v_lshrrev_b32 v2, 2, v1
    v_mul_u32_u24 v2, 3840, v2
    v_and_b32 v3, 3, v1
    v_lshl_add_u32 v12, v3, 4, v2
    s_lshl_b32 s54, s38, 7
    s_lshl_b32 s55, s44, 5
    s_add_u32 s54, s54, s55
    s_mul_i32 s62, s54, 1280
    s_mul_i32 s63, s44, 61440
    s_lshl_b32 s54, s39, 8
    s_add_u32 s63, s63, s54
    s_lshl_b32 s61, s44, 12
    s_waitcnt lgkmcnt(0)
    s_load_dword s36, s[32:33], 0
    s_cmp_eq_u32 s39, 15
    s_cbranch_scc1 P1_lidle
    s_add_u32 m0, s61, 16384
    s_add_u32 s56, s63, 0
    buffer_load_dwordx4 v12, s[8:11], s56 offen lds
    s_add_u32 m0, s61, 17408
    s_add_u32 s56, s63, 64
    buffer_load_dwordx4 v12, s[8:11], s56 offen lds
    s_add_u32 m0, s61, 18432
    s_add_u32 s56, s63, 128
    buffer_load_dwordx4 v12, s[8:11], s56 offen lds
    s_add_u32 m0, s61, 19456
    s_add_u32 s56, s63, 192
    buffer_load_dwordx4 v12, s[8:11], s56 offen lds
    s_add_u32 m0, s61, 0
    s_add_u32 s56, s62, 0
    buffer_load_dwordx4 v10, s[4:7], s56 offen lds
    s_add_u32 m0, s61, 1024
    s_add_u32 s56, s62, 10240
    buffer_load_dwordx4 v11, s[4:7], s56 offen lds
    s_add_u32 m0, s61, 2048
    s_add_u32 s56, s62, 20480
    buffer_load_dwordx4 v10, s[4:7], s56 offen lds
    s_add_u32 m0, s61, 3072
    s_add_u32 s56, s62, 30720
    buffer_load_dwordx4 v11, s[4:7], s56 offen lds
    s_add_u32 m0, s61, 49152
    s_add_u32 s56, s63, 245760
    buffer_load_dwordx4 v12, s[8:11], s56 offen lds
    s_add_u32 m0, s61, 50176
    s_add_u32 s56, s63, 245824
    buffer_load_dwordx4 v12, s[8:11], s56 offen lds
    s_add_u32 m0, s61, 51200
    s_add_u32 s56, s63, 245888
    buffer_load_dwordx4 v12, s[8:11], s56 offen lds
    s_add_u32 m0, s61, 52224
    s_add_u32 s56, s63, 245952
    buffer_load_dwordx4 v12, s[8:11], s56 offen lds
    s_add_u32 m0, s61, 32768
    s_add_u32 s56, s62, 128
    buffer_load_dwordx4 v10, s[4:7], s56 offen lds
    s_add_u32 m0, s61, 33792
    s_add_u32 s56, s62, 10368
    buffer_load_dwordx4 v11, s[4:7], s56 offen lds
    s_add_u32 m0, s61, 34816
    s_add_u32 s56, s62, 20608
    buffer_load_dwordx4 v10, s[4:7], s56 offen lds
    s_add_u32 m0, s61, 35840
    s_add_u32 s56, s62, 30848
    buffer_load_dwordx4 v11, s[4:7], s56 offen lds
    s_add_u32 m0, s61, 81920
    s_add_u32 s56, s63, 491520
    buffer_load_dwordx4 v12, s[8:11], s56 offen lds
    s_add_u32 m0, s61, 82944
    s_add_u32 s56, s63, 491584
    buffer_load_dwordx4 v12, s[8:11], s56 offen lds
    s_add_u32 m0, s61, 83968
    s_add_u32 s56, s63, 491648
    buffer_load_dwordx4 v12, s[8:11], s56 offen lds
    s_add_u32 m0, s61, 84992
    s_add_u32 s56, s63, 491712
    buffer_load_dwordx4 v12, s[8:11], s56 offen lds
    s_add_u32 m0, s61, 65536
    s_add_u32 s56, s62, 256
    buffer_load_dwordx4 v10, s[4:7], s56 offen lds
    s_add_u32 m0, s61, 66560
    s_add_u32 s56, s62, 10496
    buffer_load_dwordx4 v11, s[4:7], s56 offen lds
    s_add_u32 m0, s61, 67584
    s_add_u32 s56, s62, 20736
    buffer_load_dwordx4 v10, s[4:7], s56 offen lds
    s_add_u32 m0, s61, 68608
    s_add_u32 s56, s62, 30976
    buffer_load_dwordx4 v11, s[4:7], s56 offen lds
    s_waitcnt vmcnt(16)
    s_barrier
    s_add_u32 m0, s61, 114688
    s_add_u32 s56, s63, 737280
    buffer_load_dwordx4 v12, s[8:11], s56 offen lds
    s_add_u32 m0, s61, 115712
    s_add_u32 s56, s63, 737344
    buffer_load_dwordx4 v12, s[8:11], s56 offen lds
    s_add_u32 m0, s61, 116736
    s_add_u32 s56, s63, 737408
    buffer_load_dwordx4 v12, s[8:11], s56 offen lds
    s_add_u32 m0, s61, 117760
    s_add_u32 s56, s63, 737472
    buffer_load_dwordx4 v12, s[8:11], s56 offen lds
    s_add_u32 m0, s61, 98304
    s_add_u32 s56, s62, 384
    buffer_load_dwordx4 v10, s[4:7], s56 offen lds
    s_add_u32 m0, s61, 99328
    s_add_u32 s56, s62, 10624
    buffer_load_dwordx4 v11, s[4:7], s56 offen lds
    s_add_u32 m0, s61, 100352
    s_add_u32 s56, s62, 20864
    buffer_load_dwordx4 v10, s[4:7], s56 offen lds
    s_add_u32 m0, s61, 101376
    s_add_u32 s56, s62, 31104
    buffer_load_dwordx4 v11, s[4:7], s56 offen lds
    s_waitcnt vmcnt(16)
    s_barrier
    s_add_u32 m0, s61, 147456
    s_add_u32 s56, s63, 983040
    buffer_load_dwordx4 v12, s[8:11], s56 offen lds
    s_add_u32 m0, s61, 148480
    s_add_u32 s56, s63, 983104
    buffer_load_dwordx4 v12, s[8:11], s56 offen lds
    s_add_u32 m0, s61, 149504
    s_add_u32 s56, s63, 983168
    buffer_load_dwordx4 v12, s[8:11], s56 offen lds
    s_add_u32 m0, s61, 150528
    s_add_u32 s56, s63, 983232
    buffer_load_dwordx4 v12, s[8:11], s56 offen lds
    s_add_u32 m0, s61, 131072
    s_add_u32 s56, s62, 512
    buffer_load_dwordx4 v10, s[4:7], s56 offen lds
    s_add_u32 m0, s61, 132096
    s_add_u32 s56, s62, 10752
    buffer_load_dwordx4 v11, s[4:7], s56 offen lds
    s_add_u32 m0, s61, 133120
    s_add_u32 s56, s62, 20992
    buffer_load_dwordx4 v10, s[4:7], s56 offen lds
    s_add_u32 m0, s61, 134144
    s_add_u32 s56, s62, 31232
    buffer_load_dwordx4 v11, s[4:7], s56 offen lds
    s_waitcnt vmcnt(16)
    s_barrier
    s_add_u32 m0, s61, 16384
    s_add_u32 s56, s63, 1228800
    buffer_load_dwordx4 v12, s[8:11], s56 offen lds
    s_add_u32 m0, s61, 17408
    s_add_u32 s56, s63, 1228864
    buffer_load_dwordx4 v12, s[8:11], s56 offen lds
    s_add_u32 m0, s61, 18432
    s_add_u32 s56, s63, 1228928
    buffer_load_dwordx4 v12, s[8:11], s56 offen lds
    s_add_u32 m0, s61, 19456
    s_add_u32 s56, s63, 1228992
    buffer_load_dwordx4 v12, s[8:11], s56 offen lds
    s_add_u32 m0, s61, 0
    s_add_u32 s56, s62, 640
    buffer_load_dwordx4 v10, s[4:7], s56 offen lds
    s_add_u32 m0, s61, 1024
    s_add_u32 s56, s62, 10880
    buffer_load_dwordx4 v11, s[4:7], s56 offen lds
    s_add_u32 m0, s61, 2048
    s_add_u32 s56, s62, 21120
    buffer_load_dwordx4 v10, s[4:7], s56 offen lds
    s_add_u32 m0, s61, 3072
    s_add_u32 s56, s62, 31360
    buffer_load_dwordx4 v11, s[4:7], s56 offen lds
    s_waitcnt vmcnt(16)
    s_barrier
    s_add_u32 m0, s61, 49152
    s_add_u32 s56, s63, 1474560
    buffer_load_dwordx4 v12, s[8:11], s56 offen lds
    s_add_u32 m0, s61, 50176
    s_add_u32 s56, s63, 1474624
    buffer_load_dwordx4 v12, s[8:11], s56 offen lds
    s_add_u32 m0, s61, 51200
    s_add_u32 s56, s63, 1474688
    buffer_load_dwordx4 v12, s[8:11], s56 offen lds
    s_add_u32 m0, s61, 52224
    s_add_u32 s56, s63, 1474752
    buffer_load_dwordx4 v12, s[8:11], s56 offen lds
    s_add_u32 m0, s61, 32768
    s_add_u32 s56, s62, 768
    buffer_load_dwordx4 v10, s[4:7], s56 offen lds
    s_add_u32 m0, s61, 33792
    s_add_u32 s56, s62, 11008
    buffer_load_dwordx4 v11, s[4:7], s56 offen lds
    s_add_u32 m0, s61, 34816
    s_add_u32 s56, s62, 21248
    buffer_load_dwordx4 v10, s[4:7], s56 offen lds
    s_add_u32 m0, s61, 35840
    s_add_u32 s56, s62, 31488
    buffer_load_dwordx4 v11, s[4:7], s56 offen lds
    s_waitcnt vmcnt(16)
    s_barrier
    s_add_u32 m0, s61, 81920
    s_add_u32 s56, s63, 1720320
    buffer_load_dwordx4 v12, s[8:11], s56 offen lds
    s_add_u32 m0, s61, 82944
    s_add_u32 s56, s63, 1720384
    buffer_load_dwordx4 v12, s[8:11], s56 offen lds
    s_add_u32 m0, s61, 83968
    s_add_u32 s56, s63, 1720448
    buffer_load_dwordx4 v12, s[8:11], s56 offen lds
    s_add_u32 m0, s61, 84992
    s_add_u32 s56, s63, 1720512
    buffer_load_dwordx4 v12, s[8:11], s56 offen lds
    s_add_u32 m0, s61, 65536
    s_add_u32 s56, s62, 896
    buffer_load_dwordx4 v10, s[4:7], s56 offen lds
    s_add_u32 m0, s61, 66560
    s_add_u32 s56, s62, 11136
    buffer_load_dwordx4 v11, s[4:7], s56 offen lds
    s_add_u32 m0, s61, 67584
    s_add_u32 s56, s62, 21376
    buffer_load_dwordx4 v10, s[4:7], s56 offen lds
    s_add_u32 m0, s61, 68608
    s_add_u32 s56, s62, 31616
    buffer_load_dwordx4 v11, s[4:7], s56 offen lds
    s_waitcnt vmcnt(16)
    s_barrier
    s_add_u32 m0, s61, 114688
    s_add_u32 s56, s63, 1966080
    buffer_load_dwordx4 v12, s[8:11], s56 offen lds
    s_add_u32 m0, s61, 115712
    s_add_u32 s56, s63, 1966144
    buffer_load_dwordx4 v12, s[8:11], s56 offen lds
    s_add_u32 m0, s61, 116736
    s_add_u32 s56, s63, 1966208
    buffer_load_dwordx4 v12, s[8:11], s56 offen lds
    s_add_u32 m0, s61, 117760
    s_add_u32 s56, s63, 1966272
    buffer_load_dwordx4 v12, s[8:11], s56 offen lds
    s_add_u32 m0, s61, 98304
    s_add_u32 s56, s62, 1024
    buffer_load_dwordx4 v10, s[4:7], s56 offen lds
    s_add_u32 m0, s61, 99328
    s_add_u32 s56, s62, 11264
    buffer_load_dwordx4 v11, s[4:7], s56 offen lds
    s_add_u32 m0, s61, 100352
    s_add_u32 s56, s62, 21504
    buffer_load_dwordx4 v10, s[4:7], s56 offen lds
    s_add_u32 m0, s61, 101376
    s_add_u32 s56, s62, 31744
    buffer_load_dwordx4 v11, s[4:7], s56 offen lds
    s_waitcnt vmcnt(16)
    s_barrier
    s_add_u32 m0, s61, 147456
    s_add_u32 s56, s63, 2211840
    buffer_load_dwordx4 v12, s[8:11], s56 offen lds
    s_add_u32 m0, s61, 148480
    s_add_u32 s56, s63, 2211904
    buffer_load_dwordx4 v12, s[8:11], s56 offen lds
    s_add_u32 m0, s61, 149504
    s_add_u32 s56, s63, 2211968
    buffer_load_dwordx4 v12, s[8:11], s56 offen lds
    s_add_u32 m0, s61, 150528
    s_add_u32 s56, s63, 2212032
    buffer_load_dwordx4 v12, s[8:11], s56 offen lds
    s_add_u32 m0, s61, 131072
    s_add_u32 s56, s62, 1152
    buffer_load_dwordx4 v10, s[4:7], s56 offen lds
    s_add_u32 m0, s61, 132096
    s_add_u32 s56, s62, 11392
    buffer_load_dwordx4 v11, s[4:7], s56 offen lds
    s_add_u32 m0, s61, 133120
    s_add_u32 s56, s62, 21632
    buffer_load_dwordx4 v10, s[4:7], s56 offen lds
    s_add_u32 m0, s61, 134144
    s_add_u32 s56, s62, 31872
    buffer_load_dwordx4 v11, s[4:7], s56 offen lds
    s_lshl_b32 s66, s39, 2
    s_add_u32 s66, s66, s44
    s_lshl_b32 s66, s66, 12
    s_add_u32 s66, s66, 0xb0000
    v_lshlrev_b32 v6, 4, v1
    buffer_load_dwordx4 v[32:35], v6, s[32:35], s66 offen offset:0 sc1
    buffer_load_dwordx4 v[36:39], v6, s[32:35], s66 offen offset:1024 sc1
    buffer_load_dwordx4 v[40:43], v6, s[32:35], s66 offen offset:2048 sc1
    buffer_load_dwordx4 v[44:47], v6, s[32:35], s66 offen offset:3072 sc1
    s_waitcnt lgkmcnt(0)
    s_add_u32 s36, s36, 1
    s_not_b32 s37, s36
    s_waitcnt vmcnt(20)
    s_barrier
    s_waitcnt vmcnt(12)
    s_barrier
    s_lshl_b32 s54, s44, 9
    v_lshl_add_u32 v4, v1, 3, s54
    s_mov_b32 s99, 0x80000
    s_waitcnt vmcnt(0)
P1_gchk:
    v_xor_b32 v34, s36, v34
    v_xor_b32 v35, s37, v35
    v_xor_b32 v38, s36, v38
    v_xor_b32 v39, s37, v39
    v_xor_b32 v42, s36, v42
    v_xor_b32 v43, s37, v43
    v_xor_b32 v46, s36, v46
    v_xor_b32 v47, s37, v47
    v_or_b32 v2, v34, v35
    v_or3_b32 v2, v2, v38, v39
    v_or3_b32 v2, v2, v42, v43
    v_or3_b32 v2, v2, v46, v47
    v_cmp_ne_u32 vcc, 0, v2
    s_nop 1
    s_cbranch_vccnz P1_gretry
P1_gok:
    v_add_f32 v32, v32, v36
    v_add_f32 v33, v33, v37
    v_add_f32 v40, v40, v44
    v_add_f32 v41, v41, v45
    v_add_f32 v32, v32, v40
    v_add_f32 v33, v33, v41
    ds_write_b64 v4, v[32:33]
    s_waitcnt lgkmcnt(0)
    s_waitcnt vmcnt(4)
    s_barrier
    s_branch P1_nopub
P1_gretry:
    buffer_load_dwordx4 v[32:35], v6, s[32:35], s66 offen offset:0 sc1
    buffer_load_dwordx4 v[36:39], v6, s[32:35], s66 offen offset:1024 sc1
    buffer_load_dwordx4 v[40:43], v6, s[32:35], s66 offen offset:2048 sc1
    buffer_load_dwordx4 v[44:47], v6, s[32:35], s66 offen offset:3072 sc1
    s_waitcnt vmcnt(0)
    s_sub_u32 s99, s99, 1
    s_cbranch_scc0 P1_gchk
    s_branch P1_gok
P1_lidle:
    s_waitcnt lgkmcnt(0)
    s_add_u32 s36, s36, 1
    s_not_b32 s37, s36
    s_branch P1_nopub
P1_comp:
    s_and_b32 s54, s2, 7
    s_lshl_b32 s54, s54, 8
    s_and_b32 s55, s2, 0xf8
    s_add_u32 s54, s54, s55
    s_lshl_b32 s55, s3, 1
    s_add_u32 s54, s54, s55
    v_lshrrev_b32 v2, 5, v1
    v_and_b32 v3, 31, v1
    v_add_u32 v174, s54, v2
    v_mul_u32_u24 v175, 1280, v174
    v_lshl_add_u32 v175, v3, 4, v175
    v_mov_b32 v7, 0x40000000
    v_cmp_gt_u32 vcc, 16, v3
    v_lshrrev_b32 v177, 2, v1
    v_mul_u32_u24 v177, 3840, v177
    v_cndmask_b32 v176, v7, v175, vcc
    v_and_b32 v178, 3, v1
    v_lshl_add_u32 v177, v178, 4, v177
    v_lshl_add_u32 v179, v2, 30, v177
    s_mul_i32 s54, s38, 153600
    s_lshl_b32 s55, s39, 8
    s_add_u32 s54, s54, s55
    s_lshl_b32 s55, s3, 6
    s_add_u32 s54, s54, s55
    s_add_u32 s55, s54, 61440
    s_add_u32 s56, s54, 122880
    s_mov_b32 s94, s54
    s_mov_b32 s95, s55
    s_mov_b32 s96, s56
    s_waitcnt lgkmcnt(0)
    s_load_dword s36, s[32:33], 0
    buffer_load_dwordx4 v[160:163], v175, s[4:7], 0 offen
    buffer_load_dwordx4 v[164:167], v175, s[4:7], 0 offen offset:512
    buffer_load_dwordx4 v[168:171], v176, s[4:7], 0 offen offset:1024
    buffer_load_dwordx4 v[180:183], v177, s[8:11], s94 offen
    buffer_load_dwordx4 v[184:187], v177, s[8:11], s95 offen
    buffer_load_dwordx4 v[188:191], v179, s[8:11], s96 offen
    v_lshlrev_b32 v174, 4, v174
    v_add_u32 v174, 0x1000, v174
    v_lshrrev_b32 v179, 4, v1
    v_lshl_add_u32 v179, v178, 2, v179
    v_lshlrev_b32 v179, 4, v179
    s_and_b32 s69, s38, 7
    s_lshl_b32 s69, s69, 1
    s_lshr_b32 s54, s38, 3
    s_add_u32 s69, s69, s54
    s_and_b32 s42, s3, 1
    s_lshr_b32 s43, s44, 1
    s_cmp_ge_u32 s39, 5
    s_cselect_b32 s41, 1, 0
    s_cmp_ge_u32 s39, 10
    s_cselect_b32 s41, 2, s41
    s_mul_i32 s40, s41, 5
    s_sub_u32 s40, s39, s40
    s_lshl_b32 s54, s43, 4
    s_mul_i32 s54, s54, 0x01010101
    s_add_u32 s46, s54, 0x03020100
    s_add_u32 s47, s54, 0x07060504
    s_add_u32 s48, s54, 0x0b0a0908
    s_add_u32 s49, s54, 0x0f0e0d0c
    s_lshl_b32 s54, s40, 1
    s_add_u32 s54, s54, s43
    s_cmp_eq_u32 s41, 2
    s_cselect_b32 s54, 10, s54
    s_cmp_eq_u32 s54, 0
    s_cselect_b32 s46, 0xa150e17, s46
    s_cselect_b32 s47, 0x1000403, s47
    s_cselect_b32 s48, 0xd1b0c1a, s48
    s_cselect_b32 s49, 0x1e081f09, s49
    s_cmp_eq_u32 s54, 1
    s_cselect_b32 s46, 0x1619141d, s46
    s_cselect_b32 s47, 0xf101312, s47
    s_cselect_b32 s48, 0x2051c06, s48
    s_cselect_b32 s49, 0xb071118, s49
    s_cmp_eq_u32 s54, 2
    s_cselect_b32 s46, 0x18191b1a, s46
    s_cselect_b32 s47, 0x1d1f1e1c, s47
    s_cselect_b32 s48, 0x40e0511, s48
    s_cselect_b32 s49, 0xf0a100b, s49
    s_cmp_eq_u32 s54, 3
    s_cselect_b32 s46, 0x7120615, s46
    s_cselect_b32 s47, 0x140113, s47
    s_cselect_b32 s48, 0x3081609, s48
    s_cselect_b32 s49, 0xd02170c, s49
    s_cmp_eq_u32 s54, 4
    s_cselect_b32 s46, 0x1d101b11, s46
    s_cselect_b32 s47, 0xe140f12, s47
    s_cselect_b32 s48, 0x1c091e07, s48
    s_cselect_b32 s49, 0xb0a0d08, s49
    s_cmp_eq_u32 s54, 5
    s_cselect_b32 s46, 0x4160318, s46
    s_cselect_b32 s47, 0x2190517, s47
    s_cselect_b32 s48, 0x131f1a0c, s48
    s_cselect_b32 s49, 0x1000615, s49
    s_cmp_eq_u32 s54, 6
    s_cselect_b32 s46, 0x11141016, s46
    s_cselect_b32 s47, 0x1d1b1f1a, s47
    s_cselect_b32 s48, 0x7050604, s48
    s_cselect_b32 s49, 0x2000103, s49
    s_cmp_eq_u32 s54, 7
    s_cselect_b32 s46, 0xd180c19, s46
    s_cselect_b32 s47, 0xe171213, s47
    s_cselect_b32 s48, 0x90a080b, s48
    s_cselect_b32 s49, 0x1e0f151c, s49
    s_cmp_eq_u32 s54, 8
    s_cselect_b32 s46, 0x5060302, s46
    s_cselect_b32 s47, 0x10c000f, s47
    s_cselect_b32 s48, 0x15171118, s48
    s_cselect_b32 s49, 0x141e121b, s49
    s_cmp_eq_u32 s54, 9
    s_cselect_b32 s46, 0xa090b08, s46
    s_cselect_b32 s47, 0x1c0d1f0e, s47
    s_cselect_b32 s48, 0x1d19101a, s48
    s_cselect_b32 s49, 0x4130716, s49
    v_and_b32 v2, 3, v1
    v_bfe_u32 v3, v1, 4, 1
    v_lshl_add_u32 v2, v3, 2, v2
    v_lshlrev_b32 v2, 3, v2
    v_bfe_u32 v3, v1, 2, 2
    v_lshrrev_b32 v4, 5, v1
    v_lshl_add_u32 v3, v4, 3, v3
    v_lshlrev_b32 v3, 6, v3
    v_add_u32 v3, 16384, v3
    v_lshrrev_b64 v[8:9], v2, s[46:47]
    v_and_b32 v8, 31, v8
    v_lshrrev_b32 v9, 3, v8
    v_and_b32 v8, 7, v8
    v_lshlrev_b32 v9, 10, v9
    v_lshl_add_u32 v9, v8, 3, v9
    v_add_u32 v6, v9, v3
    v_lshrrev_b64 v[8:9], v2, s[48:49]
    v_and_b32 v8, 31, v8
    v_lshrrev_b32 v9, 3, v8
    v_and_b32 v8, 7, v8
    v_lshlrev_b32 v9, 10, v9
    v_lshl_add_u32 v9, v8, 3, v9
    v_add_u32 v7, v9, v3
    v_and_b32 v2, 31, v1
    v_lshrrev_b32 v4, 5, v1
    v_bfe_u32 v3, v2, 1, 3
    v_xor_b32 v3, v3, v4
    s_lshl_b32 s54, s42, 13
    v_lshl_add_u32 v5, v2, 7, s54
    v_xor_b32 v8, 0, v3
    v_lshl_add_u32 v10, v8, 4, v5
    v_xor_b32 v8, 2, v3
    v_lshl_add_u32 v11, v8, 4, v5
    v_xor_b32 v8, 4, v3
    v_lshl_add_u32 v12, v8, 4, v5
    v_xor_b32 v8, 6, v3
    v_lshl_add_u32 v13, v8, 4, v5
    s_lshl_b32 s57, s39, 4
    s_add_u32 s57, s57, s38
    s_lshl_b32 s57, s57, 2
    s_add_u32 s57, s57, s3
    s_lshl_b32 s57, s57, 8
    s_add_u32 s57, s57, 0xb0000
    s_mov_b32 s55, 0x3f803f80
    s_mov_b32 s56, 0x3f80
    s_mov_b32 s60, 0x3f800000
    v_mov_b32 v172, 0
    v_mov_b32 v173, 0
    s_waitcnt lgkmcnt(0)
    s_add_u32 s36, s36, 1
    s_not_b32 s37, s36
    s_waitcnt vmcnt(3)
    v_dot2_f32_bf16 v172, v160, s55, v172
    v_dot2_f32_bf16 v173, v160, v160, v173
    v_dot2_f32_bf16 v172, v161, s55, v172
    v_dot2_f32_bf16 v173, v161, v161, v173
    v_dot2_f32_bf16 v172, v162, s55, v172
    v_dot2_f32_bf16 v173, v162, v162, v173
    v_dot2_f32_bf16 v172, v163, s55, v172
    v_dot2_f32_bf16 v173, v163, v163, v173
    v_dot2_f32_bf16 v172, v164, s55, v172
    v_dot2_f32_bf16 v173, v164, v164, v173
    v_dot2_f32_bf16 v172, v165, s55, v172
    v_dot2_f32_bf16 v173, v165, v165, v173
    v_dot2_f32_bf16 v172, v166, s55, v172
    v_dot2_f32_bf16 v173, v166, v166, v173
    v_dot2_f32_bf16 v172, v167, s55, v172
    v_dot2_f32_bf16 v173, v167, v167, v173
    v_dot2_f32_bf16 v172, v168, s55, v172
    v_dot2_f32_bf16 v173, v168, v168, v173
    v_dot2_f32_bf16 v172, v169, s55, v172
    v_dot2_f32_bf16 v173, v169, v169, v173
    v_dot2_f32_bf16 v172, v170, s55, v172
    v_dot2_f32_bf16 v173, v170, v170, v173
    v_dot2_f32_bf16 v172, v171, s55, v172
    v_dot2_f32_bf16 v173, v171, v171, v173
    s_nop 3
    v_add_f32_dpp v172, v172, v172 row_shr:1 row_mask:0xf bank_mask:0xf bound_ctrl:0
    v_add_f32_dpp v173, v173, v173 row_shr:1 row_mask:0xf bank_mask:0xf bound_ctrl:0
    s_nop 0
    v_add_f32_dpp v172, v172, v172 row_shr:2 row_mask:0xf bank_mask:0xf bound_ctrl:0
    v_add_f32_dpp v173, v173, v173 row_shr:2 row_mask:0xf bank_mask:0xf bound_ctrl:0
    s_nop 0
    v_add_f32_dpp v172, v172, v172 row_shr:4 row_mask:0xf bank_mask:0xf bound_ctrl:0
    v_add_f32_dpp v173, v173, v173 row_shr:4 row_mask:0xf bank_mask:0xf bound_ctrl:0
    s_nop 0
    v_add_f32_dpp v172, v172, v172 row_shr:8 row_mask:0xf bank_mask:0xf bound_ctrl:0
    v_add_f32_dpp v173, v173, v173 row_shr:8 row_mask:0xf bank_mask:0xf bound_ctrl:0
    s_nop 0
    v_add_f32_dpp v172, v172, v172 row_bcast:15 row_mask:0xa bank_mask:0xf
    v_add_f32_dpp v173, v173, v173 row_bcast:15 row_mask:0xa bank_mask:0xf
    v_mul_f32 v160, 0x3acccccd, v172
    v_mul_f32 v173, 0x3acccccd, v173
    v_fma_f32 v173, -v160, v160, v173
    v_max_f32 v173, 0, v173
    v_add_f32 v173, 0x3727c5ac, v173
    v_rsq_f32 v161, v173
    v_mov_b32 v162, s36
    v_mov_b32 v163, s37
    s_mov_b32 exec_lo, 0x80000000
    s_mov_b32 exec_hi, 0x80000000
    buffer_store_dwordx4 v[160:163], v174, s[32:35], 0 offen sc1
    s_mov_b64 exec, -1
    s_cmp_eq_u32 s39, 15
    s_cbranch_scc1 P1_done
    s_waitcnt vmcnt(1)
    v_dot2_f32_bf16 v164, v180, s56, 0
    v_dot2_f32_bf16 v165, v180, s60, 0
    v_dot2_f32_bf16 v166, v181, s56, 0
    v_dot2_f32_bf16 v167, v181, s60, 0
    v_dot2_f32_bf16 v168, v182, s56, 0
    v_dot2_f32_bf16 v169, v182, s60, 0
    v_dot2_f32_bf16 v170, v183, s56, 0
    v_dot2_f32_bf16 v171, v183, s60, 0
    v_dot2_f32_bf16 v164, v184, s56, v164
    v_dot2_f32_bf16 v165, v184, s60, v165
    v_dot2_f32_bf16 v166, v185, s56, v166
    v_dot2_f32_bf16 v167, v185, s60, v167
    v_dot2_f32_bf16 v168, v186, s56, v168
    v_dot2_f32_bf16 v169, v186, s60, v169
    v_dot2_f32_bf16 v170, v187, s56, v170
    v_dot2_f32_bf16 v171, v187, s60, v171
    v_dot2_f32_bf16 v164, v188, s56, v164
    v_dot2_f32_bf16 v165, v188, s60, v165
    v_dot2_f32_bf16 v166, v189, s56, v166
    v_dot2_f32_bf16 v167, v189, s60, v167
    v_dot2_f32_bf16 v168, v190, s56, v168
    v_dot2_f32_bf16 v169, v190, s60, v169
    v_dot2_f32_bf16 v170, v191, s56, v170
    v_dot2_f32_bf16 v171, v191, s60, v171
    s_nop 2
    v_permlane32_swap_b32 v164, v168
    v_permlane32_swap_b32 v165, v169
    v_permlane32_swap_b32 v166, v170
    v_permlane32_swap_b32 v167, v171
    v_add_f32 v164, v164, v168
    v_add_f32 v165, v165, v169
    v_add_f32 v166, v166, v170
    v_add_f32 v167, v167, v171
    s_nop 0
    v_permlane16_swap_b32 v164, v166
    v_permlane16_swap_b32 v165, v167
    v_add_f32 v164, v164, v166
    v_add_f32 v165, v165, v167
    v_mov_b32 v166, s36
    v_add_f32_dpp v164, v164, v164 row_shr:4 row_mask:0xf bank_mask:0xf bound_ctrl:0
    v_add_f32_dpp v165, v165, v165 row_shr:4 row_mask:0xf bank_mask:0xf bound_ctrl:0
    v_mov_b32 v167, s37
    v_add_f32_dpp v164, v164, v164 row_shr:8 row_mask:0xf bank_mask:0xf bound_ctrl:0
    v_add_f32_dpp v165, v165, v165 row_shr:8 row_mask:0xf bank_mask:0xf bound_ctrl:0
    s_mov_b32 exec_lo, 0xf000f000
    s_mov_b32 exec_hi, 0xf000f000
    buffer_store_dwordx4 v[164:167], v179, s[32:35], s57 offen sc1
    s_mov_b64 exec, -1
    s_barrier
    ds_read_b128 v[128:131], v10 offset:0
    ds_read_b64_tr_b16 v[136:137], v6 offset:0
    ds_read_b64_tr_b16 v[138:139], v6 offset:256
    ds_read_b64_tr_b16 v[140:141], v7 offset:0
    ds_read_b64_tr_b16 v[142:143], v7 offset:256
    ds_read_b128 v[132:135], v10 offset:4096
    ds_read_b128 v[144:147], v11 offset:0
    ds_read_b64_tr_b16 v[152:153], v6 offset:4096
    ds_read_b64_tr_b16 v[154:155], v6 offset:4352
    ds_read_b64_tr_b16 v[156:157], v7 offset:4096
    ds_read_b64_tr_b16 v[158:159], v7 offset:4352
    ds_read_b128 v[148:151], v11 offset:4096
    s_cmp_eq_u32 s41, 2
    s_cbranch_scc1 P1_cloopv
P1_cloop:
    s_waitcnt lgkmcnt(6)
    v_mfma_f32_32x32x16_bf16 v[64:79], v[136:139], v[128:131], 0
    ds_read_b128 v[208:211], v12 offset:0
    ds_read_b64_tr_b16 v[216:217], v6 offset:8192
    v_add_u32 v14, 65536, v10
    v_mfma_f32_32x32x16_bf16 v[80:95], v[140:143], v[128:131], 0
    ds_read_b64_tr_b16 v[218:219], v6 offset:8448
    ds_read_b64_tr_b16 v[220:221], v7 offset:8192
    v_add_u32 v18, 65536, v14
    v_mfma_f32_32x32x16_bf16 v[96:111], v[136:139], v[132:135], 0
    ds_read_b64_tr_b16 v[222:223], v7 offset:8448
    ds_read_b128 v[212:215], v12 offset:4096
    v_add_u32 v15, 65536, v11
    v_add_u32 v19, 65536, v15
    v_mfma_f32_32x32x16_bf16 v[112:127], v[140:143], v[132:135], 0
    v_add_u32 v16, 65536, v12
    v_add_u32 v20, 65536, v16
    v_add_u32 v17, 65536, v13
    s_waitcnt lgkmcnt(6)
    v_mfma_f32_32x32x16_bf16 v[64:79], v[152:155], v[144:147], v[64:79]
    ds_read_b128 v[128:131], v13 offset:0
    ds_read_b64_tr_b16 v[136:137], v6 offset:12288
    v_add_u32 v21, 65536, v17
    v_mfma_f32_32x32x16_bf16 v[80:95], v[156:159], v[144:147], v[80:95]
    ds_read_b64_tr_b16 v[138:139], v6 offset:12544
    ds_read_b64_tr_b16 v[140:141], v7 offset:12288
    v_add_u32 v56, 65536, v6
    v_mfma_f32_32x32x16_bf16 v[96:111], v[152:155], v[148:151], v[96:111]
    ds_read_b64_tr_b16 v[142:143], v7 offset:12544
    ds_read_b128 v[132:135], v13 offset:4096
    v_add_u32 v58, 65536, v56
    v_add_u32 v57, 65536, v7
    v_mfma_f32_32x32x16_bf16 v[112:127], v[156:159], v[148:151], v[112:127]
    v_add_u32 v59, 65536, v57
    s_lshl_b32 s54, s38, 7
    s_lshl_b32 s55, s42, 6
    s_barrier
    s_waitcnt lgkmcnt(6)
    v_mfma_f32_32x32x16_bf16 v[64:79], v[216:219], v[208:211], v[64:79]
    ds_read_b128 v[144:147], v10 offset:32768
    ds_read_b64_tr_b16 v[152:153], v6 offset:32768
    s_add_u32 s54, s54, s55
    v_mfma_f32_32x32x16_bf16 v[80:95], v[220:223], v[208:211], v[80:95]
    ds_read_b64_tr_b16 v[154:155], v6 offset:33024
    ds_read_b64_tr_b16 v[156:157], v7 offset:32768
    v_add_u32 v22, s54, v2
    v_mfma_f32_32x32x16_bf16 v[96:111], v[216:219], v[212:215], v[96:111]
    ds_read_b64_tr_b16 v[158:159], v7 offset:33024
    ds_read_b128 v[148:151], v10 offset:36864
    v_lshlrev_b32 v22, 4, v22
    v_add_u32 v22, 0x1000, v22
    v_mfma_f32_32x32x16_bf16 v[112:127], v[220:223], v[212:215], v[112:127]
    s_lshl_b32 s54, s40, 1
    s_add_u32 s54, s54, s43
    s_cmp_eq_u32 s41, 2
    s_waitcnt lgkmcnt(6)
    v_mfma_f32_32x32x16_bf16 v[64:79], v[136:139], v[128:131], v[64:79]
    ds_read_b128 v[208:211], v11 offset:32768
    ds_read_b64_tr_b16 v[216:217], v6 offset:36864
    s_cselect_b32 s54, 10, s54
    v_mfma_f32_32x32x16_bf16 v[80:95], v[140:143], v[128:131], v[80:95]
    ds_read_b64_tr_b16 v[218:219], v6 offset:37120
    ds_read_b64_tr_b16 v[220:221], v7 offset:36864
    s_mov_b64 s[50:51], 0
    v_mfma_f32_32x32x16_bf16 v[96:111], v[136:139], v[132:135], v[96:111]
    ds_read_b64_tr_b16 v[222:223], v7 offset:37120
    ds_read_b128 v[212:215], v11 offset:36864
    s_mov_b64 s[52:53], 0
    s_cmp_eq_u32 s54, 0
    v_mfma_f32_32x32x16_bf16 v[112:127], v[140:143], v[132:135], v[112:127]
    s_cselect_b32 s50, 0x80a0a284, s50
    s_cselect_b32 s51, 0x86818285, s51
    s_cmp_eq_u32 s54, 1
    s_waitcnt lgkmcnt(6)
    v_mfma_f32_32x32x16_bf16 v[64:79], v[152:155], v[144:147], v[64:79]
    ds_read_b128 v[128:131], v12 offset:32768
    ds_read_b64_tr_b16 v[136:137], v6 offset:40960
    s_cselect_b32 s50, 0x83a3a4a5, s50
    v_mfma_f32_32x32x16_bf16 v[80:95], v[156:159], v[144:147], v[80:95]
    ds_read_b64_tr_b16 v[138:139], v6 offset:41216
    ds_read_b64_tr_b16 v[140:141], v7 offset:40960
    s_cselect_b32 s51, 0xa1, s51
    v_mfma_f32_32x32x16_bf16 v[96:111], v[152:155], v[148:151], v[96:111]
    ds_read_b64_tr_b16 v[142:143], v7 offset:41216
    ds_read_b128 v[132:135], v12 offset:36864
    s_cselect_b32 s52, 0x80008500, s52
    s_cselect_b32 s53, 0x82818384, s53
    v_mfma_f32_32x32x16_bf16 v[112:127], v[156:159], v[148:151], v[112:127]
    s_cmp_eq_u32 s54, 2
    s_cselect_b32 s50, 0xac8cab8b, s50
    s_cselect_b32 s51, 0x89a8a7a9, s51
    s_waitcnt lgkmcnt(6)
    v_mfma_f32_32x32x16_bf16 v[64:79], v[216:219], v[208:211], v[64:79]
    ds_read_b128 v[144:147], v13 offset:32768
    ds_read_b64_tr_b16 v[152:153], v6 offset:45056
    s_cmp_eq_u32 s54, 3
    v_mfma_f32_32x32x16_bf16 v[80:95], v[220:223], v[208:211], v[80:95]
    ds_read_b64_tr_b16 v[154:155], v6 offset:45312
    ds_read_b64_tr_b16 v[156:157], v7 offset:45056
    s_cselect_b32 s50, 0xa6aa878a, s50
    v_mfma_f32_32x32x16_bf16 v[96:111], v[216:219], v[212:215], v[96:111]
    ds_read_b64_tr_b16 v[158:159], v7 offset:45312
    ds_read_b128 v[148:151], v13 offset:36864
    s_cselect_b32 s51, 0x88, s51
    s_cselect_b32 s52, 0x87008a00, s52
    v_mfma_f32_32x32x16_bf16 v[112:127], v[220:223], v[212:215], v[112:127]
    s_cselect_b32 s53, 0x89868b88, s53
    s_cmp_eq_u32 s54, 4
    s_cselect_b32 s50, 0xafb09290, s50
    s_barrier
    s_waitcnt lgkmcnt(6)
    v_mfma_f32_32x32x16_bf16 v[64:79], v[136:139], v[128:131], v[64:79]
    ds_read_b128 v[208:211], v14 offset:0
    ds_read_b64_tr_b16 v[216:217], v56 offset:0
    s_cselect_b32 s51, 0x8faeb28e, s51
    v_mfma_f32_32x32x16_bf16 v[80:95], v[140:143], v[128:131], v[80:95]
    ds_read_b64_tr_b16 v[218:219], v56 offset:256
    ds_read_b64_tr_b16 v[220:221], v57 offset:0
    s_cmp_eq_u32 s54, 5
    v_mfma_f32_32x32x16_bf16 v[96:111], v[136:139], v[132:135], v[96:111]
    ds_read_b64_tr_b16 v[222:223], v57 offset:256
    ds_read_b128 v[212:215], v14 offset:4096
    s_cselect_b32 s50, 0x8db1ad91, s50
    s_cselect_b32 s52, 0x9093928f, s52
    v_mfma_f32_32x32x16_bf16 v[112:127], v[140:143], v[132:135], v[112:127]
    s_cselect_b32 s53, 0x8d8c8e91, s53
    s_cmp_eq_u32 s54, 6
    s_cselect_b32 s50, 0x99b896b7, s50
    s_waitcnt lgkmcnt(6)
    v_mfma_f32_32x32x16_bf16 v[64:79], v[152:155], v[144:147], v[64:79]
    ds_read_b128 v[128:131], v15 offset:0
    ds_read_b64_tr_b16 v[136:137], v56 offset:4096
    s_cselect_b32 s51, 0xb39394b4, s51
    v_mfma_f32_32x32x16_bf16 v[80:95], v[156:159], v[144:147], v[80:95]
    ds_read_b64_tr_b16 v[138:139], v56 offset:4352
    ds_read_b64_tr_b16 v[140:141], v57 offset:4096
    s_cmp_eq_u32 s54, 7
    v_mfma_f32_32x32x16_bf16 v[96:111], v[152:155], v[148:151], v[96:111]
    ds_read_b64_tr_b16 v[142:143], v57 offset:4352
    ds_read_b128 v[132:135], v15 offset:4096
    s_cselect_b32 s50, 0xb6979598, s50
    s_cselect_b32 s51, 0xb5, s51
    v_mfma_f32_32x32x16_bf16 v[112:127], v[156:159], v[148:151], v[112:127]
    s_cselect_b32 s52, 0x95009400, s52
    s_cselect_b32 s53, 0x99969798, s53
    s_cmp_eq_u32 s54, 8
    s_waitcnt lgkmcnt(6)
    v_mfma_f32_32x32x16_bf16 v[64:79], v[216:219], v[208:211], v[64:79]
    ds_read_b128 v[144:147], v16 offset:0
    ds_read_b64_tr_b16 v[152:153], v56 offset:8192
    s_cselect_b32 s50, 0xb99c9aba, s50
    v_mfma_f32_32x32x16_bf16 v[80:95], v[220:223], v[208:211], v[80:95]
    ds_read_b64_tr_b16 v[154:155], v56 offset:8448
    ds_read_b64_tr_b16 v[156:157], v57 offset:8192
    s_cselect_b32 s51, 0x9d9fbd9e, s51
    v_mfma_f32_32x32x16_bf16 v[96:111], v[216:219], v[212:215], v[96:111]
    ds_read_b64_tr_b16 v[158:159], v57 offset:8448
    ds_read_b128 v[148:151], v16 offset:4096
    s_cmp_eq_u32 s54, 9
    s_cselect_b32 s50, 0xbfbc9bbb, s50
    v_mfma_f32_32x32x16_bf16 v[112:127], v[220:223], v[212:215], v[112:127]
    s_cselect_b32 s51, 0xbe, s51
    s_cselect_b32 s52, 0x9f009c00, s52
    s_cselect_b32 s53, 0x9a9d9b9e, s53
    s_waitcnt lgkmcnt(6)
    v_mfma_f32_32x32x16_bf16 v[64:79], v[136:139], v[128:131], v[64:79]
    ds_read_b128 v[208:211], v17 offset:0
    ds_read_b64_tr_b16 v[216:217], v56 offset:12288
    s_cmp_eq_u32 s41, 0
    v_mfma_f32_32x32x16_bf16 v[80:95], v[140:143], v[128:131], v[80:95]
    ds_read_b64_tr_b16 v[218:219], v56 offset:12544
    ds_read_b64_tr_b16 v[220:221], v57 offset:12288
    s_mov_b32 s64, 163840
    v_mfma_f32_32x32x16_bf16 v[96:111], v[136:139], v[132:135], v[96:111]
    ds_read_b64_tr_b16 v[222:223], v57 offset:12544
    ds_read_b128 v[212:215], v17 offset:4096
    s_cselect_b32 s64, 65536, s64
    s_mov_b32 s65, 163840
    v_mfma_f32_32x32x16_bf16 v[112:127], v[140:143], v[132:135], v[112:127]
    s_cselect_b32 s65, 16384, s65
    s_mov_b32 s54, 10240
    s_cselect_b32 s54, 4096, s54
    s_barrier
    s_waitcnt lgkmcnt(6)
    v_mfma_f32_32x32x16_bf16 v[64:79], v[152:155], v[144:147], v[64:79]
    ds_read_b128 v[128:131], v14 offset:32768
    ds_read_b64_tr_b16 v[136:137], v56 offset:32768
    s_mov_b32 s55, 10240
    v_mfma_f32_32x32x16_bf16 v[80:95], v[156:159], v[144:147], v[80:95]
    ds_read_b64_tr_b16 v[138:139], v56 offset:33024
    ds_read_b64_tr_b16 v[140:141], v57 offset:32768
    s_cselect_b32 s55, 1024, s55
    v_mfma_f32_32x32x16_bf16 v[96:111], v[152:155], v[148:151], v[96:111]
    ds_read_b64_tr_b16 v[142:143], v57 offset:33024
    ds_read_b128 v[132:135], v14 offset:36864
    s_mov_b32 s66, 0x400000
    s_cselect_b32 s66, 0x100000, s66
    v_mfma_f32_32x32x16_bf16 v[112:127], v[156:159], v[148:151], v[112:127]
    s_mov_b32 s67, 0x401000
    s_cselect_b32 s67, 0x300000, s67
    s_cselect_b32 s68, 0x3ea52b5c, 1.0
    s_waitcnt lgkmcnt(6)
    v_mfma_f32_32x32x16_bf16 v[64:79], v[216:219], v[208:211], v[64:79]
    ds_read_b128 v[144:147], v15 offset:32768
    ds_read_b64_tr_b16 v[152:153], v56 offset:36864
    s_cselect_b64 vcc, -1, 0
    v_mfma_f32_32x32x16_bf16 v[80:95], v[220:223], v[208:211], v[80:95]
    ds_read_b64_tr_b16 v[154:155], v56 offset:37120
    ds_read_b64_tr_b16 v[156:157], v57 offset:36864
    s_cselect_b32 s56, s38, s69
    v_mfma_f32_32x32x16_bf16 v[96:111], v[216:219], v[212:215], v[96:111]
    ds_read_b64_tr_b16 v[158:159], v57 offset:37120
    ds_read_b128 v[148:151], v15 offset:36864
    s_mul_i32 s54, s54, s56
    s_mul_i32 s55, s55, s56
    v_mfma_f32_32x32x16_bf16 v[112:127], v[220:223], v[212:215], v[112:127]
    s_add_u32 s66, s66, s54
    s_add_u32 s67, s67, s55
    s_lshl_b32 s54, s42, 11
    s_waitcnt lgkmcnt(6)
    v_mfma_f32_32x32x16_bf16 v[64:79], v[136:139], v[128:131], v[64:79]
    ds_read_b128 v[208:211], v16 offset:32768
    ds_read_b64_tr_b16 v[216:217], v56 offset:40960
    s_lshl_b32 s55, s42, 9
    v_mfma_f32_32x32x16_bf16 v[80:95], v[140:143], v[128:131], v[80:95]
    ds_read_b64_tr_b16 v[218:219], v56 offset:41216
    ds_read_b64_tr_b16 v[220:221], v57 offset:40960
    s_add_u32 s66, s66, s54
    v_mfma_f32_32x32x16_bf16 v[96:111], v[136:139], v[132:135], v[96:111]
    ds_read_b64_tr_b16 v[222:223], v57 offset:41216
    ds_read_b128 v[212:215], v16 offset:36864
    s_add_u32 s67, s67, s55
    v_bfe_u32 v3, v2, 2, 1
    v_mfma_f32_32x32x16_bf16 v[112:127], v[140:143], v[132:135], v[112:127]
    v_bfe_u32 v5, v2, 3, 1
    v_and_b32 v8, 0x13, v2
    v_lshl_add_u32 v8, v3, 3, v8
    s_waitcnt lgkmcnt(6)
    v_mfma_f32_32x32x16_bf16 v[64:79], v[152:155], v[144:147], v[64:79]
    ds_read_b128 v[128:131], v17 offset:32768
    ds_read_b64_tr_b16 v[136:137], v56 offset:45056
    v_lshl_add_u32 v8, v5, 2, v8
    v_mfma_f32_32x32x16_bf16 v[80:95], v[156:159], v[144:147], v[80:95]
    ds_read_b64_tr_b16 v[138:139], v56 offset:45312
    ds_read_b64_tr_b16 v[140:141], v57 offset:45056
    v_cndmask_b32 v32, v8, v2, vcc
    v_mfma_f32_32x32x16_bf16 v[96:111], v[152:155], v[148:151], v[96:111]
    ds_read_b64_tr_b16 v[142:143], v57 offset:45312
    ds_read_b128 v[132:135], v17 offset:36864
    v_lshlrev_b32 v33, 3, v4
    v_mov_b32 v34, 0x40000000
    v_mfma_f32_32x32x16_bf16 v[112:127], v[156:159], v[148:151], v[112:127]
    v_add_u32 v3, 0, v33
    v_lshrrev_b64 v[8:9], v3, s[50:51]
    v_and_b32 v9, 31, v8
    s_barrier
    s_waitcnt lgkmcnt(6)
    v_mfma_f32_32x32x16_bf16 v[64:79], v[216:219], v[208:211], v[64:79]
    ds_read_b128 v[144:147], v18 offset:0
    ds_read_b64_tr_b16 v[152:153], v58 offset:0
    v_mul_u32_u24 v9, s64, v9
    v_mfma_f32_32x32x16_bf16 v[80:95], v[220:223], v[208:211], v[80:95]
    ds_read_b64_tr_b16 v[154:155], v58 offset:256
    ds_read_b64_tr_b16 v[156:157], v59 offset:0
    v_bfe_u32 v5, v8, 5, 1
    v_mfma_f32_32x32x16_bf16 v[96:111], v[216:219], v[212:215], v[96:111]
    ds_read_b64_tr_b16 v[158:159], v59 offset:256
    ds_read_b128 v[148:151], v18 offset:4096
    v_lshl_add_u32 v9, v5, 9, v9
    v_lshl_add_u32 v9, v32, 4, v9
    v_mfma_f32_32x32x16_bf16 v[112:127], v[220:223], v[212:215], v[112:127]
    v_and_b32 v8, 0x80, v8
    v_cmp_ne_u32 vcc, 0, v8
    s_nop 1
    s_waitcnt lgkmcnt(6)
    v_mfma_f32_32x32x16_bf16 v[64:79], v[136:139], v[128:131], v[64:79]
    ds_read_b128 v[208:211], v19 offset:0
    ds_read_b64_tr_b16 v[216:217], v58 offset:4096
    v_cndmask_b32 v44, v34, v9, vcc
    v_mfma_f32_32x32x16_bf16 v[80:95], v[140:143], v[128:131], v[80:95]
    ds_read_b64_tr_b16 v[218:219], v58 offset:4352
    ds_read_b64_tr_b16 v[220:221], v59 offset:4096
    v_lshrrev_b64 v[8:9], v3, s[52:53]
    v_mfma_f32_32x32x16_bf16 v[96:111], v[136:139], v[132:135], v[96:111]
    ds_read_b64_tr_b16 v[222:223], v59 offset:4352
    ds_read_b128 v[212:215], v19 offset:4096
    v_and_b32 v9, 31, v8
    v_mul_u32_u24 v9, s65, v9
    v_mfma_f32_32x32x16_bf16 v[112:127], v[140:143], v[132:135], v[112:127]
    v_lshl_add_u32 v9, v32, 3, v9
    v_and_b32 v8, 0x80, v8
    v_cmp_ne_u32 vcc, 0, v8
    s_waitcnt lgkmcnt(6)
    v_mfma_f32_32x32x16_bf16 v[64:79], v[152:155], v[144:147], v[64:79]
    ds_read_b128 v[128:131], v20 offset:0
    ds_read_b64_tr_b16 v[136:137], v58 offset:8192
    s_nop 1
    v_mfma_f32_32x32x16_bf16 v[80:95], v[156:159], v[144:147], v[80:95]
    ds_read_b64_tr_b16 v[138:139], v58 offset:8448
    ds_read_b64_tr_b16 v[140:141], v59 offset:8192
    v_cndmask_b32 v48, v34, v9, vcc
    v_mfma_f32_32x32x16_bf16 v[96:111], v[152:155], v[148:151], v[96:111]
    ds_read_b64_tr_b16 v[142:143], v59 offset:8448
    ds_read_b128 v[132:135], v20 offset:4096
    v_add_u32 v3, 16, v33
    v_lshrrev_b64 v[8:9], v3, s[50:51]
    v_mfma_f32_32x32x16_bf16 v[112:127], v[156:159], v[148:151], v[112:127]
    v_and_b32 v9, 31, v8
    v_mul_u32_u24 v9, s64, v9
    v_bfe_u32 v5, v8, 5, 1
    s_waitcnt lgkmcnt(6)
    v_mfma_f32_32x32x16_bf16 v[64:79], v[216:219], v[208:211], v[64:79]
    ds_read_b128 v[144:147], v21 offset:0
    ds_read_b64_tr_b16 v[152:153], v58 offset:12288
    v_lshl_add_u32 v9, v5, 9, v9
    v_mfma_f32_32x32x16_bf16 v[80:95], v[220:223], v[208:211], v[80:95]
    ds_read_b64_tr_b16 v[154:155], v58 offset:12544
    ds_read_b64_tr_b16 v[156:157], v59 offset:12288
    v_lshl_add_u32 v9, v32, 4, v9
    v_mfma_f32_32x32x16_bf16 v[96:111], v[216:219], v[212:215], v[96:111]
    ds_read_b64_tr_b16 v[158:159], v59 offset:12544
    ds_read_b128 v[148:151], v21 offset:4096
    v_and_b32 v8, 0x80, v8
    v_cmp_ne_u32 vcc, 0, v8
    v_mfma_f32_32x32x16_bf16 v[112:127], v[220:223], v[212:215], v[112:127]
    s_nop 1
    v_cndmask_b32 v45, v34, v9, vcc
    v_lshrrev_b64 v[8:9], v3, s[52:53]
    s_barrier
    s_waitcnt lgkmcnt(6)
    v_mfma_f32_32x32x16_bf16 v[64:79], v[136:139], v[128:131], v[64:79]
    ds_read_b128 v[208:211], v10 offset:0
    ds_read_b64_tr_b16 v[216:217], v6 offset:0
    v_and_b32 v9, 31, v8
    v_mfma_f32_32x32x16_bf16 v[80:95], v[140:143], v[128:131], v[80:95]
    ds_read_b64_tr_b16 v[218:219], v6 offset:256
    ds_read_b64_tr_b16 v[220:221], v7 offset:0
    v_mul_u32_u24 v9, s65, v9
    v_mfma_f32_32x32x16_bf16 v[96:111], v[136:139], v[132:135], v[96:111]
    ds_read_b64_tr_b16 v[222:223], v7 offset:256
    ds_read_b128 v[212:215], v10 offset:4096
    v_lshl_add_u32 v9, v32, 3, v9
    v_and_b32 v8, 0x80, v8
    v_mfma_f32_32x32x16_bf16 v[112:127], v[140:143], v[132:135], v[112:127]
    v_cmp_ne_u32 vcc, 0, v8
    s_nop 1
    v_cndmask_b32 v49, v34, v9, vcc
    s_waitcnt lgkmcnt(6)
    v_mfma_f32_32x32x16_bf16 v[64:79], v[152:155], v[144:147], v[64:79]
    ds_read_b128 v[128:131], v11 offset:0
    ds_read_b64_tr_b16 v[136:137], v6 offset:4096
    v_add_u32 v3, 32, v33
    v_mfma_f32_32x32x16_bf16 v[80:95], v[156:159], v[144:147], v[80:95]
    ds_read_b64_tr_b16 v[138:139], v6 offset:4352
    ds_read_b64_tr_b16 v[140:141], v7 offset:4096
    v_lshrrev_b64 v[8:9], v3, s[50:51]
    v_mfma_f32_32x32x16_bf16 v[96:111], v[152:155], v[148:151], v[96:111]
    ds_read_b64_tr_b16 v[142:143], v7 offset:4352
    ds_read_b128 v[132:135], v11 offset:4096
    v_and_b32 v9, 31, v8
    v_mul_u32_u24 v9, s64, v9
    v_mfma_f32_32x32x16_bf16 v[112:127], v[156:159], v[148:151], v[112:127]
    v_bfe_u32 v5, v8, 5, 1
    v_lshl_add_u32 v9, v5, 9, v9
    v_lshl_add_u32 v9, v32, 4, v9
    s_waitcnt lgkmcnt(6)
    v_mfma_f32_32x32x16_bf16 v[64:79], v[216:219], v[208:211], v[64:79]
    ds_read_b128 v[144:147], v12 offset:0
    ds_read_b64_tr_b16 v[152:153], v6 offset:8192
    v_and_b32 v8, 0x80, v8
    v_mfma_f32_32x32x16_bf16 v[80:95], v[220:223], v[208:211], v[80:95]
    ds_read_b64_tr_b16 v[154:155], v6 offset:8448
    ds_read_b64_tr_b16 v[156:157], v7 offset:8192
    v_cmp_ne_u32 vcc, 0, v8
    v_mfma_f32_32x32x16_bf16 v[96:111], v[216:219], v[212:215], v[96:111]
    ds_read_b64_tr_b16 v[158:159], v7 offset:8448
    ds_read_b128 v[148:151], v12 offset:4096
    s_nop 1
    v_cndmask_b32 v46, v34, v9, vcc
    v_mfma_f32_32x32x16_bf16 v[112:127], v[220:223], v[212:215], v[112:127]
    v_lshrrev_b64 v[8:9], v3, s[52:53]
    v_and_b32 v9, 31, v8
    v_mul_u32_u24 v9, s65, v9
    s_waitcnt lgkmcnt(6)
    v_mfma_f32_32x32x16_bf16 v[64:79], v[136:139], v[128:131], v[64:79]
    ds_read_b128 v[208:211], v13 offset:0
    ds_read_b64_tr_b16 v[216:217], v6 offset:12288
    v_lshl_add_u32 v9, v32, 3, v9
    v_mfma_f32_32x32x16_bf16 v[80:95], v[140:143], v[128:131], v[80:95]
    ds_read_b64_tr_b16 v[218:219], v6 offset:12544
    ds_read_b64_tr_b16 v[220:221], v7 offset:12288
    v_and_b32 v8, 0x80, v8
    v_mfma_f32_32x32x16_bf16 v[96:111], v[136:139], v[132:135], v[96:111]
    ds_read_b64_tr_b16 v[222:223], v7 offset:12544
    ds_read_b128 v[212:215], v13 offset:4096
    v_cmp_ne_u32 vcc, 0, v8
    s_nop 1
    v_mfma_f32_32x32x16_bf16 v[112:127], v[140:143], v[132:135], v[112:127]
    v_cndmask_b32 v50, v34, v9, vcc
    v_add_u32 v3, 48, v33
    v_lshrrev_b64 v[8:9], v3, s[50:51]
    s_barrier
    s_waitcnt lgkmcnt(6)
    v_mfma_f32_32x32x16_bf16 v[64:79], v[152:155], v[144:147], v[64:79]
    ds_read_b128 v[128:131], v10 offset:32768
    ds_read_b64_tr_b16 v[136:137], v6 offset:32768
    v_and_b32 v9, 31, v8
    v_mfma_f32_32x32x16_bf16 v[80:95], v[156:159], v[144:147], v[80:95]
    ds_read_b64_tr_b16 v[138:139], v6 offset:33024
    ds_read_b64_tr_b16 v[140:141], v7 offset:32768
    v_mul_u32_u24 v9, s64, v9
    v_mfma_f32_32x32x16_bf16 v[96:111], v[152:155], v[148:151], v[96:111]
    ds_read_b64_tr_b16 v[142:143], v7 offset:33024
    ds_read_b128 v[132:135], v10 offset:36864
    v_bfe_u32 v5, v8, 5, 1
    v_lshl_add_u32 v9, v5, 9, v9
    v_mfma_f32_32x32x16_bf16 v[112:127], v[156:159], v[148:151], v[112:127]
    v_lshl_add_u32 v9, v32, 4, v9
    v_and_b32 v8, 0x80, v8
    v_cmp_ne_u32 vcc, 0, v8
    s_waitcnt lgkmcnt(6)
    v_mfma_f32_32x32x16_bf16 v[64:79], v[216:219], v[208:211], v[64:79]
    ds_read_b128 v[144:147], v11 offset:32768
    ds_read_b64_tr_b16 v[152:153], v6 offset:36864
    s_nop 1
    v_mfma_f32_32x32x16_bf16 v[80:95], v[220:223], v[208:211], v[80:95]
    ds_read_b64_tr_b16 v[154:155], v6 offset:37120
    ds_read_b64_tr_b16 v[156:157], v7 offset:36864
    v_cndmask_b32 v47, v34, v9, vcc
    v_mfma_f32_32x32x16_bf16 v[96:111], v[216:219], v[212:215], v[96:111]
    ds_read_b64_tr_b16 v[158:159], v7 offset:37120
    ds_read_b128 v[148:151], v11 offset:36864
    v_lshrrev_b64 v[8:9], v3, s[52:53]
    v_and_b32 v9, 31, v8
    v_mfma_f32_32x32x16_bf16 v[112:127], v[220:223], v[212:215], v[112:127]
    v_mul_u32_u24 v9, s65, v9
    v_lshl_add_u32 v9, v32, 3, v9
    v_and_b32 v8, 0x80, v8
    s_waitcnt lgkmcnt(6)
    v_mfma_f32_32x32x16_bf16 v[64:79], v[136:139], v[128:131], v[64:79]
    ds_read_b128 v[208:211], v12 offset:32768
    ds_read_b64_tr_b16 v[216:217], v6 offset:40960
    v_cmp_ne_u32 vcc, 0, v8
    v_mfma_f32_32x32x16_bf16 v[80:95], v[140:143], v[128:131], v[80:95]
    ds_read_b64_tr_b16 v[218:219], v6 offset:41216
    ds_read_b64_tr_b16 v[220:221], v7 offset:40960
    s_nop 1
    v_mfma_f32_32x32x16_bf16 v[96:111], v[136:139], v[132:135], v[96:111]
    ds_read_b64_tr_b16 v[222:223], v7 offset:41216
    ds_read_b128 v[212:215], v12 offset:36864
    v_cndmask_b32 v51, v34, v9, vcc
    v_bfe_u32 v35, v1, 2, 3
    v_mfma_f32_32x32x16_bf16 v[112:127], v[140:143], v[132:135], v[112:127]
    v_lshlrev_b32 v35, 3, v35
    v_and_b32 v36, 3, v1
    v_lshrrev_b32 v37, 5, v1
    s_waitcnt lgkmcnt(6)
    v_mfma_f32_32x32x16_bf16 v[64:79], v[152:155], v[144:147], v[64:79]
    ds_read_b128 v[128:131], v13 offset:32768
    ds_read_b64_tr_b16 v[136:137], v6 offset:45056
    v_lshlrev_b32 v37, 8, v37
    v_mfma_f32_32x32x16_bf16 v[80:95], v[156:159], v[144:147], v[80:95]
    ds_read_b64_tr_b16 v[138:139], v6 offset:45312
    ds_read_b64_tr_b16 v[140:141], v7 offset:45056
    v_add_u32 v36, v36, v37
    v_mfma_f32_32x32x16_bf16 v[96:111], v[152:155], v[148:151], v[96:111]
    ds_read_b64_tr_b16 v[142:143], v7 offset:45312
    ds_read_b128 v[132:135], v13 offset:36864
    v_lshrrev_b64 v[8:9], v35, s[46:47]
    v_and_b32 v8, 31, v8
    v_mfma_f32_32x32x16_bf16 v[112:127], v[156:159], v[148:151], v[112:127]
    v_lshl_add_u32 v8, v8, 2, v36
    v_lshlrev_b32 v38, 2, v8
    v_lshrrev_b64 v[8:9], v35, s[48:49]
    s_barrier
    s_waitcnt lgkmcnt(6)
    v_mfma_f32_32x32x16_bf16 v[64:79], v[216:219], v[208:211], v[64:79]
    ds_read_b128 v[144:147], v14 offset:0
    ds_read_b64_tr_b16 v[152:153], v56 offset:0
    v_and_b32 v8, 31, v8
    v_mfma_f32_32x32x16_bf16 v[80:95], v[220:223], v[208:211], v[80:95]
    ds_read_b64_tr_b16 v[154:155], v56 offset:256
    ds_read_b64_tr_b16 v[156:157], v57 offset:0
    v_lshl_add_u32 v8, v8, 2, v36
    v_mfma_f32_32x32x16_bf16 v[96:111], v[216:219], v[212:215], v[96:111]
    ds_read_b64_tr_b16 v[158:159], v57 offset:256
    ds_read_b128 v[148:151], v14 offset:4096
    v_lshlrev_b32 v39, 2, v8
    v_mov_b32 v226, 0
    v_mfma_f32_32x32x16_bf16 v[112:127], v[220:223], v[212:215], v[112:127]
    v_mov_b32 v227, 0
    v_mov_b32 v230, 0
    v_mov_b32 v231, 0
    s_waitcnt lgkmcnt(6)
    v_mfma_f32_32x32x16_bf16 v[64:79], v[136:139], v[128:131], v[64:79]
    ds_read_b128 v[208:211], v15 offset:0
    ds_read_b64_tr_b16 v[216:217], v56 offset:4096
    v_mov_b32 v234, 0
    v_mfma_f32_32x32x16_bf16 v[80:95], v[140:143], v[128:131], v[80:95]
    ds_read_b64_tr_b16 v[218:219], v56 offset:4352
    ds_read_b64_tr_b16 v[220:221], v57 offset:4096
    v_mov_b32 v235, 0
    v_mfma_f32_32x32x16_bf16 v[96:111], v[136:139], v[132:135], v[96:111]
    ds_read_b64_tr_b16 v[222:223], v57 offset:4352
    ds_read_b128 v[212:215], v15 offset:4096
    v_mov_b32 v238, 0
    v_mov_b32 v239, 0
    v_mfma_f32_32x32x16_bf16 v[112:127], v[140:143], v[132:135], v[112:127]
    s_waitcnt lgkmcnt(6)
    v_mfma_f32_32x32x16_bf16 v[64:79], v[152:155], v[144:147], v[64:79]
    ds_read_b128 v[128:131], v16 offset:0
    ds_read_b64_tr_b16 v[136:137], v56 offset:8192
    v_mfma_f32_32x32x16_bf16 v[80:95], v[156:159], v[144:147], v[80:95]
    ds_read_b64_tr_b16 v[138:139], v56 offset:8448
    ds_read_b64_tr_b16 v[140:141], v57 offset:8192
    v_mfma_f32_32x32x16_bf16 v[96:111], v[152:155], v[148:151], v[96:111]
    ds_read_b64_tr_b16 v[142:143], v57 offset:8448
    ds_read_b128 v[132:135], v16 offset:4096
    v_mfma_f32_32x32x16_bf16 v[112:127], v[156:159], v[148:151], v[112:127]
    s_waitcnt lgkmcnt(6)
    v_mfma_f32_32x32x16_bf16 v[64:79], v[216:219], v[208:211], v[64:79]
    ds_read_b128 v[144:147], v17 offset:0
    ds_read_b64_tr_b16 v[152:153], v56 offset:12288
    v_mfma_f32_32x32x16_bf16 v[80:95], v[220:223], v[208:211], v[80:95]
    ds_read_b64_tr_b16 v[154:155], v56 offset:12544
    ds_read_b64_tr_b16 v[156:157], v57 offset:12288
    v_mfma_f32_32x32x16_bf16 v[96:111], v[216:219], v[212:215], v[96:111]
    ds_read_b64_tr_b16 v[158:159], v57 offset:12544
    ds_read_b128 v[148:151], v17 offset:4096
    v_mfma_f32_32x32x16_bf16 v[112:127], v[220:223], v[212:215], v[112:127]
    s_barrier
    s_waitcnt lgkmcnt(6)
    v_mfma_f32_32x32x16_bf16 v[64:79], v[136:139], v[128:131], v[64:79]
    ds_read_b128 v[208:211], v14 offset:32768
    ds_read_b64_tr_b16 v[216:217], v56 offset:32768
    v_mfma_f32_32x32x16_bf16 v[80:95], v[140:143], v[128:131], v[80:95]
    ds_read_b64_tr_b16 v[218:219], v56 offset:33024
    ds_read_b64_tr_b16 v[220:221], v57 offset:32768
    v_mfma_f32_32x32x16_bf16 v[96:111], v[136:139], v[132:135], v[96:111]
    ds_read_b64_tr_b16 v[222:223], v57 offset:33024
    ds_read_b128 v[212:215], v14 offset:36864
    v_mfma_f32_32x32x16_bf16 v[112:127], v[140:143], v[132:135], v[112:127]
    s_waitcnt lgkmcnt(6)
    v_mfma_f32_32x32x16_bf16 v[64:79], v[152:155], v[144:147], v[64:79]
    ds_read_b128 v[128:131], v15 offset:32768
    ds_read_b64_tr_b16 v[136:137], v56 offset:36864
    v_mfma_f32_32x32x16_bf16 v[80:95], v[156:159], v[144:147], v[80:95]
    ds_read_b64_tr_b16 v[138:139], v56 offset:37120
    ds_read_b64_tr_b16 v[140:141], v57 offset:36864
    v_mfma_f32_32x32x16_bf16 v[96:111], v[152:155], v[148:151], v[96:111]
    ds_read_b64_tr_b16 v[142:143], v57 offset:37120
    ds_read_b128 v[132:135], v15 offset:36864
    v_mfma_f32_32x32x16_bf16 v[112:127], v[156:159], v[148:151], v[112:127]
    buffer_load_dwordx4 v[24:27], v22, s[32:35], 0 offen sc1
    buffer_load_dwordx4 v[28:31], v22, s[32:35], 0 offen offset:512 sc1
    s_waitcnt lgkmcnt(6)
    v_mfma_f32_32x32x16_bf16 v[64:79], v[216:219], v[208:211], v[64:79]
    ds_read_b128 v[144:147], v16 offset:32768
    ds_read_b64_tr_b16 v[152:153], v56 offset:40960
    v_mfma_f32_32x32x16_bf16 v[80:95], v[220:223], v[208:211], v[80:95]
    ds_read_b64_tr_b16 v[154:155], v56 offset:41216
    ds_read_b64_tr_b16 v[156:157], v57 offset:40960
    v_mfma_f32_32x32x16_bf16 v[96:111], v[216:219], v[212:215], v[96:111]
    ds_read_b64_tr_b16 v[158:159], v57 offset:41216
    ds_read_b128 v[148:151], v16 offset:36864
    v_mfma_f32_32x32x16_bf16 v[112:127], v[220:223], v[212:215], v[112:127]
    s_waitcnt lgkmcnt(6)
    v_mfma_f32_32x32x16_bf16 v[64:79], v[136:139], v[128:131], v[64:79]
    ds_read_b128 v[208:211], v17 offset:32768
    ds_read_b64_tr_b16 v[216:217], v56 offset:45056
    v_mfma_f32_32x32x16_bf16 v[80:95], v[140:143], v[128:131], v[80:95]
    ds_read_b64_tr_b16 v[218:219], v56 offset:45312
    ds_read_b64_tr_b16 v[220:221], v57 offset:45056
    v_mfma_f32_32x32x16_bf16 v[96:111], v[136:139], v[132:135], v[96:111]
    ds_read_b64_tr_b16 v[222:223], v57 offset:45312
    ds_read_b128 v[212:215], v17 offset:36864
    v_mfma_f32_32x32x16_bf16 v[112:127], v[140:143], v[132:135], v[112:127]
    s_barrier
    s_waitcnt lgkmcnt(6)
    v_mfma_f32_32x32x16_bf16 v[64:79], v[152:155], v[144:147], v[64:79]
    ds_read_b128 v[128:131], v18 offset:0
    ds_read_b64_tr_b16 v[136:137], v58 offset:0
    v_mfma_f32_32x32x16_bf16 v[80:95], v[156:159], v[144:147], v[80:95]
    ds_read_b64_tr_b16 v[138:139], v58 offset:256
    ds_read_b64_tr_b16 v[140:141], v59 offset:0
    v_mfma_f32_32x32x16_bf16 v[96:111], v[152:155], v[148:151], v[96:111]
    ds_read_b64_tr_b16 v[142:143], v59 offset:256
    ds_read_b128 v[132:135], v18 offset:4096
    v_mfma_f32_32x32x16_bf16 v[112:127], v[156:159], v[148:151], v[112:127]
    s_waitcnt lgkmcnt(6)
    ds_read_b32 v40, v38
    ds_read_b32 v41, v38 offset:512
    ds_read_b32 v42, v39
    ds_read_b32 v43, v39 offset:512
    v_mfma_f32_32x32x16_bf16 v[64:79], v[216:219], v[208:211], v[64:79]
    ds_read_b128 v[144:147], v19 offset:0
    ds_read_b64_tr_b16 v[152:153], v58 offset:4096
    v_mfma_f32_32x32x16_bf16 v[80:95], v[220:223], v[208:211], v[80:95]
    ds_read_b64_tr_b16 v[154:155], v58 offset:4352
    ds_read_b64_tr_b16 v[156:157], v59 offset:4096
    v_mfma_f32_32x32x16_bf16 v[96:111], v[216:219], v[212:215], v[96:111]
    ds_read_b64_tr_b16 v[158:159], v59 offset:4352
    ds_read_b128 v[148:151], v19 offset:4096
    v_mfma_f32_32x32x16_bf16 v[112:127], v[220:223], v[212:215], v[112:127]
    s_waitcnt lgkmcnt(6)
    s_mov_b32 s99, 0x80000
    s_waitcnt vmcnt(0)
P1_cloopchk:
    v_xor_b32 v3, s36, v26
    v_xor_b32 v4, s37, v27
    v_xor_b32 v5, s36, v30
    v_xor_b32 v8, s37, v31
    v_or3_b32 v3, v3, v4, v5
    v_or_b32 v3, v3, v8
    v_cmp_ne_u32 vcc, 0, v3
    s_nop 1
    s_cbranch_vccnz P1_clooprty
P1_cloopok:
    v_mfma_f32_32x32x16_bf16 v[64:79], v[136:139], v[128:131], v[64:79]
    ds_read_b128 v[208:211], v20 offset:0
    ds_read_b64_tr_b16 v[216:217], v58 offset:8192
    v_cvt_pk_bf16_f32 v232, -v24, -v24
    v_and_b32 v5, 0xffff0000, v232
    v_sub_f32 v5, -v24, v5
    v_mfma_f32_32x32x16_bf16 v[80:95], v[140:143], v[128:131], v[80:95]
    ds_read_b64_tr_b16 v[218:219], v58 offset:8448
    ds_read_b64_tr_b16 v[220:221], v59 offset:8192
    v_cvt_pk_bf16_f32 v233, v5, 0
    v_cvt_pk_bf16_f32 v236, -v28, -v28
    v_and_b32 v5, 0xffff0000, v236
    v_mfma_f32_32x32x16_bf16 v[96:111], v[136:139], v[132:135], v[96:111]
    ds_read_b64_tr_b16 v[222:223], v59 offset:8448
    ds_read_b128 v[212:215], v20 offset:4096
    v_sub_f32 v5, -v28, v5
    v_cvt_pk_bf16_f32 v237, v5, 0
    v_mul_f32 v24, s68, v25
    v_mfma_f32_32x32x16_bf16 v[112:127], v[140:143], v[132:135], v[112:127]
    v_mul_f32 v25, s68, v25
    v_mul_f32 v28, s68, v29
    v_mul_f32 v29, s68, v29
    s_waitcnt lgkmcnt(6)
    v_mfma_f32_32x32x16_bf16 v[64:79], v[152:155], v[144:147], v[64:79]
    ds_read_b128 v[128:131], v21 offset:0
    ds_read_b64_tr_b16 v[136:137], v58 offset:12288
    v_add_f32 v40, v40, v41
    v_cvt_pk_bf16_f32 v225, v40, 0
    v_lshlrev_b32 v41, 16, v225
    v_mfma_f32_32x32x16_bf16 v[80:95], v[156:159], v[144:147], v[80:95]
    ds_read_b64_tr_b16 v[138:139], v58 offset:12544
    ds_read_b64_tr_b16 v[140:141], v59 offset:12288
    v_sub_f32 v41, v40, v41
    v_cvt_pk_bf16_f32 v224, v40, v41
    v_add_f32 v42, v42, v43
    v_mfma_f32_32x32x16_bf16 v[96:111], v[152:155], v[148:151], v[96:111]
    ds_read_b64_tr_b16 v[142:143], v59 offset:12544
    ds_read_b128 v[132:135], v21 offset:4096
    v_cvt_pk_bf16_f32 v229, v42, 0
    v_lshlrev_b32 v43, 16, v229
    v_sub_f32 v43, v42, v43
    v_mfma_f32_32x32x16_bf16 v[112:127], v[156:159], v[148:151], v[112:127]
    v_cvt_pk_bf16_f32 v228, v42, v43
    s_waitcnt lgkmcnt(6)
    v_mfma_f32_32x32x16_bf16 v[64:79], v[216:219], v[208:211], v[64:79]
    v_mfma_f32_32x32x16_bf16 v[80:95], v[220:223], v[208:211], v[80:95]
    v_mfma_f32_32x32x16_bf16 v[96:111], v[216:219], v[212:215], v[96:111]
    v_mfma_f32_32x32x16_bf16 v[112:127], v[220:223], v[212:215], v[112:127]
    s_waitcnt lgkmcnt(0)
    v_mfma_f32_32x32x16_bf16 v[64:79], v[136:139], v[128:131], v[64:79]
    v_mfma_f32_32x32x16_bf16 v[80:95], v[140:143], v[128:131], v[80:95]
    v_mfma_f32_32x32x16_bf16 v[96:111], v[136:139], v[132:135], v[96:111]
    v_mfma_f32_32x32x16_bf16 v[112:127], v[140:143], v[132:135], v[112:127]
    s_nop 0
    v_mfma_f32_32x32x16_bf16 v[64:79], v[224:227], v[232:235], v[64:79]
    v_mfma_f32_32x32x16_bf16 v[80:95], v[228:231], v[232:235], v[80:95]
    v_mfma_f32_32x32x16_bf16 v[96:111], v[224:227], v[236:239], v[96:111]
    v_mfma_f32_32x32x16_bf16 v[112:127], v[228:231], v[236:239], v[112:127]
    s_nop 7
    s_nop 1
    v_pk_mul_f32 v[64:65], v[64:65], v[24:25]
    v_pk_mul_f32 v[66:67], v[66:67], v[24:25]
    v_pk_mul_f32 v[68:69], v[68:69], v[24:25]
    v_pk_mul_f32 v[70:71], v[70:71], v[24:25]
    v_pk_mul_f32 v[72:73], v[72:73], v[24:25]
    v_pk_mul_f32 v[74:75], v[74:75], v[24:25]
    v_pk_mul_f32 v[76:77], v[76:77], v[24:25]
    v_pk_mul_f32 v[78:79], v[78:79], v[24:25]
    v_cvt_pk_bf16_f32 v192, v64, v65
    v_cvt_pk_bf16_f32 v193, v66, v67
    v_cvt_pk_bf16_f32 v194, v68, v69
    v_cvt_pk_bf16_f32 v195, v70, v71
    v_cvt_pk_bf16_f32 v196, v72, v73
    v_cvt_pk_bf16_f32 v197, v74, v75
    v_cvt_pk_bf16_f32 v198, v76, v77
    v_cvt_pk_bf16_f32 v199, v78, v79
    buffer_store_dwordx4 v[192:195], v44, s[32:35], s66 offen offset:0 sc1
    buffer_store_dwordx4 v[196:199], v45, s[32:35], s66 offen offset:0 sc1
    v_pk_mul_f32 v[80:81], v[80:81], v[24:25]
    v_pk_mul_f32 v[82:83], v[82:83], v[24:25]
    v_pk_mul_f32 v[84:85], v[84:85], v[24:25]
    v_pk_mul_f32 v[86:87], v[86:87], v[24:25]
    v_pk_mul_f32 v[88:89], v[88:89], v[24:25]
    v_pk_mul_f32 v[90:91], v[90:91], v[24:25]
    v_pk_mul_f32 v[92:93], v[92:93], v[24:25]
    v_pk_mul_f32 v[94:95], v[94:95], v[24:25]
    v_cvt_pk_bf16_f32 v200, v80, v81
    v_cvt_pk_bf16_f32 v201, v82, v83
    v_cvt_pk_bf16_f32 v202, v84, v85
    v_cvt_pk_bf16_f32 v203, v86, v87
    v_cvt_pk_bf16_f32 v204, v88, v89
    v_cvt_pk_bf16_f32 v205, v90, v91
    v_cvt_pk_bf16_f32 v206, v92, v93
    v_cvt_pk_bf16_f32 v207, v94, v95
    buffer_store_dwordx4 v[200:203], v46, s[32:35], s66 offen offset:0 sc1
    buffer_store_dwordx4 v[204:207], v47, s[32:35], s66 offen offset:0 sc1
    s_cmp_eq_u32 s43, 0
    s_cbranch_scc1 L_notail_1
    buffer_store_dwordx2 v[200:201], v48, s[32:35], s67 offen offset:0 sc1
    buffer_store_dwordx2 v[202:203], v49, s[32:35], s67 offen offset:0 sc1
    buffer_store_dwordx2 v[204:205], v50, s[32:35], s67 offen offset:0 sc1
    buffer_store_dwordx2 v[206:207], v51, s[32:35], s67 offen offset:0 sc1
L_notail_1:
    v_pk_mul_f32 v[96:97], v[96:97], v[28:29]
    v_pk_mul_f32 v[98:99], v[98:99], v[28:29]
    v_pk_mul_f32 v[100:101], v[100:101], v[28:29]
    v_pk_mul_f32 v[102:103], v[102:103], v[28:29]
    v_pk_mul_f32 v[104:105], v[104:105], v[28:29]
    v_pk_mul_f32 v[106:107], v[106:107], v[28:29]
    v_pk_mul_f32 v[108:109], v[108:109], v[28:29]
    v_pk_mul_f32 v[110:111], v[110:111], v[28:29]
    v_cvt_pk_bf16_f32 v208, v96, v97
    v_cvt_pk_bf16_f32 v209, v98, v99
    v_cvt_pk_bf16_f32 v210, v100, v101
    v_cvt_pk_bf16_f32 v211, v102, v103
    v_cvt_pk_bf16_f32 v212, v104, v105
    v_cvt_pk_bf16_f32 v213, v106, v107
    v_cvt_pk_bf16_f32 v214, v108, v109
    v_cvt_pk_bf16_f32 v215, v110, v111
    buffer_store_dwordx4 v[208:211], v44, s[32:35], s66 offen offset:1024 sc1
    buffer_store_dwordx4 v[212:215], v45, s[32:35], s66 offen offset:1024 sc1
    v_pk_mul_f32 v[112:113], v[112:113], v[28:29]
    v_pk_mul_f32 v[114:115], v[114:115], v[28:29]
    v_pk_mul_f32 v[116:117], v[116:117], v[28:29]
    v_pk_mul_f32 v[118:119], v[118:119], v[28:29]
    v_pk_mul_f32 v[120:121], v[120:121], v[28:29]
    v_pk_mul_f32 v[122:123], v[122:123], v[28:29]
    v_pk_mul_f32 v[124:125], v[124:125], v[28:29]
    v_pk_mul_f32 v[126:127], v[126:127], v[28:29]
    v_cvt_pk_bf16_f32 v216, v112, v113
    v_cvt_pk_bf16_f32 v217, v114, v115
    v_cvt_pk_bf16_f32 v218, v116, v117
    v_cvt_pk_bf16_f32 v219, v118, v119
    v_cvt_pk_bf16_f32 v220, v120, v121
    v_cvt_pk_bf16_f32 v221, v122, v123
    v_cvt_pk_bf16_f32 v222, v124, v125
    v_cvt_pk_bf16_f32 v223, v126, v127
    buffer_store_dwordx4 v[216:219], v46, s[32:35], s66 offen offset:1024 sc1
    buffer_store_dwordx4 v[220:223], v47, s[32:35], s66 offen offset:1024 sc1
    s_cmp_eq_u32 s43, 0
    s_cbranch_scc1 L_notail_2
    buffer_store_dwordx2 v[216:217], v48, s[32:35], s67 offen offset:256 sc1
    buffer_store_dwordx2 v[218:219], v49, s[32:35], s67 offen offset:256 sc1
    buffer_store_dwordx2 v[220:221], v50, s[32:35], s67 offen offset:256 sc1
    buffer_store_dwordx2 v[222:223], v51, s[32:35], s67 offen offset:256 sc1
L_notail_2:
    s_branch P1_done
P1_clooprty:
    buffer_load_dwordx4 v[24:27], v22, s[32:35], 0 offen sc1
    buffer_load_dwordx4 v[28:31], v22, s[32:35], 0 offen offset:512 sc1
    s_waitcnt vmcnt(0)
    s_sub_u32 s99, s99, 1
    s_cbranch_scc0 P1_cloopchk
    s_branch P1_cloopok
P1_cloopv:
    s_waitcnt lgkmcnt(6)
    v_mfma_f32_32x32x16_bf16 v[64:79], v[128:131], v[136:139], 0
    ds_read_b128 v[208:211], v12 offset:0
    ds_read_b64_tr_b16 v[216:217], v6 offset:8192
    v_add_u32 v14, 65536, v10
    v_mfma_f32_32x32x16_bf16 v[80:95], v[128:131], v[140:143], 0
    ds_read_b64_tr_b16 v[218:219], v6 offset:8448
    ds_read_b64_tr_b16 v[220:221], v7 offset:8192
    v_add_u32 v18, 65536, v14
    v_mfma_f32_32x32x16_bf16 v[96:111], v[132:135], v[136:139], 0
    ds_read_b64_tr_b16 v[222:223], v7 offset:8448
    ds_read_b128 v[212:215], v12 offset:4096
    v_add_u32 v15, 65536, v11
    v_add_u32 v19, 65536, v15
    v_mfma_f32_32x32x16_bf16 v[112:127], v[132:135], v[140:143], 0
    v_add_u32 v16, 65536, v12
    v_add_u32 v20, 65536, v16
    v_add_u32 v17, 65536, v13
    s_waitcnt lgkmcnt(6)
    v_mfma_f32_32x32x16_bf16 v[64:79], v[144:147], v[152:155], v[64:79]
    ds_read_b128 v[128:131], v13 offset:0
    ds_read_b64_tr_b16 v[136:137], v6 offset:12288
    v_add_u32 v21, 65536, v17
    v_mfma_f32_32x32x16_bf16 v[80:95], v[144:147], v[156:159], v[80:95]
    ds_read_b64_tr_b16 v[138:139], v6 offset:12544
    ds_read_b64_tr_b16 v[140:141], v7 offset:12288
    v_add_u32 v56, 65536, v6
    v_mfma_f32_32x32x16_bf16 v[96:111], v[148:151], v[152:155], v[96:111]
    ds_read_b64_tr_b16 v[142:143], v7 offset:12544
    ds_read_b128 v[132:135], v13 offset:4096
    v_add_u32 v58, 65536, v56
    v_add_u32 v57, 65536, v7
    v_mfma_f32_32x32x16_bf16 v[112:127], v[148:151], v[156:159], v[112:127]
    v_add_u32 v59, 65536, v57
    s_lshl_b32 s54, s38, 7
    s_lshl_b32 s55, s42, 6
    s_barrier
    s_waitcnt lgkmcnt(6)
    v_mfma_f32_32x32x16_bf16 v[64:79], v[208:211], v[216:219], v[64:79]
    ds_read_b128 v[144:147], v10 offset:32768
    ds_read_b64_tr_b16 v[152:153], v6 offset:32768
    s_add_u32 s54, s54, s55
    v_mfma_f32_32x32x16_bf16 v[80:95], v[208:211], v[220:223], v[80:95]
    ds_read_b64_tr_b16 v[154:155], v6 offset:33024
    ds_read_b64_tr_b16 v[156:157], v7 offset:32768
    v_add_u32 v22, s54, v2
    v_mfma_f32_32x32x16_bf16 v[96:111], v[212:215], v[216:219], v[96:111]
    ds_read_b64_tr_b16 v[158:159], v7 offset:33024
    ds_read_b128 v[148:151], v10 offset:36864
    v_lshlrev_b32 v22, 4, v22
    v_add_u32 v22, 0x1000, v22
    v_mfma_f32_32x32x16_bf16 v[112:127], v[212:215], v[220:223], v[112:127]
    s_lshl_b32 s54, s40, 7
    s_lshl_b32 s55, s43, 6
    s_add_u32 s54, s54, s55
    s_waitcnt lgkmcnt(6)
    v_mfma_f32_32x32x16_bf16 v[64:79], v[128:131], v[136:139], v[64:79]
    ds_read_b128 v[208:211], v11 offset:32768
    ds_read_b64_tr_b16 v[216:217], v6 offset:36864
    s_mul_i32 s66, s69, 10240
    v_mfma_f32_32x32x16_bf16 v[80:95], v[128:131], v[140:143], v[80:95]
    ds_read_b64_tr_b16 v[218:219], v6 offset:37120
    ds_read_b64_tr_b16 v[220:221], v7 offset:36864
    s_mul_i32 s55, s42, 2560
    v_mfma_f32_32x32x16_bf16 v[96:111], v[132:135], v[136:139], v[96:111]
    ds_read_b64_tr_b16 v[222:223], v7 offset:37120
    ds_read_b128 v[212:215], v11 offset:36864
    s_add_u32 s66, s66, s55
    s_add_u32 s66, s66, 0x401400
    v_mfma_f32_32x32x16_bf16 v[112:127], v[132:135], v[140:143], v[112:127]
    s_mov_b32 s64, 163840
    s_movk_i32 s56, 3277
    v_mul_u32_u24 v5, 320, v4
    s_waitcnt lgkmcnt(6)
    v_mfma_f32_32x32x16_bf16 v[64:79], v[144:147], v[152:155], v[64:79]
    ds_read_b128 v[128:131], v12 offset:32768
    ds_read_b64_tr_b16 v[136:137], v6 offset:40960
    v_add3_u32 v3, v2, s54, 0
    v_mfma_f32_32x32x16_bf16 v[80:95], v[144:147], v[156:159], v[80:95]
    ds_read_b64_tr_b16 v[138:139], v6 offset:41216
    ds_read_b64_tr_b16 v[140:141], v7 offset:40960
    v_mul_u32_u24 v8, s56, v3
    v_mfma_f32_32x32x16_bf16 v[96:111], v[148:151], v[152:155], v[96:111]
    ds_read_b64_tr_b16 v[142:143], v7 offset:41216
    ds_read_b128 v[132:135], v12 offset:36864
    v_lshrrev_b32 v8, 16, v8
    v_mul_u32_u24 v9, 20, v8
    v_mfma_f32_32x32x16_bf16 v[112:127], v[148:151], v[156:159], v[112:127]
    v_sub_u32 v9, v3, v9
    v_mul_u32_u24 v8, s64, v8
    v_lshl_add_u32 v8, v9, 4, v8
    s_waitcnt lgkmcnt(6)
    v_mfma_f32_32x32x16_bf16 v[64:79], v[208:211], v[216:219], v[64:79]
    ds_read_b128 v[144:147], v13 offset:32768
    ds_read_b64_tr_b16 v[152:153], v6 offset:45056
    v_add_u32 v44, v8, v5
    v_mfma_f32_32x32x16_bf16 v[80:95], v[208:211], v[220:223], v[80:95]
    ds_read_b64_tr_b16 v[154:155], v6 offset:45312
    ds_read_b64_tr_b16 v[156:157], v7 offset:45056
    v_add3_u32 v3, v2, s54, 32
    v_mfma_f32_32x32x16_bf16 v[96:111], v[212:215], v[216:219], v[96:111]
    ds_read_b64_tr_b16 v[158:159], v7 offset:45312
    ds_read_b128 v[148:151], v13 offset:36864
    v_mul_u32_u24 v8, s56, v3
    v_lshrrev_b32 v8, 16, v8
    v_mfma_f32_32x32x16_bf16 v[112:127], v[212:215], v[220:223], v[112:127]
    v_mul_u32_u24 v9, 20, v8
    v_sub_u32 v9, v3, v9
    v_mul_u32_u24 v8, s64, v8
    s_barrier
    s_waitcnt lgkmcnt(6)
    v_mfma_f32_32x32x16_bf16 v[64:79], v[128:131], v[136:139], v[64:79]
    ds_read_b128 v[208:211], v14 offset:0
    ds_read_b64_tr_b16 v[216:217], v56 offset:0
    v_lshl_add_u32 v8, v9, 4, v8
    v_mfma_f32_32x32x16_bf16 v[80:95], v[128:131], v[140:143], v[80:95]
    ds_read_b64_tr_b16 v[218:219], v56 offset:256
    ds_read_b64_tr_b16 v[220:221], v57 offset:0
    v_add_u32 v45, v8, v5
    v_mfma_f32_32x32x16_bf16 v[96:111], v[132:135], v[136:139], v[96:111]
    ds_read_b64_tr_b16 v[222:223], v57 offset:256
    ds_read_b128 v[212:215], v14 offset:4096
    v_mov_b32 v46, 0x40000000
    v_mov_b32 v47, 0x40000000
    v_mfma_f32_32x32x16_bf16 v[112:127], v[132:135], v[140:143], v[112:127]
    v_mov_b32 v48, 0x40000000
    v_mov_b32 v49, 0x40000000
    v_mov_b32 v50, 0x40000000
    s_waitcnt lgkmcnt(6)
    v_mfma_f32_32x32x16_bf16 v[64:79], v[144:147], v[152:155], v[64:79]
    ds_read_b128 v[128:131], v15 offset:0
    ds_read_b64_tr_b16 v[136:137], v56 offset:4096
    v_mov_b32 v51, 0x40000000
    v_mfma_f32_32x32x16_bf16 v[80:95], v[144:147], v[156:159], v[80:95]
    ds_read_b64_tr_b16 v[138:139], v56 offset:4352
    ds_read_b64_tr_b16 v[140:141], v57 offset:4096
    v_bfe_u32 v35, v1, 2, 3
    v_mfma_f32_32x32x16_bf16 v[96:111], v[148:151], v[152:155], v[96:111]
    ds_read_b64_tr_b16 v[142:143], v57 offset:4352
    ds_read_b128 v[132:135], v15 offset:4096
    v_lshlrev_b32 v35, 3, v35
    v_and_b32 v36, 3, v1
    v_mfma_f32_32x32x16_bf16 v[112:127], v[148:151], v[156:159], v[112:127]
    v_lshrrev_b32 v37, 5, v1
    v_lshlrev_b32 v37, 8, v37
    v_add_u32 v36, v36, v37
    s_waitcnt lgkmcnt(6)
    v_mfma_f32_32x32x16_bf16 v[64:79], v[208:211], v[216:219], v[64:79]
    ds_read_b128 v[144:147], v16 offset:0
    ds_read_b64_tr_b16 v[152:153], v56 offset:8192
    v_lshrrev_b64 v[8:9], v35, s[46:47]
    v_mfma_f32_32x32x16_bf16 v[80:95], v[208:211], v[220:223], v[80:95]
    ds_read_b64_tr_b16 v[154:155], v56 offset:8448
    ds_read_b64_tr_b16 v[156:157], v57 offset:8192
    v_and_b32 v8, 31, v8
    v_mfma_f32_32x32x16_bf16 v[96:111], v[212:215], v[216:219], v[96:111]
    ds_read_b64_tr_b16 v[158:159], v57 offset:8448
    ds_read_b128 v[148:151], v16 offset:4096
    v_lshl_add_u32 v8, v8, 2, v36
    v_lshlrev_b32 v38, 2, v8
    v_mfma_f32_32x32x16_bf16 v[112:127], v[212:215], v[220:223], v[112:127]
    v_lshrrev_b64 v[8:9], v35, s[48:49]
    v_and_b32 v8, 31, v8
    v_lshl_add_u32 v8, v8, 2, v36
    s_waitcnt lgkmcnt(6)
    v_mfma_f32_32x32x16_bf16 v[64:79], v[128:131], v[136:139], v[64:79]
    ds_read_b128 v[208:211], v17 offset:0
    ds_read_b64_tr_b16 v[216:217], v56 offset:12288
    v_lshlrev_b32 v39, 2, v8
    v_mfma_f32_32x32x16_bf16 v[80:95], v[128:131], v[140:143], v[80:95]
    ds_read_b64_tr_b16 v[218:219], v56 offset:12544
    ds_read_b64_tr_b16 v[220:221], v57 offset:12288
    v_mov_b32 v226, 0
    v_mfma_f32_32x32x16_bf16 v[96:111], v[132:135], v[136:139], v[96:111]
    ds_read_b64_tr_b16 v[222:223], v57 offset:12544
    ds_read_b128 v[212:215], v17 offset:4096
    v_mov_b32 v227, 0
    v_mov_b32 v230, 0
    v_mfma_f32_32x32x16_bf16 v[112:127], v[132:135], v[140:143], v[112:127]
    v_mov_b32 v231, 0
    v_mov_b32 v234, 0
    v_mov_b32 v235, 0
    s_barrier
    s_waitcnt lgkmcnt(6)
    v_mfma_f32_32x32x16_bf16 v[64:79], v[144:147], v[152:155], v[64:79]
    ds_read_b128 v[128:131], v14 offset:32768
    ds_read_b64_tr_b16 v[136:137], v56 offset:32768
    v_mov_b32 v238, 0
    v_mfma_f32_32x32x16_bf16 v[80:95], v[144:147], v[156:159], v[80:95]
    ds_read_b64_tr_b16 v[138:139], v56 offset:33024
    ds_read_b64_tr_b16 v[140:141], v57 offset:32768
    v_mov_b32 v239, 0
    v_mfma_f32_32x32x16_bf16 v[96:111], v[148:151], v[152:155], v[96:111]
    ds_read_b64_tr_b16 v[142:143], v57 offset:33024
    ds_read_b128 v[132:135], v14 offset:36864
    v_mfma_f32_32x32x16_bf16 v[112:127], v[148:151], v[156:159], v[112:127]
    s_waitcnt lgkmcnt(6)
    v_mfma_f32_32x32x16_bf16 v[64:79], v[208:211], v[216:219], v[64:79]
    ds_read_b128 v[144:147], v15 offset:32768
    ds_read_b64_tr_b16 v[152:153], v56 offset:36864
    v_mfma_f32_32x32x16_bf16 v[80:95], v[208:211], v[220:223], v[80:95]
    ds_read_b64_tr_b16 v[154:155], v56 offset:37120
    ds_read_b64_tr_b16 v[156:157], v57 offset:36864
    v_mfma_f32_32x32x16_bf16 v[96:111], v[212:215], v[216:219], v[96:111]
    ds_read_b64_tr_b16 v[158:159], v57 offset:37120
    ds_read_b128 v[148:151], v15 offset:36864
    v_mfma_f32_32x32x16_bf16 v[112:127], v[212:215], v[220:223], v[112:127]
    s_waitcnt lgkmcnt(6)
    v_mfma_f32_32x32x16_bf16 v[64:79], v[128:131], v[136:139], v[64:79]
    ds_read_b128 v[208:211], v16 offset:32768
    ds_read_b64_tr_b16 v[216:217], v56 offset:40960
    v_mfma_f32_32x32x16_bf16 v[80:95], v[128:131], v[140:143], v[80:95]
    ds_read_b64_tr_b16 v[218:219], v56 offset:41216
    ds_read_b64_tr_b16 v[220:221], v57 offset:40960
    v_mfma_f32_32x32x16_bf16 v[96:111], v[132:135], v[136:139], v[96:111]
    ds_read_b64_tr_b16 v[222:223], v57 offset:41216
    ds_read_b128 v[212:215], v16 offset:36864
    v_mfma_f32_32x32x16_bf16 v[112:127], v[132:135], v[140:143], v[112:127]
    s_waitcnt lgkmcnt(6)
    v_mfma_f32_32x32x16_bf16 v[64:79], v[144:147], v[152:155], v[64:79]
    ds_read_b128 v[128:131], v17 offset:32768
    ds_read_b64_tr_b16 v[136:137], v56 offset:45056
    v_mfma_f32_32x32x16_bf16 v[80:95], v[144:147], v[156:159], v[80:95]
    ds_read_b64_tr_b16 v[138:139], v56 offset:45312
    ds_read_b64_tr_b16 v[140:141], v57 offset:45056
    v_mfma_f32_32x32x16_bf16 v[96:111], v[148:151], v[152:155], v[96:111]
    ds_read_b64_tr_b16 v[142:143], v57 offset:45312
    ds_read_b128 v[132:135], v17 offset:36864
    v_mfma_f32_32x32x16_bf16 v[112:127], v[148:151], v[156:159], v[112:127]
    s_barrier
    s_waitcnt lgkmcnt(6)
    v_mfma_f32_32x32x16_bf16 v[64:79], v[208:211], v[216:219], v[64:79]
    ds_read_b128 v[144:147], v18 offset:0
    ds_read_b64_tr_b16 v[152:153], v58 offset:0
    v_mfma_f32_32x32x16_bf16 v[80:95], v[208:211], v[220:223], v[80:95]
    ds_read_b64_tr_b16 v[154:155], v58 offset:256
    ds_read_b64_tr_b16 v[156:157], v59 offset:0
    v_mfma_f32_32x32x16_bf16 v[96:111], v[212:215], v[216:219], v[96:111]
    ds_read_b64_tr_b16 v[158:159], v59 offset:256
    ds_read_b128 v[148:151], v18 offset:4096
    v_mfma_f32_32x32x16_bf16 v[112:127], v[212:215], v[220:223], v[112:127]
    s_waitcnt lgkmcnt(6)
    v_mfma_f32_32x32x16_bf16 v[64:79], v[128:131], v[136:139], v[64:79]
    ds_read_b128 v[208:211], v19 offset:0
    ds_read_b64_tr_b16 v[216:217], v58 offset:4096
    v_mfma_f32_32x32x16_bf16 v[80:95], v[128:131], v[140:143], v[80:95]
    ds_read_b64_tr_b16 v[218:219], v58 offset:4352
    ds_read_b64_tr_b16 v[220:221], v59 offset:4096
    v_mfma_f32_32x32x16_bf16 v[96:111], v[132:135], v[136:139], v[96:111]
    ds_read_b64_tr_b16 v[222:223], v59 offset:4352
    ds_read_b128 v[212:215], v19 offset:4096
    v_mfma_f32_32x32x16_bf16 v[112:127], v[132:135], v[140:143], v[112:127]
    s_waitcnt lgkmcnt(6)
    v_mfma_f32_32x32x16_bf16 v[64:79], v[144:147], v[152:155], v[64:79]
    ds_read_b128 v[128:131], v20 offset:0
    ds_read_b64_tr_b16 v[136:137], v58 offset:8192
    v_mfma_f32_32x32x16_bf16 v[80:95], v[144:147], v[156:159], v[80:95]
    ds_read_b64_tr_b16 v[138:139], v58 offset:8448
    ds_read_b64_tr_b16 v[140:141], v59 offset:8192
    v_mfma_f32_32x32x16_bf16 v[96:111], v[148:151], v[152:155], v[96:111]
    ds_read_b64_tr_b16 v[142:143], v59 offset:8448
    ds_read_b128 v[132:135], v20 offset:4096
    v_mfma_f32_32x32x16_bf16 v[112:127], v[148:151], v[156:159], v[112:127]
    s_waitcnt lgkmcnt(6)
    v_mfma_f32_32x32x16_bf16 v[64:79], v[208:211], v[216:219], v[64:79]
    ds_read_b128 v[144:147], v21 offset:0
    ds_read_b64_tr_b16 v[152:153], v58 offset:12288
    v_mfma_f32_32x32x16_bf16 v[80:95], v[208:211], v[220:223], v[80:95]
    ds_read_b64_tr_b16 v[154:155], v58 offset:12544
    ds_read_b64_tr_b16 v[156:157], v59 offset:12288
    v_mfma_f32_32x32x16_bf16 v[96:111], v[212:215], v[216:219], v[96:111]
    ds_read_b64_tr_b16 v[158:159], v59 offset:12544
    ds_read_b128 v[148:151], v21 offset:4096
    v_mfma_f32_32x32x16_bf16 v[112:127], v[212:215], v[220:223], v[112:127]
    s_barrier
    s_waitcnt lgkmcnt(6)
    v_mfma_f32_32x32x16_bf16 v[64:79], v[128:131], v[136:139], v[64:79]
    ds_read_b128 v[208:211], v10 offset:0
    ds_read_b64_tr_b16 v[216:217], v6 offset:0
    v_mfma_f32_32x32x16_bf16 v[80:95], v[128:131], v[140:143], v[80:95]
    ds_read_b64_tr_b16 v[218:219], v6 offset:256
    ds_read_b64_tr_b16 v[220:221], v7 offset:0
    v_mfma_f32_32x32x16_bf16 v[96:111], v[132:135], v[136:139], v[96:111]
    ds_read_b64_tr_b16 v[222:223], v7 offset:256
    ds_read_b128 v[212:215], v10 offset:4096
    v_mfma_f32_32x32x16_bf16 v[112:127], v[132:135], v[140:143], v[112:127]
    s_waitcnt lgkmcnt(6)
    v_mfma_f32_32x32x16_bf16 v[64:79], v[144:147], v[152:155], v[64:79]
    ds_read_b128 v[128:131], v11 offset:0
    ds_read_b64_tr_b16 v[136:137], v6 offset:4096
    v_mfma_f32_32x32x16_bf16 v[80:95], v[144:147], v[156:159], v[80:95]
    ds_read_b64_tr_b16 v[138:139], v6 offset:4352
    ds_read_b64_tr_b16 v[140:141], v7 offset:4096
    v_mfma_f32_32x32x16_bf16 v[96:111], v[148:151], v[152:155], v[96:111]
    ds_read_b64_tr_b16 v[142:143], v7 offset:4352
    ds_read_b128 v[132:135], v11 offset:4096
    v_mfma_f32_32x32x16_bf16 v[112:127], v[148:151], v[156:159], v[112:127]
    s_waitcnt lgkmcnt(6)
    v_mfma_f32_32x32x16_bf16 v[64:79], v[208:211], v[216:219], v[64:79]
    ds_read_b128 v[144:147], v12 offset:0
    ds_read_b64_tr_b16 v[152:153], v6 offset:8192
    v_mfma_f32_32x32x16_bf16 v[80:95], v[208:211], v[220:223], v[80:95]
    ds_read_b64_tr_b16 v[154:155], v6 offset:8448
    ds_read_b64_tr_b16 v[156:157], v7 offset:8192
    v_mfma_f32_32x32x16_bf16 v[96:111], v[212:215], v[216:219], v[96:111]
    ds_read_b64_tr_b16 v[158:159], v7 offset:8448
    ds_read_b128 v[148:151], v12 offset:4096
    v_mfma_f32_32x32x16_bf16 v[112:127], v[212:215], v[220:223], v[112:127]
    s_waitcnt lgkmcnt(6)
    v_mfma_f32_32x32x16_bf16 v[64:79], v[128:131], v[136:139], v[64:79]
    ds_read_b128 v[208:211], v13 offset:0
    ds_read_b64_tr_b16 v[216:217], v6 offset:12288
    v_mfma_f32_32x32x16_bf16 v[80:95], v[128:131], v[140:143], v[80:95]
    ds_read_b64_tr_b16 v[218:219], v6 offset:12544
    ds_read_b64_tr_b16 v[220:221], v7 offset:12288
    v_mfma_f32_32x32x16_bf16 v[96:111], v[132:135], v[136:139], v[96:111]
    ds_read_b64_tr_b16 v[222:223], v7 offset:12544
    ds_read_b128 v[212:215], v13 offset:4096
    v_mfma_f32_32x32x16_bf16 v[112:127], v[132:135], v[140:143], v[112:127]
    s_barrier
    s_waitcnt lgkmcnt(6)
    v_mfma_f32_32x32x16_bf16 v[64:79], v[144:147], v[152:155], v[64:79]
    ds_read_b128 v[128:131], v10 offset:32768
    ds_read_b64_tr_b16 v[136:137], v6 offset:32768
    v_mfma_f32_32x32x16_bf16 v[80:95], v[144:147], v[156:159], v[80:95]
    ds_read_b64_tr_b16 v[138:139], v6 offset:33024
    ds_read_b64_tr_b16 v[140:141], v7 offset:32768
    v_mfma_f32_32x32x16_bf16 v[96:111], v[148:151], v[152:155], v[96:111]
    ds_read_b64_tr_b16 v[142:143], v7 offset:33024
    ds_read_b128 v[132:135], v10 offset:36864
    v_mfma_f32_32x32x16_bf16 v[112:127], v[148:151], v[156:159], v[112:127]
    s_waitcnt lgkmcnt(6)
    v_mfma_f32_32x32x16_bf16 v[64:79], v[208:211], v[216:219], v[64:79]
    ds_read_b128 v[144:147], v11 offset:32768
    ds_read_b64_tr_b16 v[152:153], v6 offset:36864
    v_mfma_f32_32x32x16_bf16 v[80:95], v[208:211], v[220:223], v[80:95]
    ds_read_b64_tr_b16 v[154:155], v6 offset:37120
    ds_read_b64_tr_b16 v[156:157], v7 offset:36864
    v_mfma_f32_32x32x16_bf16 v[96:111], v[212:215], v[216:219], v[96:111]
    ds_read_b64_tr_b16 v[158:159], v7 offset:37120
    ds_read_b128 v[148:151], v11 offset:36864
    v_mfma_f32_32x32x16_bf16 v[112:127], v[212:215], v[220:223], v[112:127]
    s_waitcnt lgkmcnt(6)
    v_mfma_f32_32x32x16_bf16 v[64:79], v[128:131], v[136:139], v[64:79]
    ds_read_b128 v[208:211], v12 offset:32768
    ds_read_b64_tr_b16 v[216:217], v6 offset:40960
    v_mfma_f32_32x32x16_bf16 v[80:95], v[128:131], v[140:143], v[80:95]
    ds_read_b64_tr_b16 v[218:219], v6 offset:41216
    ds_read_b64_tr_b16 v[220:221], v7 offset:40960
    v_mfma_f32_32x32x16_bf16 v[96:111], v[132:135], v[136:139], v[96:111]
    ds_read_b64_tr_b16 v[222:223], v7 offset:41216
    ds_read_b128 v[212:215], v12 offset:36864
    v_mfma_f32_32x32x16_bf16 v[112:127], v[132:135], v[140:143], v[112:127]
    s_waitcnt lgkmcnt(6)
    v_mfma_f32_32x32x16_bf16 v[64:79], v[144:147], v[152:155], v[64:79]
    ds_read_b128 v[128:131], v13 offset:32768
    ds_read_b64_tr_b16 v[136:137], v6 offset:45056
    v_mfma_f32_32x32x16_bf16 v[80:95], v[144:147], v[156:159], v[80:95]
    ds_read_b64_tr_b16 v[138:139], v6 offset:45312
    ds_read_b64_tr_b16 v[140:141], v7 offset:45056
    v_mfma_f32_32x32x16_bf16 v[96:111], v[148:151], v[152:155], v[96:111]
    ds_read_b64_tr_b16 v[142:143], v7 offset:45312
    ds_read_b128 v[132:135], v13 offset:36864
    v_mfma_f32_32x32x16_bf16 v[112:127], v[148:151], v[156:159], v[112:127]
    s_barrier
    s_waitcnt lgkmcnt(6)
    v_mfma_f32_32x32x16_bf16 v[64:79], v[208:211], v[216:219], v[64:79]
    ds_read_b128 v[144:147], v14 offset:0
    ds_read_b64_tr_b16 v[152:153], v56 offset:0
    v_mfma_f32_32x32x16_bf16 v[80:95], v[208:211], v[220:223], v[80:95]
    ds_read_b64_tr_b16 v[154:155], v56 offset:256
    ds_read_b64_tr_b16 v[156:157], v57 offset:0
    v_mfma_f32_32x32x16_bf16 v[96:111], v[212:215], v[216:219], v[96:111]
    ds_read_b64_tr_b16 v[158:159], v57 offset:256
    ds_read_b128 v[148:151], v14 offset:4096
    v_mfma_f32_32x32x16_bf16 v[112:127], v[212:215], v[220:223], v[112:127]
    s_waitcnt lgkmcnt(6)
    v_mfma_f32_32x32x16_bf16 v[64:79], v[128:131], v[136:139], v[64:79]
    ds_read_b128 v[208:211], v15 offset:0
    ds_read_b64_tr_b16 v[216:217], v56 offset:4096
    v_mfma_f32_32x32x16_bf16 v[80:95], v[128:131], v[140:143], v[80:95]
    ds_read_b64_tr_b16 v[218:219], v56 offset:4352
    ds_read_b64_tr_b16 v[220:221], v57 offset:4096
    v_mfma_f32_32x32x16_bf16 v[96:111], v[132:135], v[136:139], v[96:111]
    ds_read_b64_tr_b16 v[222:223], v57 offset:4352
    ds_read_b128 v[212:215], v15 offset:4096
    v_mfma_f32_32x32x16_bf16 v[112:127], v[132:135], v[140:143], v[112:127]
    s_waitcnt lgkmcnt(6)
    v_mfma_f32_32x32x16_bf16 v[64:79], v[144:147], v[152:155], v[64:79]
    ds_read_b128 v[128:131], v16 offset:0
    ds_read_b64_tr_b16 v[136:137], v56 offset:8192
    v_mfma_f32_32x32x16_bf16 v[80:95], v[144:147], v[156:159], v[80:95]
    ds_read_b64_tr_b16 v[138:139], v56 offset:8448
    ds_read_b64_tr_b16 v[140:141], v57 offset:8192
    v_mfma_f32_32x32x16_bf16 v[96:111], v[148:151], v[152:155], v[96:111]
    ds_read_b64_tr_b16 v[142:143], v57 offset:8448
    ds_read_b128 v[132:135], v16 offset:4096
    v_mfma_f32_32x32x16_bf16 v[112:127], v[148:151], v[156:159], v[112:127]
    s_waitcnt lgkmcnt(6)
    v_mfma_f32_32x32x16_bf16 v[64:79], v[208:211], v[216:219], v[64:79]
    ds_read_b128 v[144:147], v17 offset:0
    ds_read_b64_tr_b16 v[152:153], v56 offset:12288
    v_mfma_f32_32x32x16_bf16 v[80:95], v[208:211], v[220:223], v[80:95]
    ds_read_b64_tr_b16 v[154:155], v56 offset:12544
    ds_read_b64_tr_b16 v[156:157], v57 offset:12288
    v_mfma_f32_32x32x16_bf16 v[96:111], v[212:215], v[216:219], v[96:111]
    ds_read_b64_tr_b16 v[158:159], v57 offset:12544
    ds_read_b128 v[148:151], v17 offset:4096
    v_mfma_f32_32x32x16_bf16 v[112:127], v[212:215], v[220:223], v[112:127]
    s_barrier
    s_waitcnt lgkmcnt(6)
    v_mfma_f32_32x32x16_bf16 v[64:79], v[128:131], v[136:139], v[64:79]
    ds_read_b128 v[208:211], v14 offset:32768
    ds_read_b64_tr_b16 v[216:217], v56 offset:32768
    v_mfma_f32_32x32x16_bf16 v[80:95], v[128:131], v[140:143], v[80:95]
    ds_read_b64_tr_b16 v[218:219], v56 offset:33024
    ds_read_b64_tr_b16 v[220:221], v57 offset:32768
    v_mfma_f32_32x32x16_bf16 v[96:111], v[132:135], v[136:139], v[96:111]
    ds_read_b64_tr_b16 v[222:223], v57 offset:33024
    ds_read_b128 v[212:215], v14 offset:36864
    v_mfma_f32_32x32x16_bf16 v[112:127], v[132:135], v[140:143], v[112:127]
    s_waitcnt lgkmcnt(6)
    v_mfma_f32_32x32x16_bf16 v[64:79], v[144:147], v[152:155], v[64:79]
    ds_read_b128 v[128:131], v15 offset:32768
    ds_read_b64_tr_b16 v[136:137], v56 offset:36864
    v_mfma_f32_32x32x16_bf16 v[80:95], v[144:147], v[156:159], v[80:95]
    ds_read_b64_tr_b16 v[138:139], v56 offset:37120
    ds_read_b64_tr_b16 v[140:141], v57 offset:36864
    v_mfma_f32_32x32x16_bf16 v[96:111], v[148:151], v[152:155], v[96:111]
    ds_read_b64_tr_b16 v[142:143], v57 offset:37120
    ds_read_b128 v[132:135], v15 offset:36864
    v_mfma_f32_32x32x16_bf16 v[112:127], v[148:151], v[156:159], v[112:127]
    buffer_load_dwordx4 v[24:27], v22, s[32:35], 0 offen sc1
    buffer_load_dwordx4 v[28:31], v22, s[32:35], 0 offen offset:512 sc1
    s_waitcnt lgkmcnt(6)
    v_mfma_f32_32x32x16_bf16 v[64:79], v[208:211], v[216:219], v[64:79]
    ds_read_b128 v[144:147], v16 offset:32768
    ds_read_b64_tr_b16 v[152:153], v56 offset:40960
    v_mfma_f32_32x32x16_bf16 v[80:95], v[208:211], v[220:223], v[80:95]
    ds_read_b64_tr_b16 v[154:155], v56 offset:41216
    ds_read_b64_tr_b16 v[156:157], v57 offset:40960
    v_mfma_f32_32x32x16_bf16 v[96:111], v[212:215], v[216:219], v[96:111]
    ds_read_b64_tr_b16 v[158:159], v57 offset:41216
    ds_read_b128 v[148:151], v16 offset:36864
    v_mfma_f32_32x32x16_bf16 v[112:127], v[212:215], v[220:223], v[112:127]
    s_waitcnt lgkmcnt(6)
    v_mfma_f32_32x32x16_bf16 v[64:79], v[128:131], v[136:139], v[64:79]
    ds_read_b128 v[208:211], v17 offset:32768
    ds_read_b64_tr_b16 v[216:217], v56 offset:45056
    v_mfma_f32_32x32x16_bf16 v[80:95], v[128:131], v[140:143], v[80:95]
    ds_read_b64_tr_b16 v[218:219], v56 offset:45312
    ds_read_b64_tr_b16 v[220:221], v57 offset:45056
    v_mfma_f32_32x32x16_bf16 v[96:111], v[132:135], v[136:139], v[96:111]
    ds_read_b64_tr_b16 v[222:223], v57 offset:45312
    ds_read_b128 v[212:215], v17 offset:36864
    v_mfma_f32_32x32x16_bf16 v[112:127], v[132:135], v[140:143], v[112:127]
    s_barrier
    s_waitcnt lgkmcnt(6)
    v_mfma_f32_32x32x16_bf16 v[64:79], v[144:147], v[152:155], v[64:79]
    ds_read_b128 v[128:131], v18 offset:0
    ds_read_b64_tr_b16 v[136:137], v58 offset:0
    v_mfma_f32_32x32x16_bf16 v[80:95], v[144:147], v[156:159], v[80:95]
    ds_read_b64_tr_b16 v[138:139], v58 offset:256
    ds_read_b64_tr_b16 v[140:141], v59 offset:0
    v_mfma_f32_32x32x16_bf16 v[96:111], v[148:151], v[152:155], v[96:111]
    ds_read_b64_tr_b16 v[142:143], v59 offset:256
    ds_read_b128 v[132:135], v18 offset:4096
    v_mfma_f32_32x32x16_bf16 v[112:127], v[148:151], v[156:159], v[112:127]
    s_waitcnt lgkmcnt(6)
    ds_read_b32 v40, v38
    ds_read_b32 v41, v38 offset:512
    ds_read_b32 v42, v39
    ds_read_b32 v43, v39 offset:512
    v_mfma_f32_32x32x16_bf16 v[64:79], v[208:211], v[216:219], v[64:79]
    ds_read_b128 v[144:147], v19 offset:0
    ds_read_b64_tr_b16 v[152:153], v58 offset:4096
    v_mfma_f32_32x32x16_bf16 v[80:95], v[208:211], v[220:223], v[80:95]
    ds_read_b64_tr_b16 v[154:155], v58 offset:4352
    ds_read_b64_tr_b16 v[156:157], v59 offset:4096
    v_mfma_f32_32x32x16_bf16 v[96:111], v[212:215], v[216:219], v[96:111]
    ds_read_b64_tr_b16 v[158:159], v59 offset:4352
    ds_read_b128 v[148:151], v19 offset:4096
    v_mfma_f32_32x32x16_bf16 v[112:127], v[212:215], v[220:223], v[112:127]
    s_waitcnt lgkmcnt(6)
    s_mov_b32 s99, 0x80000
    s_waitcnt vmcnt(0)
P1_cloopvchk:
    v_xor_b32 v3, s36, v26
    v_xor_b32 v4, s37, v27
    v_xor_b32 v5, s36, v30
    v_xor_b32 v8, s37, v31
    v_or3_b32 v3, v3, v4, v5
    v_or_b32 v3, v3, v8
    v_cmp_ne_u32 vcc, 0, v3
    s_nop 1
    s_cbranch_vccnz P1_cloopvrty
P1_cloopvok:
    v_mfma_f32_32x32x16_bf16 v[64:79], v[128:131], v[136:139], v[64:79]
    ds_read_b128 v[208:211], v20 offset:0
    ds_read_b64_tr_b16 v[216:217], v58 offset:8192
    s_lshl_b32 s54, s3, 8
    v_and_b32 v3, 31, v1
    v_lshl_add_u32 v3, v3, 2, s54
    v_mfma_f32_32x32x16_bf16 v[80:95], v[128:131], v[140:143], v[80:95]
    ds_read_b64_tr_b16 v[218:219], v58 offset:8448
    ds_read_b64_tr_b16 v[220:221], v59 offset:8192
    ds_write_b32 v3, v25 offset:8192
    ds_write_b32 v3, v29 offset:8320
    v_lshrrev_b32 v4, 5, v1
    v_mfma_f32_32x32x16_bf16 v[96:111], v[132:135], v[136:139], v[96:111]
    ds_read_b64_tr_b16 v[222:223], v59 offset:8448
    ds_read_b128 v[212:215], v20 offset:4096
    v_lshl_add_u32 v4, v4, 4, s54
    v_cvt_pk_bf16_f32 v232, -v24, -v24
    v_and_b32 v5, 0xffff0000, v232
    v_mfma_f32_32x32x16_bf16 v[112:127], v[132:135], v[140:143], v[112:127]
    v_sub_f32 v5, -v24, v5
    v_cvt_pk_bf16_f32 v233, v5, 0
    v_cvt_pk_bf16_f32 v236, -v28, -v28
    s_waitcnt lgkmcnt(6)
    v_mfma_f32_32x32x16_bf16 v[64:79], v[144:147], v[152:155], v[64:79]
    ds_read_b128 v[128:131], v21 offset:0
    ds_read_b64_tr_b16 v[136:137], v58 offset:12288
    v_and_b32 v5, 0xffff0000, v236
    v_sub_f32 v5, -v28, v5
    v_cvt_pk_bf16_f32 v237, v5, 0
    v_mfma_f32_32x32x16_bf16 v[80:95], v[144:147], v[156:159], v[80:95]
    ds_read_b64_tr_b16 v[138:139], v58 offset:12544
    ds_read_b64_tr_b16 v[140:141], v59 offset:12288
    v_add_f32 v40, v40, v41
    v_cvt_pk_bf16_f32 v225, v40, 0
    v_lshlrev_b32 v41, 16, v225
    v_mfma_f32_32x32x16_bf16 v[96:111], v[148:151], v[152:155], v[96:111]
    ds_read_b64_tr_b16 v[142:143], v59 offset:12544
    ds_read_b128 v[132:135], v21 offset:4096
    v_sub_f32 v41, v40, v41
    v_cvt_pk_bf16_f32 v224, v40, v41
    v_add_f32 v42, v42, v43
    v_mfma_f32_32x32x16_bf16 v[112:127], v[148:151], v[156:159], v[112:127]
    v_cvt_pk_bf16_f32 v229, v42, 0
    v_lshlrev_b32 v43, 16, v229
    v_sub_f32 v43, v42, v43
    s_waitcnt lgkmcnt(6)
    ds_read_b128 v[160:163], v4 offset:8192
    ds_read_b128 v[164:167], v4 offset:8224
    ds_read_b128 v[168:171], v4 offset:8256
    ds_read_b128 v[172:175], v4 offset:8288
    ds_read_b128 v[176:179], v4 offset:8320
    ds_read_b128 v[180:183], v4 offset:8352
    ds_read_b128 v[184:187], v4 offset:8384
    ds_read_b128 v[188:191], v4 offset:8416
    v_mfma_f32_32x32x16_bf16 v[64:79], v[208:211], v[216:219], v[64:79]
    v_cvt_pk_bf16_f32 v228, v42, v43
    v_mfma_f32_32x32x16_bf16 v[80:95], v[208:211], v[220:223], v[80:95]
    v_mfma_f32_32x32x16_bf16 v[96:111], v[212:215], v[216:219], v[96:111]
    v_mfma_f32_32x32x16_bf16 v[112:127], v[212:215], v[220:223], v[112:127]
    s_waitcnt lgkmcnt(0)
    v_mfma_f32_32x32x16_bf16 v[64:79], v[128:131], v[136:139], v[64:79]
    v_mfma_f32_32x32x16_bf16 v[80:95], v[128:131], v[140:143], v[80:95]
    v_mfma_f32_32x32x16_bf16 v[96:111], v[132:135], v[136:139], v[96:111]
    v_mfma_f32_32x32x16_bf16 v[112:127], v[132:135], v[140:143], v[112:127]
    s_nop 0
    v_mfma_f32_32x32x16_bf16 v[64:79], v[232:235], v[224:227], v[64:79]
    v_mfma_f32_32x32x16_bf16 v[80:95], v[232:235], v[228:231], v[80:95]
    v_mfma_f32_32x32x16_bf16 v[96:111], v[236:239], v[224:227], v[96:111]
    v_mfma_f32_32x32x16_bf16 v[112:127], v[236:239], v[228:231], v[112:127]
    s_nop 7
    s_nop 1
    v_pk_mul_f32 v[64:65], v[64:65], v[160:161]
    v_pk_mul_f32 v[66:67], v[66:67], v[162:163]
    v_pk_mul_f32 v[68:69], v[68:69], v[164:165]
    v_pk_mul_f32 v[70:71], v[70:71], v[166:167]
    v_pk_mul_f32 v[72:73], v[72:73], v[168:169]
    v_pk_mul_f32 v[74:75], v[74:75], v[170:171]
    v_pk_mul_f32 v[76:77], v[76:77], v[172:173]
    v_pk_mul_f32 v[78:79], v[78:79], v[174:175]
    v_cvt_pk_bf16_f32 v192, v64, v65
    v_cvt_pk_bf16_f32 v193, v66, v67
    v_cvt_pk_bf16_f32 v194, v68, v69
    v_cvt_pk_bf16_f32 v195, v70, v71
    v_cvt_pk_bf16_f32 v196, v72, v73
    v_cvt_pk_bf16_f32 v197, v74, v75
    v_cvt_pk_bf16_f32 v198, v76, v77
    v_cvt_pk_bf16_f32 v199, v78, v79
    buffer_store_dwordx4 v[192:195], v44, s[32:35], s66 offen offset:0 sc1
    buffer_store_dwordx4 v[196:199], v44, s[32:35], s66 offen offset:640 sc1
    v_pk_mul_f32 v[80:81], v[80:81], v[160:161]
    v_pk_mul_f32 v[82:83], v[82:83], v[162:163]
    v_pk_mul_f32 v[84:85], v[84:85], v[164:165]
    v_pk_mul_f32 v[86:87], v[86:87], v[166:167]
    v_pk_mul_f32 v[88:89], v[88:89], v[168:169]
    v_pk_mul_f32 v[90:91], v[90:91], v[170:171]
    v_pk_mul_f32 v[92:93], v[92:93], v[172:173]
    v_pk_mul_f32 v[94:95], v[94:95], v[174:175]
    v_cvt_pk_bf16_f32 v200, v80, v81
    v_cvt_pk_bf16_f32 v201, v82, v83
    v_cvt_pk_bf16_f32 v202, v84, v85
    v_cvt_pk_bf16_f32 v203, v86, v87
    v_cvt_pk_bf16_f32 v204, v88, v89
    v_cvt_pk_bf16_f32 v205, v90, v91
    v_cvt_pk_bf16_f32 v206, v92, v93
    v_cvt_pk_bf16_f32 v207, v94, v95
    buffer_store_dwordx4 v[200:203], v45, s[32:35], s66 offen offset:0 sc1
    buffer_store_dwordx4 v[204:207], v45, s[32:35], s66 offen offset:640 sc1
    v_pk_mul_f32 v[96:97], v[96:97], v[176:177]
    v_pk_mul_f32 v[98:99], v[98:99], v[178:179]
    v_pk_mul_f32 v[100:101], v[100:101], v[180:181]
    v_pk_mul_f32 v[102:103], v[102:103], v[182:183]
    v_pk_mul_f32 v[104:105], v[104:105], v[184:185]
    v_pk_mul_f32 v[106:107], v[106:107], v[186:187]
    v_pk_mul_f32 v[108:109], v[108:109], v[188:189]
    v_pk_mul_f32 v[110:111], v[110:111], v[190:191]
    v_cvt_pk_bf16_f32 v208, v96, v97
    v_cvt_pk_bf16_f32 v209, v98, v99
    v_cvt_pk_bf16_f32 v210, v100, v101
    v_cvt_pk_bf16_f32 v211, v102, v103
    v_cvt_pk_bf16_f32 v212, v104, v105
    v_cvt_pk_bf16_f32 v213, v106, v107
    v_cvt_pk_bf16_f32 v214, v108, v109
    v_cvt_pk_bf16_f32 v215, v110, v111
    buffer_store_dwordx4 v[208:211], v44, s[32:35], s66 offen offset:1280 sc1
    buffer_store_dwordx4 v[212:215], v44, s[32:35], s66 offen offset:1920 sc1
    v_pk_mul_f32 v[112:113], v[112:113], v[176:177]
    v_pk_mul_f32 v[114:115], v[114:115], v[178:179]
    v_pk_mul_f32 v[116:117], v[116:117], v[180:181]
    v_pk_mul_f32 v[118:119], v[118:119], v[182:183]
    v_pk_mul_f32 v[120:121], v[120:121], v[184:185]
    v_pk_mul_f32 v[122:123], v[122:123], v[186:187]
    v_pk_mul_f32 v[124:125], v[124:125], v[188:189]
    v_pk_mul_f32 v[126:127], v[126:127], v[190:191]
    v_cvt_pk_bf16_f32 v216, v112, v113
    v_cvt_pk_bf16_f32 v217, v114, v115
    v_cvt_pk_bf16_f32 v218, v116, v117
    v_cvt_pk_bf16_f32 v219, v118, v119
    v_cvt_pk_bf16_f32 v220, v120, v121
    v_cvt_pk_bf16_f32 v221, v122, v123
    v_cvt_pk_bf16_f32 v222, v124, v125
    v_cvt_pk_bf16_f32 v223, v126, v127
    buffer_store_dwordx4 v[216:219], v45, s[32:35], s66 offen offset:1280 sc1
    buffer_store_dwordx4 v[220:223], v45, s[32:35], s66 offen offset:1920 sc1
    s_branch P1_done
P1_cloopvrty:
    buffer_load_dwordx4 v[24:27], v22, s[32:35], 0 offen sc1
    buffer_load_dwordx4 v[28:31], v22, s[32:35], 0 offen offset:512 sc1
    s_waitcnt vmcnt(0)
    s_sub_u32 s99, s99, 1
    s_cbranch_scc0 P1_cloopvchk
    s_branch P1_cloopvok
P1_done:
    s_waitcnt vmcnt(0)
    s_barrier
    s_cmp_lg_u32 s3, 0
    s_cbranch_scc1 P1_nopub
    s_cmp_eq_u32 s39, 15
    s_cbranch_scc1 P1_nopub
    s_lshl_b32 s54, s39, 4
    s_add_u32 s54, s54, s38
    s_lshl_b32 s54, s54, 5
    s_add_u32 s54, s54, 0x2210000
    v_mov_b32 v244, s36
    v_mov_b32 v245, s37
    v_lshlrev_b32 v246, 20, v1
    s_waitcnt vmcnt(0)
    s_mov_b64 exec, 0x1
    buffer_store_dwordx2 v[244:245], v246, s[32:35], s54 offen sc1
    s_mov_b64 exec, -1
P1_nopub:
    s_mov_b32 s98, 0
P2_begin:
    s_and_b32 s44, s2, 7
    s_lshr_b32 s45, s2, 3
    s_lshl_b32 s38, s44, 2
    s_lshr_b32 s46, s45, 3
    s_add_u32 s38, s38, s46
    s_and_b32 s39, s45, 7
    s_and_b32 s40, s3, 3
    s_lshr_b32 s41, s3, 2
    s_mov_b32 s52, 0x000fffff
    s_mov_b32 s53, 0x000fffff
    s_mov_b32 s54, -1
    s_mov_b32 s55, 0
    s_mul_i32 s50, s38, 163840
    s_add_u32 s50, s50, 0x400000
    s_lshl_b32 s44, s38, 6
    s_lshl_b32 s45, s39, 3
    s_add_u32 s44, s44, s45
    s_lshl_b32 s45, s40, 1
    s_add_u32 s44, s44, s45
    s_lshl_b32 s56, s44, 10
    s_add_u32 s56, s56, 0x100000
    s_lshl_b32 s57, s44, 8
    s_add_u32 s57, s57, 0x300000
    v_lshlrev_b32 v5, 4, v1
    v_lshlrev_b32 v6, 3, v1
    v_lshrrev_b32 v7, 5, v1
    v_lshl_add_u32 v7, v7, 30, v6
    s_cmp_lt_u32 s3, 3
    s_cbranch_scc1 P2_nors
    s_sub_u32 s44, s3, 3
    s_mul_i32 s45, s38, 20
    s_lshl_b32 s46, s44, 2
    s_add_u32 s45, s45, s46
    s_mul_i32 s45, s45, 1280
    v_lshrrev_b32 v21, 4, v1
    v_mul_u32_u24 v22, 1280, v21
    v_and_b32 v23, 15, v1
    v_lshl_add_u32 v22, v23, 4, v22
    buffer_load_dwordx4 v[64:67], v22, s[12:15], s45 offen offset:0
    buffer_load_dwordx4 v[68:71], v22, s[12:15], s45 offen offset:256
    buffer_load_dwordx4 v[72:75], v22, s[12:15], s45 offen offset:512
    buffer_load_dwordx4 v[76:79], v22, s[12:15], s45 offen offset:768
    buffer_load_dwordx4 v[80:83], v22, s[12:15], s45 offen offset:1024
P2_nors:
    v_mov_b32 v247, v7
    v_mov_b32 v254, v7
    v_mov_b32 v246, v7
    s_lshl_b32 s47, s39, 3
    s_lshl_b32 s45, s40, 1
    s_add_u32 s47, s47, s45
    s_lshl_b32 s45, s47, 15
    s_lshl_b32 s46, s38, 9
    s_add_u32 s45, s45, s46
    s_add_u32 s68, s45, 0x900000
    s_lshl_b32 s46, s47, 13
    s_lshl_b32 s45, s38, 7
    s_add_u32 s46, s46, s45
    s_add_u32 s69, s46, 0xb00000
    s_lshl_b32 s46, s47, 12
    s_lshl_b32 s45, s38, 5
    s_add_u32 s46, s46, s45
    s_add_u32 s51, s46, 0x2220000
    v_and_b32 v24, 15, v1
    v_bfe_u32 v25, v1, 4, 1
    v_lshrrev_b32 v26, 5, v1
    v_lshlrev_b32 v200, 14, v25
    v_lshl_add_u32 v200, v26, 8, v200
    v_lshl_add_u32 v200, v24, 4, v200
    v_add_u32 v202, 32768, v200
    v_lshlrev_b32 v201, 12, v25
    v_lshl_add_u32 v201, v24, 3, v201
    v_lshl_add_u32 v201, v26, 30, v201
    v_add_u32 v203, 8192, v201
    s_lshr_b32 s48, s2, 3
    s_lshl_b32 s48, s48, 3
    s_add_u32 s48, s48, s3
    s_and_b32 s45, s2, 7
    s_lshl_b32 s46, s45, 8
    s_add_u32 s46, s46, s48
    s_mul_i32 s46, s46, 10
    v_add_lshl_u32 v161, v1, s46, 7
    s_mul_i32 s46, s48, 25
    v_add_lshl_u32 v160, v1, s46, 7
    s_and_b32 s46, s45, 1
    s_lshl_b32 s46, s46, 8
    s_add_u32 s46, s46, s48
    s_mul_i32 s46, s46, 60
    s_add_u32 s46, s46, 0x36000
    v_add_lshl_u32 v162, v1, s46, 7
    s_movk_i32 s48, 6554
    s_bitcmp1_b32 s3, 0
    s_cselect_b64 vcc, -1, 0
    v_add_u32 v22, 0, v1
    v_mul_u32_u24 v23, s48, v22
    v_lshrrev_b32 v23, 16, v23
    v_mul_u32_u24 v24, 10, v23
    v_sub_u32 v24, v22, v24
    v_lshlrev_b32 v24, 4, v24
    v_mul_u32_u24 v22, 1280, v23
    v_add_u32 v208, v22, v24
    v_lshrrev_b32 v25, 4, v23
    v_mul_u32_u24 v22, 5120, v25
    v_add_u32 v213, v22, v208
    v_lshlrev_b32 v25, 2, v25
    v_bfe_u32 v27, v23, 2, 1
    v_lshl_add_u32 v25, v27, 1, v25
    v_bfe_u32 v27, v23, 3, 1
    v_add_u32 v25, v25, v27
    v_mul_u32_u24 v25, 20, v25
    v_and_b32 v27, 3, v23
    v_add3_u32 v25, v25, v27, 16
    v_mul_u32_u24 v25, 1280, v25
    v_add_u32 v25, v25, v24
    v_cndmask_b32 v218, v213, v25, vcc
    v_add_u32 v22, 64, v1
    v_mul_u32_u24 v23, s48, v22
    v_lshrrev_b32 v23, 16, v23
    v_mul_u32_u24 v24, 10, v23
    v_sub_u32 v24, v22, v24
    v_lshlrev_b32 v24, 4, v24
    v_mul_u32_u24 v22, 1280, v23
    v_add_u32 v209, v22, v24
    v_lshrrev_b32 v25, 4, v23
    v_mul_u32_u24 v22, 5120, v25
    v_add_u32 v214, v22, v209
    v_lshlrev_b32 v25, 2, v25
    v_bfe_u32 v27, v23, 2, 1
    v_lshl_add_u32 v25, v27, 1, v25
    v_bfe_u32 v27, v23, 3, 1
    v_add_u32 v25, v25, v27
    v_mul_u32_u24 v25, 20, v25
    v_and_b32 v27, 3, v23
    v_add3_u32 v25, v25, v27, 16
    v_mul_u32_u24 v25, 1280, v25
    v_add_u32 v25, v25, v24
    v_cndmask_b32 v219, v214, v25, vcc
    v_add_u32 v22, 128, v1
    v_mul_u32_u24 v23, s48, v22
    v_lshrrev_b32 v23, 16, v23
    v_mul_u32_u24 v24, 10, v23
    v_sub_u32 v24, v22, v24
    v_lshlrev_b32 v24, 4, v24
    v_mul_u32_u24 v22, 1280, v23
    v_add_u32 v210, v22, v24
    v_lshrrev_b32 v25, 4, v23
    v_mul_u32_u24 v22, 5120, v25
    v_add_u32 v215, v22, v210
    v_lshlrev_b32 v25, 2, v25
    v_bfe_u32 v27, v23, 2, 1
    v_lshl_add_u32 v25, v27, 1, v25
    v_bfe_u32 v27, v23, 3, 1
    v_add_u32 v25, v25, v27
    v_mul_u32_u24 v25, 20, v25
    v_and_b32 v27, 3, v23
    v_add3_u32 v25, v25, v27, 16
    v_mul_u32_u24 v25, 1280, v25
    v_add_u32 v25, v25, v24
    v_cndmask_b32 v220, v215, v25, vcc
    v_add_u32 v22, 192, v1
    v_mul_u32_u24 v23, s48, v22
    v_lshrrev_b32 v23, 16, v23
    v_mul_u32_u24 v24, 10, v23
    v_sub_u32 v24, v22, v24
    v_lshlrev_b32 v24, 4, v24
    v_mul_u32_u24 v22, 1280, v23
    v_add_u32 v211, v22, v24
    v_lshrrev_b32 v25, 4, v23
    v_mul_u32_u24 v22, 5120, v25
    v_add_u32 v216, v22, v211
    v_lshlrev_b32 v25, 2, v25
    v_bfe_u32 v27, v23, 2, 1
    v_lshl_add_u32 v25, v27, 1, v25
    v_bfe_u32 v27, v23, 3, 1
    v_add_u32 v25, v25, v27
    v_mul_u32_u24 v25, 20, v25
    v_and_b32 v27, 3, v23
    v_add3_u32 v25, v25, v27, 16
    v_mul_u32_u24 v25, 1280, v25
    v_add_u32 v25, v25, v24
    v_cndmask_b32 v221, v216, v25, vcc
    v_add_u32 v22, 256, v1
    v_mul_u32_u24 v23, s48, v22
    v_lshrrev_b32 v23, 16, v23
    v_mul_u32_u24 v24, 10, v23
    v_sub_u32 v24, v22, v24
    v_lshlrev_b32 v24, 4, v24
    v_mul_u32_u24 v22, 1280, v23
    v_add_u32 v212, v22, v24
    v_lshrrev_b32 v25, 4, v23
    v_mul_u32_u24 v22, 5120, v25
    v_add_u32 v217, v22, v212
    v_lshlrev_b32 v25, 2, v25
    v_bfe_u32 v27, v23, 2, 1
    v_lshl_add_u32 v25, v27, 1, v25
    v_bfe_u32 v27, v23, 3, 1
    v_add_u32 v25, v25, v27
    v_mul_u32_u24 v25, 20, v25
    v_and_b32 v27, 3, v23
    v_add3_u32 v25, v25, v27, 16
    v_mul_u32_u24 v25, 1280, v25
    v_add_u32 v25, v25, v24
    v_cndmask_b32 v222, v217, v25, vcc
    s_mov_b32 s67, 0x20000
    s_cmp_le_u32 s3, 4
    s_cbranch_scc0 P2_quint
    s_mul_i32 s45, s2, 5
    s_add_u32 s45, s45, s3
    s_mul_i32 s60, s45, 3072
    s_add_u32 s60, s60, 0x1b00000
    s_mul_i32 s46, s45, 52429
    s_lshr_b32 s46, s46, 22
    s_mul_i32 s47, s46, 80
    s_sub_u32 s45, s45, s47
    s_mul_i32 s59, s46, 192
    s_lshr_b32 s47, s45, 1
    s_mul_i32 s47, s47, 49152
    s_add_u32 s59, s59, s47
    s_bitcmp1_b32 s45, 0
    s_cselect_b64 s[64:65], s[20:21], s[16:17]
    s_mov_b32 s66, 0x1e0000
    v_lshrrev_b32 v22, 2, v1
    v_mul_u32_u24 v22, 3072, v22
    v_and_b32 v23, 3, v1
    v_lshl_add_u32 v170, v23, 4, v22
    v_add_u32 v171, 64, v170
    v_add_u32 v172, 64, v171
    v_mov_b32 v173, 0x40000000
    v_mov_b32 v174, 0x40000000
    v_mov_b32 v175, v5
    v_mov_b32 v176, 0x40000000
    v_mov_b32 v177, 0x40000000
    s_branch P2_rldone
P2_quint:
    s_lshl_b32 s45, s2, 1
    s_add_u32 s45, s45, s3
    s_sub_u32 s45, s45, 5
    s_cmp_eq_u32 s3, 7
    s_cselect_b32 s45, 384, s45
    s_cmp_ge_u32 s45, 384
    s_cselect_b32 s48, 0x40000000, 0
    v_add_u32 v175, s48, v5
    v_mov_b32 v176, v175
    v_add_u32 v177, 4096, v175
    s_mul_i32 s60, s45, 5120
    s_add_u32 s60, s60, 0x1f00000
    s_mul_i32 s46, s45, 1366
    s_lshr_b32 s46, s46, 16
    s_mul_i32 s47, s46, 48
    s_sub_u32 s45, s45, s47
    s_mul_i32 s59, s46, 160
    s_and_b32 s46, s45, 1
    s_mul_i32 s46, s46, 24
    s_lshr_b32 s45, s45, 1
    s_add_u32 s45, s45, s46
    s_mul_i32 s45, s45, 40960
    s_add_u32 s59, s59, s45
    s_add_u32 s59, s59, s48
    s_mov_b64 s[64:65], s[24:25]
    s_mov_b32 s66, 0x1e0000
    v_mov_b32 v170, v208
    v_mov_b32 v171, v209
    v_mov_b32 v172, v210
    v_mov_b32 v173, v211
    v_mov_b32 v174, v212
P2_rldone:
    s_and_b32 s46, s2, 7
    s_lshr_b32 s47, s2, 3
    s_lshr_b32 s48, s46, 0
    s_lshl_b32 s48, s48, 2
    s_and_b32 s49, s46, 0
    s_lshl_b32 s49, s49, 3
    s_and_b32 s46, s47, 3
    s_add_u32 s48, s48, s46
    s_lshr_b32 s46, s47, 2
    s_add_u32 s49, s49, s46
    s_and_b32 s48, s3, 1
    s_lshr_b32 s46, s3, 1
    s_mul_i32 s47, s48, 120
    s_add_u32 s47, s47, 40
    s_mul_i32 s61, s46, s47
    s_mul_i32 s61, s61, 1280
    s_mul_i32 s49, s49, 160
    s_add_u32 s61, s61, s49
    s_mul_i32 s47, s48, 6
    s_add_u32 s46, s46, s47
    s_add_u32 s46, s46, 4
    s_mul_i32 s46, s46, 51200
    s_add_u32 s42, s46, s49
    s_mul_i32 s94, s3, 5120
    s_add_u32 s94, s94, 40960
    s_cmp_lt_u32 s3, 3
    s_cbranch_scc1 P2_top
    s_lshr_b32 s45, s38, 1
    s_and_b32 s46, s38, 1
    s_lshl_b32 s45, s45, 7
    s_lshl_b32 s47, s46, 5
    s_add_u32 s45, s45, s47
    s_and_b32 s47, s44, 1
    s_lshl_b32 s47, s47, 4
    s_add_u32 s45, s45, s47
    s_lshr_b32 s47, s44, 1
    s_lshl_b32 s47, s47, 3
    s_add_u32 s45, s45, s47
    s_lshr_b32 s47, s38, 3
    s_lshl_b32 s47, s47, 7
    s_lshl_b32 s46, s46, 3
    s_add_u32 s47, s47, s46
    s_bfe_u32 s46, s38, 0x20001
    s_lshl_b32 s46, s46, 4
    s_add_u32 s47, s47, s46
    s_add_u32 s47, s47, 2048
    s_cmp_eq_u32 s44, 4
    s_cselect_b32 s45, s47, s45
    s_mul_i32 s46, s39, 2560
    s_add_u32 s45, s45, s46
    s_add_u32 s45, s45, 0xa0000
    s_mov_b32 s46, 0x3f803f80
    v_mov_b32 v22, 0
    v_mov_b32 v23, 0
    v_lshlrev_b32 v21, 1, v21
    s_waitcnt vmcnt(0)
    v_dot2_f32_bf16 v22, v64, s46, v22
    v_dot2_f32_bf16 v23, v65, s46, v23
    v_dot2_f32_bf16 v22, v66, s46, v22
    v_dot2_f32_bf16 v23, v67, s46, v23
    v_dot2_f32_bf16 v22, v68, s46, v22
    v_dot2_f32_bf16 v23, v69, s46, v23
    v_dot2_f32_bf16 v22, v70, s46, v22
    v_dot2_f32_bf16 v23, v71, s46, v23
    v_dot2_f32_bf16 v22, v72, s46, v22
    v_dot2_f32_bf16 v23, v73, s46, v23
    v_dot2_f32_bf16 v22, v74, s46, v22
    v_dot2_f32_bf16 v23, v75, s46, v23
    v_dot2_f32_bf16 v22, v76, s46, v22
    v_dot2_f32_bf16 v23, v77, s46, v23
    v_dot2_f32_bf16 v22, v78, s46, v22
    v_dot2_f32_bf16 v23, v79, s46, v23
    v_dot2_f32_bf16 v22, v80, s46, v22
    v_dot2_f32_bf16 v23, v81, s46, v23
    v_dot2_f32_bf16 v22, v82, s46, v22
    v_dot2_f32_bf16 v23, v83, s46, v23
    s_nop 2
    v_add_f32 v22, v22, v23
    s_nop 1
    v_add_f32_dpp v22, v22, v22 row_shr:1 row_mask:0xf bank_mask:0xf bound_ctrl:0
    s_nop 1
    v_add_f32_dpp v22, v22, v22 row_shr:2 row_mask:0xf bank_mask:0xf bound_ctrl:0
    s_nop 1
    v_add_f32_dpp v22, v22, v22 row_shr:4 row_mask:0xf bank_mask:0xf bound_ctrl:0
    s_nop 1
    v_add_f32_dpp v22, v22, v22 row_shr:8 row_mask:0xf bank_mask:0xf bound_ctrl:0
    v_cvt_pk_bf16_f32 v23, v22, 0
    v_lshlrev_b32 v24, 16, v23
    v_sub_f32 v24, v22, v24
    v_cvt_pk_bf16_f32 v24, v24, 0
    s_mov_b32 exec_lo, 0x80008000
    s_mov_b32 exec_hi, 0x80008000
    buffer_store_short v23, v21, s[32:35], s45 offen sc1
    buffer_store_short v24, v21, s[32:35], s45 offen offset:64 sc1
    s_mov_b64 exec, -1
P2_top:
    s_mul_i32 s44, s41, 10240
    v_add_u32 v2, s44, v5
    v_add_u32 v3, s44, v6
    v_add_u32 v3, 4096, v3
    v_and_b32 v21, 31, v1
    v_lshrrev_b32 v22, 5, v1
    v_mul_u32_u24 v22, 320, v22
    v_lshl_add_u32 v22, v21, 4, v22
    v_add_u32 v22, 5120, v22
    v_add_u32 v4, s44, v22
    v_mov_b32 v20, 0xdddddddd
    v_and_b32 v21, 27, v21
    v_cmp_eq_u32 vcc, 24, v21
    v_mov_b32 v22, 0x3f803f80
    v_mov_b32 v23, 0x3f80
    v_cndmask_b32 v21, 0, v22, vcc
    v_mov_b32 v144, v21
    v_mov_b32 v145, v21
    v_mov_b32 v146, v21
    v_mov_b32 v147, v21
    v_mov_b32 v148, v21
    v_mov_b32 v149, v21
    v_mov_b32 v150, v21
    v_mov_b32 v151, v21
    v_mov_b32 v152, v21
    v_mov_b32 v153, v21
    v_mov_b32 v154, v21
    v_mov_b32 v155, v21
    v_mov_b32 v156, v21
    v_mov_b32 v157, v21
    v_mov_b32 v158, v21
    v_mov_b32 v159, v21
    v_mov_b32 v136, v22
    v_mov_b32 v137, v23
    v_mov_b32 v138, v22
    v_mov_b32 v139, v23
    v_mov_b32 v140, v22
    v_mov_b32 v141, v23
    v_mov_b32 v142, v22
    v_mov_b32 v143, v23
    v_mov_b32 v32, 0
    v_mov_b32 v33, 0
    v_mov_b32 v34, 0
    v_mov_b32 v35, 0
    v_mov_b32 v36, 0
    v_mov_b32 v37, 0
    v_mov_b32 v38, 0
    v_mov_b32 v39, 0
    v_mov_b32 v40, 0
    v_mov_b32 v41, 0
    v_mov_b32 v42, 0
    v_mov_b32 v43, 0
    v_mov_b32 v44, 0
    v_mov_b32 v45, 0
    v_mov_b32 v46, 0
    v_mov_b32 v47, 0
    v_mov_b32 v48, 0
    v_mov_b32 v49, 0
    v_mov_b32 v50, 0
    v_mov_b32 v51, 0
    v_mov_b32 v52, 0
    v_mov_b32 v53, 0
    v_mov_b32 v54, 0
    v_mov_b32 v55, 0
    v_mov_b32 v56, 0
    v_mov_b32 v57, 0
    v_mov_b32 v58, 0
    v_mov_b32 v59, 0
    v_mov_b32 v60, 0
    v_mov_b32 v61, 0
    v_mov_b32 v62, 0
    v_mov_b32 v63, 0
    v_mov_b32 v120, 0
    v_mov_b32 v121, 0
    v_mov_b32 v122, 0
    v_mov_b32 v123, 0
    v_mov_b32 v124, 0
    v_mov_b32 v125, 0
    v_mov_b32 v126, 0
    v_mov_b32 v127, 0
    s_xor_b32 s44, s41, 1
    s_or_b32 s44, s44, s98
    s_cbranch_scc1 L_noba_3
    s_barrier
    s_mov_b64 exec, 0
    s_cmp_eq_u32 s3, 4
    s_cbranch_scc1 L_pad0
    s_cmp_eq_u32 s3, 5
    s_cbranch_scc1 L_pad1
    s_cmp_eq_u32 s3, 6
    s_cbranch_scc1 L_pad2
    s_cmp_eq_u32 s3, 7
    s_cbranch_scc1 L_pad3
L_warm0:
    s_mov_b64 exec, -1
L_noba_3:
    s_cmp_lg_u32 s3, 1
    s_cbranch_scc1 P2_nopoll
    s_mul_i32 s44, s38, 20
    s_add_u32 s45, s44, 19
    s_lshr_b32 s44, s44, 7
    s_lshr_b32 s45, s45, 7
    v_mov_b32 v21, s44
    v_mov_b32 v22, s45
    v_and_b32 v23, 16, v1
    v_cmp_ne_u32 vcc, 0, v23
    v_lshrrev_b32 v24, 5, v1
    v_mul_u32_u24 v24, 5, v24
    v_cndmask_b32 v23, v21, v22, vcc
    v_add3_u32 v23, v23, v24, 5
    v_and_b32 v24, 15, v1
    v_lshl_add_u32 v23, v23, 4, v24
    v_lshlrev_b32 v23, 5, v23
    v_and_b32 v24, 2, v1
    v_cmp_ne_u32 vcc, 0, v24
    v_and_b32 v24, 1, v1
    s_lshl_b32 s46, s39, 1
    v_cndmask_b32 v21, v21, v22, vcc
    v_lshl_add_u32 v21, v21, 4, v24
    v_add_lshl_u32 v21, v21, s46, 5
    s_mov_b32 s44, 0x2210000
    s_mov_b32 s99, 0x80000
    s_add_u32 s97, s44, 0x0
L_poll_4:
    buffer_load_dwordx2 v[248:249], v23, s[32:35], s44 offen sc1
    buffer_load_dwordx2 v[250:251], v21, s[32:35], s44 offen sc1
    s_waitcnt vmcnt(0)
    v_xor_b32 v248, s36, v248
    v_xor_b32 v249, s37, v249
    v_xor_b32 v250, s36, v250
    v_xor_b32 v251, s37, v251
    v_or3_b32 v248, v248, v249, v250
    v_or_b32 v248, v248, v251
    v_cmp_ne_u32 vcc, 0, v248
    s_nop 1
    s_and_b64 exec, exec, vcc
    s_cbranch_execz L_polld_5
    s_add_u32 s44, s44, 0x100000
    s_min_u32 s44, s44, s97
    s_sleep 1
    s_sub_u32 s99, s99, 1
    s_cbranch_scc0 L_poll_4
L_polld_5:
    s_mov_b64 exec, -1
P2_nopoll:
    s_lshl_b32 s58, s3, 10
    s_barrier
    s_add_u32 s44, s58, s50
    s_mov_b32 m0, s58
    s_add_u32 s58, s58, 8192
    buffer_load_dwordx4 v5, s[32:35], s44 offen sc1 lds
    buffer_load_dwordx4 v[8:11], v5, s[32:35], s56 offen sc1
    buffer_load_dwordx2 v[16:17], v7, s[32:35], s57 offen sc1
    buffer_load_dwordx4 v[12:15], v5, s[32:35], s56 offen offset:1024 sc1
    buffer_load_dwordx2 v[18:19], v7, s[32:35], s57 offen offset:256 sc1
    s_add_u32 s44, s58, s50
    s_mov_b32 m0, s58
    s_add_u32 s58, s58, 8192
    buffer_load_dwordx4 v5, s[32:35], s44 offen sc1 lds
    s_add_u32 s44, s58, s50
    s_mov_b32 m0, s58
    s_add_u32 s58, s58, 8192
    buffer_load_dwordx4 v5, s[32:35], s44 offen sc1 lds
    s_cmp_eq_u32 s98, 0
    s_cbranch_scc1 P2_start
P2_fbl:
    s_add_u32 s44, s58, s50
    s_mov_b32 m0, s58
    s_add_u32 s58, s58, 8192
    buffer_load_dwordx4 v5, s[32:35], s44 offen sc1 lds
    s_cmp_lt_u32 s58, 163840
    s_cbranch_scc1 P2_fbl
    s_waitcnt vmcnt(0)
    s_barrier
    v_mov_b32 v24, 0xff800000
    v_mov_b32 v25, 0xff800000
    v_mov_b32 v26, v5
    v_add_u32 v27, 4096, v6
    s_mov_b32 s43, 0
P2_mx:
    ds_read_b128 v[128:131], v26 offset:0
    s_mov_b64 exec, s[54:55]
    ds_read_b64 v[136:137], v27 offset:0
    s_mov_b64 exec, -1
    s_waitcnt lgkmcnt(0)
    v_mfma_f32_32x32x16_bf16 v[64:79], v[128:131], v[8:11], 0
    v_mfma_f32_32x32x16_bf16 v[80:95], v[128:131], v[12:15], 0
    v_mfma_f32_32x32x8_bf16 v[64:79], v[136:137], v[16:17], v[64:79]
    v_mfma_f32_32x32x8_bf16 v[80:95], v[136:137], v[18:19], v[80:95]
    s_nop 11
    v_max3_f32 v24, v24, v64, v65
    v_max3_f32 v24, v24, v66, v67
    v_max3_f32 v24, v24, v68, v69
    v_max3_f32 v24, v24, v70, v71
    v_max3_f32 v24, v24, v72, v73
    v_max3_f32 v24, v24, v74, v75
    v_max3_f32 v24, v24, v76, v77
    v_max3_f32 v24, v24, v78, v79
    v_max3_f32 v25, v25, v80, v81
    v_max3_f32 v25, v25, v82, v83
    v_max3_f32 v25, v25, v84, v85
    v_max3_f32 v25, v25, v86, v87
    v_max3_f32 v25, v25, v88, v89
    v_max3_f32 v25, v25, v90, v91
    v_max3_f32 v25, v25, v92, v93
    v_max3_f32 v25, v25, v94, v95
    ds_read_b128 v[128:131], v26 offset:1024
    s_mov_b64 exec, s[54:55]
    ds_read_b64 v[136:137], v27 offset:256
    s_mov_b64 exec, -1
    s_waitcnt lgkmcnt(0)
    v_mfma_f32_32x32x16_bf16 v[64:79], v[128:131], v[8:11], 0
    v_mfma_f32_32x32x16_bf16 v[80:95], v[128:131], v[12:15], 0
    v_mfma_f32_32x32x8_bf16 v[64:79], v[136:137], v[16:17], v[64:79]
    v_mfma_f32_32x32x8_bf16 v[80:95], v[136:137], v[18:19], v[80:95]
    s_nop 11
    v_max3_f32 v24, v24, v64, v65
    v_max3_f32 v24, v24, v66, v67
    v_max3_f32 v24, v24, v68, v69
    v_max3_f32 v24, v24, v70, v71
    v_max3_f32 v24, v24, v72, v73
    v_max3_f32 v24, v24, v74, v75
    v_max3_f32 v24, v24, v76, v77
    v_max3_f32 v24, v24, v78, v79
    v_max3_f32 v25, v25, v80, v81
    v_max3_f32 v25, v25, v82, v83
    v_max3_f32 v25, v25, v84, v85
    v_max3_f32 v25, v25, v86, v87
    v_max3_f32 v25, v25, v88, v89
    v_max3_f32 v25, v25, v90, v91
    v_max3_f32 v25, v25, v92, v93
    v_max3_f32 v25, v25, v94, v95
    ds_read_b128 v[128:131], v26 offset:2048
    s_mov_b64 exec, s[54:55]
    ds_read_b64 v[136:137], v27 offset:512
    s_mov_b64 exec, -1
    s_waitcnt lgkmcnt(0)
    v_mfma_f32_32x32x16_bf16 v[64:79], v[128:131], v[8:11], 0
    v_mfma_f32_32x32x16_bf16 v[80:95], v[128:131], v[12:15], 0
    v_mfma_f32_32x32x8_bf16 v[64:79], v[136:137], v[16:17], v[64:79]
    v_mfma_f32_32x32x8_bf16 v[80:95], v[136:137], v[18:19], v[80:95]
    s_nop 11
    v_max3_f32 v24, v24, v64, v65
    v_max3_f32 v24, v24, v66, v67
    v_max3_f32 v24, v24, v68, v69
    v_max3_f32 v24, v24, v70, v71
    v_max3_f32 v24, v24, v72, v73
    v_max3_f32 v24, v24, v74, v75
    v_max3_f32 v24, v24, v76, v77
    v_max3_f32 v24, v24, v78, v79
    v_max3_f32 v25, v25, v80, v81
    v_max3_f32 v25, v25, v82, v83
    v_max3_f32 v25, v25, v84, v85
    v_max3_f32 v25, v25, v86, v87
    v_max3_f32 v25, v25, v88, v89
    v_max3_f32 v25, v25, v90, v91
    v_max3_f32 v25, v25, v92, v93
    v_max3_f32 v25, v25, v94, v95
    ds_read_b128 v[128:131], v26 offset:3072
    s_mov_b64 exec, s[54:55]
    ds_read_b64 v[136:137], v27 offset:768
    s_mov_b64 exec, -1
    s_waitcnt lgkmcnt(0)
    v_mfma_f32_32x32x16_bf16 v[64:79], v[128:131], v[8:11], 0
    v_mfma_f32_32x32x16_bf16 v[80:95], v[128:131], v[12:15], 0
    v_mfma_f32_32x32x8_bf16 v[64:79], v[136:137], v[16:17], v[64:79]
    v_mfma_f32_32x32x8_bf16 v[80:95], v[136:137], v[18:19], v[80:95]
    s_nop 11
    v_max3_f32 v24, v24, v64, v65
    v_max3_f32 v24, v24, v66, v67
    v_max3_f32 v24, v24, v68, v69
    v_max3_f32 v24, v24, v70, v71
    v_max3_f32 v24, v24, v72, v73
    v_max3_f32 v24, v24, v74, v75
    v_max3_f32 v24, v24, v76, v77
    v_max3_f32 v24, v24, v78, v79
    v_max3_f32 v25, v25, v80, v81
    v_max3_f32 v25, v25, v82, v83
    v_max3_f32 v25, v25, v84, v85
    v_max3_f32 v25, v25, v86, v87
    v_max3_f32 v25, v25, v88, v89
    v_max3_f32 v25, v25, v90, v91
    v_max3_f32 v25, v25, v92, v93
    v_max3_f32 v25, v25, v94, v95
    v_add_u32 v26, 10240, v26
    v_add_u32 v27, 10240, v27
    s_add_u32 s43, s43, 1
    s_cmp_lt_u32 s43, 16
    s_cbranch_scc1 P2_mx
    v_cmp_lt_u32 vcc, 31, v1
    v_mov_b32 v26, v24
    s_nop 1
    v_permlane32_swap_b32 v26, v24
    s_nop 1
    v_max_f32 v26, v26, v24
    v_cvt_pk_bf16_f32 v27, -v26, 0
    v_lshlrev_b32 v28, 16, v27
    v_sub_f32 v28, -v26, v28
    v_cvt_pk_bf16_f32 v27, -v26, v28
    v_and_b32 v29, 0xffff0000, v27
    v_sub_f32 v28, v28, v29
    v_cvt_pk_bf16_f32 v28, v28, 0
    v_cndmask_b32 v16, v16, v27, vcc
    v_cndmask_b32 v17, v17, v28, vcc
    v_mov_b32 v26, v25
    s_nop 1
    v_permlane32_swap_b32 v26, v25
    s_nop 1
    v_max_f32 v26, v26, v25
    v_cvt_pk_bf16_f32 v27, -v26, 0
    v_lshlrev_b32 v28, 16, v27
    v_sub_f32 v28, -v26, v28
    v_cvt_pk_bf16_f32 v27, -v26, v28
    v_and_b32 v29, 0xffff0000, v27
    v_sub_f32 v28, v28, v29
    v_cvt_pk_bf16_f32 v28, v28, 0
    v_cndmask_b32 v18, v18, v27, vcc
    v_cndmask_b32 v19, v19, v28, vcc
P2_start:
    s_waitcnt vmcnt(0)
    s_barrier
    ds_read_b128 v[128:131], v2 offset:0
    ds_read_b128 v[132:135], v2 offset:1024
    s_mov_b64 exec, s[54:55]
    ds_read2_b64 v[136:139], v3 offset0:0 offset1:32
    s_mov_b64 exec, s[52:53]
    ds_read_b128 v[144:147], v4 offset:0
    ds_read_b128 v[148:151], v4 offset:640
    s_mov_b64 exec, -1
    s_lshl_b32 s58, s3, 10
    s_add_u32 s58, s58, 24576
    s_add_u32 s44, s58, s50
    s_mov_b32 m0, s58
    s_add_u32 s58, s58, 8192
    buffer_load_dwordx4 v5, s[32:35], s44 offen sc1 lds
    s_add_u32 s44, s58, s50
    s_mov_b32 m0, s58
    s_add_u32 s58, s58, 8192
    buffer_load_dwordx4 v5, s[32:35], s44 offen sc1 lds
    s_waitcnt lgkmcnt(0)
    v_mfma_f32_32x32x16_bf16 v[64:79], v[128:131], v[8:11], 0
    v_mfma_f32_32x32x16_bf16 v[80:95], v[128:131], v[12:15], 0
    v_mfma_f32_32x32x8_bf16 v[64:79], v[136:137], v[16:17], v[64:79]
    v_mfma_f32_32x32x8_bf16 v[80:95], v[136:137], v[18:19], v[80:95]
    s_nop 10
    v_exp_f32 v64, v64
    v_exp_f32 v65, v65
    v_exp_f32 v66, v66
    v_exp_f32 v67, v67
    v_smfmac_f32_32x32x32_bf16 v[48:63], v[156:159], v[120:127], v20
    s_waitcnt lgkmcnt(0)
    ds_read_b128 v[128:131], v2 offset:2048
    v_exp_f32 v68, v68
    v_exp_f32 v69, v69
    v_exp_f32 v70, v70
    v_exp_f32 v71, v71
    v_mfma_f32_32x32x16_bf16 v[96:111], v[132:135], v[8:11], 0
    s_mov_b64 exec, s[52:53]
    ds_read_b128 v[152:155], v4 offset:1280
    ds_read_b128 v[156:159], v4 offset:1920
    s_mov_b64 exec, s[54:55]
    ds_read2_b64 v[140:143], v3 offset0:64 offset1:96
    s_mov_b64 exec, -1
    v_exp_f32 v72, v72
    v_exp_f32 v73, v73
    v_exp_f32 v74, v74
    v_exp_f32 v75, v75
    v_smfmac_f32_32x32x32_bf16 v[32:47], v[144:147], v[64:71], v20
    s_add_u32 s44, s58, s50
    s_mov_b32 m0, s58
    s_add_u32 s58, s58, 8192
    buffer_load_dwordx4 v5, s[32:35], s44 offen sc1 lds
    v_exp_f32 v76, v76
    v_exp_f32 v77, v77
    v_exp_f32 v78, v78
    v_exp_f32 v79, v79
    v_mfma_f32_32x32x8_bf16 v[96:111], v[138:139], v[16:17], v[96:111]
    v_exp_f32 v80, v80
    v_exp_f32 v81, v81
    v_exp_f32 v82, v82
    v_exp_f32 v83, v83
    v_smfmac_f32_32x32x32_bf16 v[32:47], v[148:151], v[72:79], v20
    v_exp_f32 v84, v84
    v_exp_f32 v85, v85
    v_exp_f32 v86, v86
    v_exp_f32 v87, v87
    v_mfma_f32_32x32x16_bf16 v[112:127], v[132:135], v[12:15], 0
    s_add_u32 s44, s58, s50
    s_mov_b32 m0, s58
    s_add_u32 s58, s58, 8192
    buffer_load_dwordx4 v5, s[32:35], s44 offen sc1 lds
    v_exp_f32 v88, v88
    v_exp_f32 v89, v89
    v_exp_f32 v90, v90
    v_exp_f32 v91, v91
    v_smfmac_f32_32x32x32_bf16 v[48:63], v[144:147], v[80:87], v20
    v_exp_f32 v92, v92
    v_exp_f32 v93, v93
    v_exp_f32 v94, v94
    v_exp_f32 v95, v95
    v_mfma_f32_32x32x8_bf16 v[112:127], v[138:139], v[18:19], v[112:127]
    v_exp_f32 v96, v96
    v_exp_f32 v97, v97
    v_exp_f32 v98, v98
    v_exp_f32 v99, v99
    v_smfmac_f32_32x32x32_bf16 v[48:63], v[148:151], v[88:95], v20
    s_waitcnt lgkmcnt(0)
    ds_read_b128 v[132:135], v2 offset:3072
    v_exp_f32 v100, v100
    v_exp_f32 v101, v101
    v_exp_f32 v102, v102
    v_exp_f32 v103, v103
    v_mfma_f32_32x32x16_bf16 v[64:79], v[128:131], v[8:11], 0
    s_mov_b64 exec, s[52:53]
    ds_read_b128 v[144:147], v4 offset:2560
    ds_read_b128 v[148:151], v4 offset:3200
    s_mov_b64 exec, -1
    v_exp_f32 v104, v104
    v_exp_f32 v105, v105
    v_exp_f32 v106, v106
    v_exp_f32 v107, v107
    v_smfmac_f32_32x32x32_bf16 v[32:47], v[152:155], v[96:103], v20
    s_add_u32 s44, s58, s50
    s_mov_b32 m0, s58
    s_add_u32 s58, s58, 8192
    buffer_load_dwordx4 v5, s[32:35], s44 offen sc1 lds
    v_exp_f32 v108, v108
    v_exp_f32 v109, v109
    v_exp_f32 v110, v110
    v_exp_f32 v111, v111
    v_mfma_f32_32x32x8_bf16 v[64:79], v[140:141], v[16:17], v[64:79]
    v_exp_f32 v112, v112
    v_exp_f32 v113, v113
    v_exp_f32 v114, v114
    v_exp_f32 v115, v115
    v_smfmac_f32_32x32x32_bf16 v[32:47], v[156:159], v[104:111], v20
    v_exp_f32 v116, v116
    v_exp_f32 v117, v117
    v_exp_f32 v118, v118
    v_exp_f32 v119, v119
    v_mfma_f32_32x32x16_bf16 v[80:95], v[128:131], v[12:15], 0
    s_add_u32 s44, s58, s50
    s_mov_b32 m0, s58
    s_add_u32 s58, s58, 8192
    buffer_load_dwordx4 v5, s[32:35], s44 offen sc1 lds
    v_exp_f32 v120, v120
    v_exp_f32 v121, v121
    v_exp_f32 v122, v122
    v_exp_f32 v123, v123
    v_smfmac_f32_32x32x32_bf16 v[48:63], v[152:155], v[112:119], v20
    v_exp_f32 v124, v124
    v_exp_f32 v125, v125
    v_exp_f32 v126, v126
    v_exp_f32 v127, v127
    v_mfma_f32_32x32x8_bf16 v[80:95], v[140:141], v[18:19], v[80:95]
    v_exp_f32 v64, v64
    v_exp_f32 v65, v65
    v_exp_f32 v66, v66
    v_exp_f32 v67, v67
    v_smfmac_f32_32x32x32_bf16 v[48:63], v[156:159], v[120:127], v20
    s_waitcnt lgkmcnt(0)
    s_waitcnt vmcnt(4)
    s_barrier
    v_add_u32 v3, 20480, v3
    ds_read_b128 v[128:131], v2 offset:20480
    v_exp_f32 v68, v68
    v_exp_f32 v69, v69
    v_exp_f32 v70, v70
    v_exp_f32 v71, v71
    v_mfma_f32_32x32x16_bf16 v[96:111], v[132:135], v[8:11], 0
    s_mov_b64 exec, s[52:53]
    ds_read_b128 v[152:155], v4 offset:3840
    ds_read_b128 v[156:159], v4 offset:4480
    s_mov_b64 exec, s[54:55]
    ds_read2_b64 v[136:139], v3 offset0:0 offset1:32
    s_mov_b64 exec, -1
    v_exp_f32 v72, v72
    v_exp_f32 v73, v73
    v_exp_f32 v74, v74
    v_exp_f32 v75, v75
    v_smfmac_f32_32x32x32_bf16 v[32:47], v[144:147], v[64:71], v20
    s_add_u32 s44, s58, s50
    s_mov_b32 m0, s58
    s_add_u32 s58, s58, 8192
    buffer_load_dwordx4 v5, s[32:35], s44 offen sc1 lds
    v_exp_f32 v76, v76
    v_exp_f32 v77, v77
    v_exp_f32 v78, v78
    v_exp_f32 v79, v79
    v_mfma_f32_32x32x8_bf16 v[96:111], v[142:143], v[16:17], v[96:111]
    v_exp_f32 v80, v80
    v_exp_f32 v81, v81
    v_exp_f32 v82, v82
    v_exp_f32 v83, v83
    v_smfmac_f32_32x32x32_bf16 v[32:47], v[148:151], v[72:79], v20
    v_exp_f32 v84, v84
    v_exp_f32 v85, v85
    v_exp_f32 v86, v86
    v_exp_f32 v87, v87
    v_mfma_f32_32x32x16_bf16 v[112:127], v[132:135], v[12:15], 0
    s_add_u32 s44, s58, s50
    s_mov_b32 m0, s58
    s_add_u32 s58, s58, 8192
    buffer_load_dwordx4 v5, s[32:35], s44 offen sc1 lds
    v_exp_f32 v88, v88
    v_exp_f32 v89, v89
    v_exp_f32 v90, v90
    v_exp_f32 v91, v91
    v_smfmac_f32_32x32x32_bf16 v[48:63], v[144:147], v[80:87], v20
    v_exp_f32 v92, v92
    v_exp_f32 v93, v93
    v_exp_f32 v94, v94
    v_exp_f32 v95, v95
    v_mfma_f32_32x32x8_bf16 v[112:127], v[142:143], v[18:19], v[112:127]
    v_exp_f32 v96, v96
    v_exp_f32 v97, v97
    v_exp_f32 v98, v98
    v_exp_f32 v99, v99
    v_smfmac_f32_32x32x32_bf16 v[48:63], v[148:151], v[88:95], v20
    s_waitcnt lgkmcnt(0)
    ds_read_b128 v[132:135], v2 offset:21504
    v_exp_f32 v100, v100
    v_exp_f32 v101, v101
    v_exp_f32 v102, v102
    v_exp_f32 v103, v103
    v_mfma_f32_32x32x16_bf16 v[64:79], v[128:131], v[8:11], 0
    s_mov_b64 exec, s[52:53]
    ds_read_b128 v[144:147], v4 offset:20480
    ds_read_b128 v[148:151], v4 offset:21120
    s_mov_b64 exec, -1
    v_exp_f32 v104, v104
    v_exp_f32 v105, v105
    v_exp_f32 v106, v106
    v_exp_f32 v107, v107
    v_smfmac_f32_32x32x32_bf16 v[32:47], v[152:155], v[96:103], v20
    s_add_u32 s44, s58, s50
    s_mov_b32 m0, s58
    s_add_u32 s58, s58, 8192
    buffer_load_dwordx4 v5, s[32:35], s44 offen sc1 lds
    v_exp_f32 v108, v108
    v_exp_f32 v109, v109
    v_exp_f32 v110, v110
    v_exp_f32 v111, v111
    v_mfma_f32_32x32x8_bf16 v[64:79], v[136:137], v[16:17], v[64:79]
    v_exp_f32 v112, v112
    v_exp_f32 v113, v113
    v_exp_f32 v114, v114
    v_exp_f32 v115, v115
    v_smfmac_f32_32x32x32_bf16 v[32:47], v[156:159], v[104:111], v20
    v_exp_f32 v116, v116
    v_exp_f32 v117, v117
    v_exp_f32 v118, v118
    v_exp_f32 v119, v119
    v_mfma_f32_32x32x16_bf16 v[80:95], v[128:131], v[12:15], 0
    s_add_u32 s44, s58, s50
    s_mov_b32 m0, s58
    s_add_u32 s58, s58, 8192
    buffer_load_dwordx4 v5, s[32:35], s44 offen sc1 lds
    v_exp_f32 v120, v120
    v_exp_f32 v121, v121
    v_exp_f32 v122, v122
    v_exp_f32 v123, v123
    v_smfmac_f32_32x32x32_bf16 v[48:63], v[152:155], v[112:119], v20
    v_exp_f32 v124, v124
    v_exp_f32 v125, v125
    v_exp_f32 v126, v126
    v_exp_f32 v127, v127
    v_mfma_f32_32x32x8_bf16 v[80:95], v[136:137], v[18:19], v[80:95]
    v_add_u32 v2, 20480, v2
    v_add_u32 v4, 20480, v4
    v_exp_f32 v64, v64
    v_exp_f32 v65, v65
    v_exp_f32 v66, v66
    v_exp_f32 v67, v67
    v_smfmac_f32_32x32x32_bf16 v[48:63], v[156:159], v[120:127], v20
    s_waitcnt lgkmcnt(0)
    ds_read_b128 v[128:131], v2 offset:2048
    v_exp_f32 v68, v68
    v_exp_f32 v69, v69
    v_exp_f32 v70, v70
    v_exp_f32 v71, v71
    v_mfma_f32_32x32x16_bf16 v[96:111], v[132:135], v[8:11], 0
    s_mov_b64 exec, s[52:53]
    ds_read_b128 v[152:155], v4 offset:1280
    ds_read_b128 v[156:159], v4 offset:1920
    s_mov_b64 exec, s[54:55]
    ds_read2_b64 v[140:143], v3 offset0:64 offset1:96
    s_mov_b64 exec, -1
    v_exp_f32 v72, v72
    v_exp_f32 v73, v73
    v_exp_f32 v74, v74
    v_exp_f32 v75, v75
    v_smfmac_f32_32x32x32_bf16 v[32:47], v[144:147], v[64:71], v20
    s_add_u32 s44, s58, s50
    s_mov_b32 m0, s58
    s_add_u32 s58, s58, 8192
    buffer_load_dwordx4 v5, s[32:35], s44 offen sc1 lds
    v_exp_f32 v76, v76
    v_exp_f32 v77, v77
    v_exp_f32 v78, v78
    v_exp_f32 v79, v79
    v_mfma_f32_32x32x8_bf16 v[96:111], v[138:139], v[16:17], v[96:111]
    v_exp_f32 v80, v80
    v_exp_f32 v81, v81
    v_exp_f32 v82, v82
    v_exp_f32 v83, v83
    v_smfmac_f32_32x32x32_bf16 v[32:47], v[148:151], v[72:79], v20
    v_exp_f32 v84, v84
    v_exp_f32 v85, v85
    v_exp_f32 v86, v86
    v_exp_f32 v87, v87
    v_mfma_f32_32x32x16_bf16 v[112:127], v[132:135], v[12:15], 0
    s_add_u32 s44, s58, s50
    s_mov_b32 m0, s58
    s_add_u32 s58, s58, 8192
    buffer_load_dwordx4 v5, s[32:35], s44 offen sc1 lds
    v_exp_f32 v88, v88
    v_exp_f32 v89, v89
    v_exp_f32 v90, v90
    v_exp_f32 v91, v91
    v_smfmac_f32_32x32x32_bf16 v[48:63], v[144:147], v[80:87], v20
    v_exp_f32 v92, v92
    v_exp_f32 v93, v93
    v_exp_f32 v94, v94
    v_exp_f32 v95, v95
    v_mfma_f32_32x32x8_bf16 v[112:127], v[138:139], v[18:19], v[112:127]
    v_exp_f32 v96, v96
    v_exp_f32 v97, v97
    v_exp_f32 v98, v98
    v_exp_f32 v99, v99
    v_smfmac_f32_32x32x32_bf16 v[48:63], v[148:151], v[88:95], v20
    s_waitcnt lgkmcnt(0)
    ds_read_b128 v[132:135], v2 offset:3072
    v_exp_f32 v100, v100
    v_exp_f32 v101, v101
    v_exp_f32 v102, v102
    v_exp_f32 v103, v103
    v_mfma_f32_32x32x16_bf16 v[64:79], v[128:131], v[8:11], 0
    s_mov_b64 exec, s[52:53]
    ds_read_b128 v[144:147], v4 offset:2560
    ds_read_b128 v[148:151], v4 offset:3200
    s_mov_b64 exec, -1
    v_exp_f32 v104, v104
    v_exp_f32 v105, v105
    v_exp_f32 v106, v106
    v_exp_f32 v107, v107
    v_smfmac_f32_32x32x32_bf16 v[32:47], v[152:155], v[96:103], v20
    s_add_u32 s44, s58, s50
    s_mov_b32 m0, s58
    s_add_u32 s58, s58, 8192
    buffer_load_dwordx4 v5, s[32:35], s44 offen sc1 lds
    v_exp_f32 v108, v108
    v_exp_f32 v109, v109
    v_exp_f32 v110, v110
    v_exp_f32 v111, v111
    v_mfma_f32_32x32x8_bf16 v[64:79], v[140:141], v[16:17], v[64:79]
    v_exp_f32 v112, v112
    v_exp_f32 v113, v113
    v_exp_f32 v114, v114
    v_exp_f32 v115, v115
    v_smfmac_f32_32x32x32_bf16 v[32:47], v[156:159], v[104:111], v20
    v_exp_f32 v116, v116
    v_exp_f32 v117, v117
    v_exp_f32 v118, v118
    v_exp_f32 v119, v119
    v_mfma_f32_32x32x16_bf16 v[80:95], v[128:131], v[12:15], 0
    s_add_u32 s44, s58, s50
    s_mov_b32 m0, s58
    s_add_u32 s58, s58, 8192
    buffer_load_dwordx4 v5, s[32:35], s44 offen sc1 lds
    v_exp_f32 v120, v120
    v_exp_f32 v121, v121
    v_exp_f32 v122, v122
    v_exp_f32 v123, v123
    v_smfmac_f32_32x32x32_bf16 v[48:63], v[152:155], v[112:119], v20
    v_exp_f32 v124, v124
    v_exp_f32 v125, v125
    v_exp_f32 v126, v126
    v_exp_f32 v127, v127
    v_mfma_f32_32x32x8_bf16 v[80:95], v[140:141], v[18:19], v[80:95]
    v_exp_f32 v64, v64
    v_exp_f32 v65, v65
    v_exp_f32 v66, v66
    v_exp_f32 v67, v67
    v_smfmac_f32_32x32x32_bf16 v[48:63], v[156:159], v[120:127], v20
    s_waitcnt lgkmcnt(0)
    s_waitcnt vmcnt(9)
    s_barrier
    v_add_u32 v3, 20480, v3
    ds_read_b128 v[128:131], v2 offset:20480
    v_exp_f32 v68, v68
    v_exp_f32 v69, v69
    v_exp_f32 v70, v70
    v_exp_f32 v71, v71
    v_mfma_f32_32x32x16_bf16 v[96:111], v[132:135], v[8:11], 0
    s_mov_b64 exec, s[52:53]
    ds_read_b128 v[152:155], v4 offset:3840
    ds_read_b128 v[156:159], v4 offset:4480
    s_mov_b64 exec, s[54:55]
    ds_read2_b64 v[136:139], v3 offset0:0 offset1:32
    s_mov_b64 exec, -1
    v_exp_f32 v72, v72
    v_exp_f32 v73, v73
    v_exp_f32 v74, v74
    v_exp_f32 v75, v75
    v_smfmac_f32_32x32x32_bf16 v[32:47], v[144:147], v[64:71], v20
    s_add_u32 s44, s58, s50
    s_mov_b32 m0, s58
    s_add_u32 s58, s58, 8192
    buffer_load_dwordx4 v5, s[32:35], s44 offen sc1 lds
    v_exp_f32 v76, v76
    v_exp_f32 v77, v77
    v_exp_f32 v78, v78
    v_exp_f32 v79, v79
    v_mfma_f32_32x32x8_bf16 v[96:111], v[142:143], v[16:17], v[96:111]
    v_exp_f32 v80, v80
    v_exp_f32 v81, v81
    v_exp_f32 v82, v82
    v_exp_f32 v83, v83
    v_smfmac_f32_32x32x32_bf16 v[32:47], v[148:151], v[72:79], v20
    v_exp_f32 v84, v84
    v_exp_f32 v85, v85
    v_exp_f32 v86, v86
    v_exp_f32 v87, v87
    v_mfma_f32_32x32x16_bf16 v[112:127], v[132:135], v[12:15], 0
    s_add_u32 s44, s58, s50
    s_mov_b32 m0, s58
    s_add_u32 s58, s58, 8192
    buffer_load_dwordx4 v5, s[32:35], s44 offen sc1 lds
    v_exp_f32 v88, v88
    v_exp_f32 v89, v89
    v_exp_f32 v90, v90
    v_exp_f32 v91, v91
    v_smfmac_f32_32x32x32_bf16 v[48:63], v[144:147], v[80:87], v20
    v_exp_f32 v92, v92
    v_exp_f32 v93, v93
    v_exp_f32 v94, v94
    v_exp_f32 v95, v95
    v_mfma_f32_32x32x8_bf16 v[112:127], v[142:143], v[18:19], v[112:127]
    v_exp_f32 v96, v96
    v_exp_f32 v97, v97
    v_exp_f32 v98, v98
    v_exp_f32 v99, v99
    v_smfmac_f32_32x32x32_bf16 v[48:63], v[148:151], v[88:95], v20
    s_waitcnt lgkmcnt(0)
    ds_read_b128 v[132:135], v2 offset:21504
    v_exp_f32 v100, v100
    v_exp_f32 v101, v101
    v_exp_f32 v102, v102
    v_exp_f32 v103, v103
    v_mfma_f32_32x32x16_bf16 v[64:79], v[128:131], v[8:11], 0
    s_mov_b64 exec, s[52:53]
    ds_read_b128 v[144:147], v4 offset:20480
    ds_read_b128 v[148:151], v4 offset:21120
    s_mov_b64 exec, -1
    v_exp_f32 v104, v104
    v_exp_f32 v105, v105
    v_exp_f32 v106, v106
    v_exp_f32 v107, v107
    v_smfmac_f32_32x32x32_bf16 v[32:47], v[152:155], v[96:103], v20
    s_add_u32 s44, s58, s50
    s_mov_b32 m0, s58
    s_add_u32 s58, s58, 8192
    buffer_load_dwordx4 v5, s[32:35], s44 offen sc1 lds
    v_exp_f32 v108, v108
    v_exp_f32 v109, v109
    v_exp_f32 v110, v110
    v_exp_f32 v111, v111
    v_mfma_f32_32x32x8_bf16 v[64:79], v[136:137], v[16:17], v[64:79]
    v_exp_f32 v112, v112
    v_exp_f32 v113, v113
    v_exp_f32 v114, v114
    v_exp_f32 v115, v115
    v_smfmac_f32_32x32x32_bf16 v[32:47], v[156:159], v[104:111], v20
    buffer_load_dwordx4 v[180:183], v170, s[64:67], s59 offen
    v_exp_f32 v116, v116
    v_exp_f32 v117, v117
    v_exp_f32 v118, v118
    v_exp_f32 v119, v119
    v_mfma_f32_32x32x16_bf16 v[80:95], v[128:131], v[12:15], 0
    v_exp_f32 v120, v120
    v_exp_f32 v121, v121
    v_exp_f32 v122, v122
    v_exp_f32 v123, v123
    v_smfmac_f32_32x32x32_bf16 v[48:63], v[152:155], v[112:119], v20
    buffer_load_dwordx4 v[184:187], v171, s[64:67], s59 offen
    v_exp_f32 v124, v124
    v_exp_f32 v125, v125
    v_exp_f32 v126, v126
    v_exp_f32 v127, v127
    v_mfma_f32_32x32x8_bf16 v[80:95], v[136:137], v[18:19], v[80:95]
    v_add_u32 v2, 20480, v2
    v_add_u32 v4, 20480, v4
    v_exp_f32 v64, v64
    v_exp_f32 v65, v65
    v_exp_f32 v66, v66
    v_exp_f32 v67, v67
    v_smfmac_f32_32x32x32_bf16 v[48:63], v[156:159], v[120:127], v20
    s_waitcnt lgkmcnt(0)
    ds_read_b128 v[128:131], v2 offset:2048
    v_exp_f32 v68, v68
    v_exp_f32 v69, v69
    v_exp_f32 v70, v70
    v_exp_f32 v71, v71
    v_mfma_f32_32x32x16_bf16 v[96:111], v[132:135], v[8:11], 0
    s_mov_b64 exec, s[52:53]
    ds_read_b128 v[152:155], v4 offset:1280
    ds_read_b128 v[156:159], v4 offset:1920
    s_mov_b64 exec, s[54:55]
    ds_read2_b64 v[140:143], v3 offset0:64 offset1:96
    s_mov_b64 exec, -1
    v_exp_f32 v72, v72
    v_exp_f32 v73, v73
    v_exp_f32 v74, v74
    v_exp_f32 v75, v75
    v_smfmac_f32_32x32x32_bf16 v[32:47], v[144:147], v[64:71], v20
    buffer_load_dwordx4 v[188:191], v172, s[64:67], s59 offen
    v_exp_f32 v76, v76
    v_exp_f32 v77, v77
    v_exp_f32 v78, v78
    v_exp_f32 v79, v79
    v_mfma_f32_32x32x8_bf16 v[96:111], v[138:139], v[16:17], v[96:111]
    v_exp_f32 v80, v80
    v_exp_f32 v81, v81
    v_exp_f32 v82, v82
    v_exp_f32 v83, v83
    v_smfmac_f32_32x32x32_bf16 v[32:47], v[148:151], v[72:79], v20
    buffer_load_dwordx4 v[192:195], v173, s[64:67], s59 offen
    v_exp_f32 v84, v84
    v_exp_f32 v85, v85
    v_exp_f32 v86, v86
    v_exp_f32 v87, v87
    v_mfma_f32_32x32x16_bf16 v[112:127], v[132:135], v[12:15], 0
    v_exp_f32 v88, v88
    v_exp_f32 v89, v89
    v_exp_f32 v90, v90
    v_exp_f32 v91, v91
    v_smfmac_f32_32x32x32_bf16 v[48:63], v[144:147], v[80:87], v20
    buffer_load_dwordx4 v[196:199], v174, s[64:67], s59 offen
    v_exp_f32 v92, v92
    v_exp_f32 v93, v93
    v_exp_f32 v94, v94
    v_exp_f32 v95, v95
    v_mfma_f32_32x32x8_bf16 v[112:127], v[138:139], v[18:19], v[112:127]
    v_exp_f32 v96, v96
    v_exp_f32 v97, v97
    v_exp_f32 v98, v98
    v_exp_f32 v99, v99
    v_smfmac_f32_32x32x32_bf16 v[48:63], v[148:151], v[88:95], v20
    s_waitcnt lgkmcnt(0)
    ds_read_b128 v[132:135], v2 offset:3072
    v_exp_f32 v100, v100
    v_exp_f32 v101, v101
    v_exp_f32 v102, v102
    v_exp_f32 v103, v103
    v_mfma_f32_32x32x16_bf16 v[64:79], v[128:131], v[8:11], 0
    s_mov_b64 exec, s[52:53]
    ds_read_b128 v[144:147], v4 offset:2560
    ds_read_b128 v[148:151], v4 offset:3200
    s_mov_b64 exec, -1
    v_exp_f32 v104, v104
    v_exp_f32 v105, v105
    v_exp_f32 v106, v106
    v_exp_f32 v107, v107
    v_smfmac_f32_32x32x32_bf16 v[32:47], v[152:155], v[96:103], v20
    v_exp_f32 v108, v108
    v_exp_f32 v109, v109
    v_exp_f32 v110, v110
    v_exp_f32 v111, v111
    v_mfma_f32_32x32x8_bf16 v[64:79], v[140:141], v[16:17], v[64:79]
    v_exp_f32 v112, v112
    v_exp_f32 v113, v113
    v_exp_f32 v114, v114
    v_exp_f32 v115, v115
    v_smfmac_f32_32x32x32_bf16 v[32:47], v[156:159], v[104:111], v20
    v_exp_f32 v116, v116
    v_exp_f32 v117, v117
    v_exp_f32 v118, v118
    v_exp_f32 v119, v119
    v_mfma_f32_32x32x16_bf16 v[80:95], v[128:131], v[12:15], 0
    v_exp_f32 v120, v120
    v_exp_f32 v121, v121
    v_exp_f32 v122, v122
    v_exp_f32 v123, v123
    v_smfmac_f32_32x32x32_bf16 v[48:63], v[152:155], v[112:119], v20
    v_exp_f32 v124, v124
    v_exp_f32 v125, v125
    v_exp_f32 v126, v126
    v_exp_f32 v127, v127
    v_mfma_f32_32x32x8_bf16 v[80:95], v[140:141], v[18:19], v[80:95]
    v_exp_f32 v64, v64
    v_exp_f32 v65, v65
    v_exp_f32 v66, v66
    v_exp_f32 v67, v67
    v_smfmac_f32_32x32x32_bf16 v[48:63], v[156:159], v[120:127], v20
    s_waitcnt lgkmcnt(0)
    s_waitcnt vmcnt(5)
    s_barrier
    v_add_u32 v3, 20480, v3
    ds_read_b128 v[128:131], v2 offset:20480
    v_exp_f32 v68, v68
    v_exp_f32 v69, v69
    v_exp_f32 v70, v70
    v_exp_f32 v71, v71
    v_mfma_f32_32x32x16_bf16 v[96:111], v[132:135], v[8:11], 0
    s_mov_b64 exec, s[52:53]
    ds_read_b128 v[152:155], v4 offset:3840
    ds_read_b128 v[156:159], v4 offset:4480
    s_mov_b64 exec, s[54:55]
    ds_read2_b64 v[136:139], v3 offset0:0 offset1:32
    s_mov_b64 exec, -1
    v_exp_f32 v72, v72
    v_exp_f32 v73, v73
    v_exp_f32 v74, v74
    v_exp_f32 v75, v75
    v_smfmac_f32_32x32x32_bf16 v[32:47], v[144:147], v[64:71], v20
    v_exp_f32 v76, v76
    v_exp_f32 v77, v77
    v_exp_f32 v78, v78
    v_exp_f32 v79, v79
    v_mfma_f32_32x32x8_bf16 v[96:111], v[142:143], v[16:17], v[96:111]
    v_exp_f32 v80, v80
    v_exp_f32 v81, v81
    v_exp_f32 v82, v82
    v_exp_f32 v83, v83
    v_smfmac_f32_32x32x32_bf16 v[32:47], v[148:151], v[72:79], v20
    s_mov_b64 exec, 0x1ffffff
    buffer_load_dword v165, v160, s[12:15], 0 offen
    s_mov_b64 exec, -1
    v_exp_f32 v84, v84
    v_exp_f32 v85, v85
    v_exp_f32 v86, v86
    v_exp_f32 v87, v87
    v_mfma_f32_32x32x16_bf16 v[112:127], v[132:135], v[12:15], 0
    v_exp_f32 v88, v88
    v_exp_f32 v89, v89
    v_exp_f32 v90, v90
    v_exp_f32 v91, v91
    v_smfmac_f32_32x32x32_bf16 v[48:63], v[144:147], v[80:87], v20
    v_exp_f32 v92, v92
    v_exp_f32 v93, v93
    v_exp_f32 v94, v94
    v_exp_f32 v95, v95
    v_mfma_f32_32x32x8_bf16 v[112:127], v[142:143], v[18:19], v[112:127]
    v_exp_f32 v96, v96
    v_exp_f32 v97, v97
    v_exp_f32 v98, v98
    v_exp_f32 v99, v99
    v_smfmac_f32_32x32x32_bf16 v[48:63], v[148:151], v[88:95], v20
    s_waitcnt lgkmcnt(0)
    ds_read_b128 v[132:135], v2 offset:21504
    v_exp_f32 v100, v100
    v_exp_f32 v101, v101
    v_exp_f32 v102, v102
    v_exp_f32 v103, v103
    v_mfma_f32_32x32x16_bf16 v[64:79], v[128:131], v[8:11], 0
    s_mov_b64 exec, s[52:53]
    ds_read_b128 v[144:147], v4 offset:20480
    ds_read_b128 v[148:151], v4 offset:21120
    s_mov_b64 exec, -1
    v_exp_f32 v104, v104
    v_exp_f32 v105, v105
    v_exp_f32 v106, v106
    v_exp_f32 v107, v107
    v_smfmac_f32_32x32x32_bf16 v[32:47], v[152:155], v[96:103], v20
    v_exp_f32 v108, v108
    v_exp_f32 v109, v109
    v_exp_f32 v110, v110
    v_exp_f32 v111, v111
    v_mfma_f32_32x32x8_bf16 v[64:79], v[136:137], v[16:17], v[64:79]
    v_exp_f32 v112, v112
    v_exp_f32 v113, v113
    v_exp_f32 v114, v114
    v_exp_f32 v115, v115
    v_smfmac_f32_32x32x32_bf16 v[32:47], v[156:159], v[104:111], v20
    s_mov_b64 exec, 0x3ff
    buffer_load_dword v166, v161, s[4:7], 0 offen
    s_mov_b64 exec, -1
    v_exp_f32 v116, v116
    v_exp_f32 v117, v117
    v_exp_f32 v118, v118
    v_exp_f32 v119, v119
    v_mfma_f32_32x32x16_bf16 v[80:95], v[128:131], v[12:15], 0
    v_exp_f32 v120, v120
    v_exp_f32 v121, v121
    v_exp_f32 v122, v122
    v_exp_f32 v123, v123
    v_smfmac_f32_32x32x32_bf16 v[48:63], v[152:155], v[112:119], v20
    v_exp_f32 v124, v124
    v_exp_f32 v125, v125
    v_exp_f32 v126, v126
    v_exp_f32 v127, v127
    v_mfma_f32_32x32x8_bf16 v[80:95], v[136:137], v[18:19], v[80:95]
    v_add_u32 v2, 20480, v2
    v_add_u32 v4, 20480, v4
    v_exp_f32 v64, v64
    v_exp_f32 v65, v65
    v_exp_f32 v66, v66
    v_exp_f32 v67, v67
    v_smfmac_f32_32x32x32_bf16 v[48:63], v[156:159], v[120:127], v20
    s_waitcnt lgkmcnt(0)
    ds_read_b128 v[128:131], v2 offset:2048
    v_exp_f32 v68, v68
    v_exp_f32 v69, v69
    v_exp_f32 v70, v70
    v_exp_f32 v71, v71
    v_mfma_f32_32x32x16_bf16 v[96:111], v[132:135], v[8:11], 0
    s_mov_b64 exec, s[52:53]
    ds_read_b128 v[152:155], v4 offset:1280
    ds_read_b128 v[156:159], v4 offset:1920
    s_mov_b64 exec, s[54:55]
    ds_read2_b64 v[140:143], v3 offset0:64 offset1:96
    s_mov_b64 exec, -1
    v_exp_f32 v72, v72
    v_exp_f32 v73, v73
    v_exp_f32 v74, v74
    v_exp_f32 v75, v75
    v_smfmac_f32_32x32x32_bf16 v[32:47], v[144:147], v[64:71], v20
    v_exp_f32 v76, v76
    v_exp_f32 v77, v77
    v_exp_f32 v78, v78
    v_exp_f32 v79, v79
    v_mfma_f32_32x32x8_bf16 v[96:111], v[138:139], v[16:17], v[96:111]
    v_exp_f32 v80, v80
    v_exp_f32 v81, v81
    v_exp_f32 v82, v82
    v_exp_f32 v83, v83
    v_smfmac_f32_32x32x32_bf16 v[32:47], v[148:151], v[72:79], v20
    v_exp_f32 v84, v84
    v_exp_f32 v85, v85
    v_exp_f32 v86, v86
    v_exp_f32 v87, v87
    v_mfma_f32_32x32x16_bf16 v[112:127], v[132:135], v[12:15], 0
    v_exp_f32 v88, v88
    v_exp_f32 v89, v89
    v_exp_f32 v90, v90
    v_exp_f32 v91, v91
    v_smfmac_f32_32x32x32_bf16 v[48:63], v[144:147], v[80:87], v20
    v_exp_f32 v92, v92
    v_exp_f32 v93, v93
    v_exp_f32 v94, v94
    v_exp_f32 v95, v95
    v_mfma_f32_32x32x8_bf16 v[112:127], v[138:139], v[18:19], v[112:127]
    v_exp_f32 v96, v96
    v_exp_f32 v97, v97
    v_exp_f32 v98, v98
    v_exp_f32 v99, v99
    v_smfmac_f32_32x32x32_bf16 v[48:63], v[148:151], v[88:95], v20
    s_waitcnt lgkmcnt(0)
    ds_read_b128 v[132:135], v2 offset:3072
    v_exp_f32 v100, v100
    v_exp_f32 v101, v101
    v_exp_f32 v102, v102
    v_exp_f32 v103, v103
    v_mfma_f32_32x32x16_bf16 v[64:79], v[128:131], v[8:11], 0
    s_mov_b64 exec, s[52:53]
    ds_read_b128 v[144:147], v4 offset:2560
    ds_read_b128 v[148:151], v4 offset:3200
    s_mov_b64 exec, -1
    v_exp_f32 v104, v104
    v_exp_f32 v105, v105
    v_exp_f32 v106, v106
    v_exp_f32 v107, v107
    v_smfmac_f32_32x32x32_bf16 v[32:47], v[152:155], v[96:103], v20
    v_exp_f32 v108, v108
    v_exp_f32 v109, v109
    v_exp_f32 v110, v110
    v_exp_f32 v111, v111
    v_mfma_f32_32x32x8_bf16 v[64:79], v[140:141], v[16:17], v[64:79]
    v_exp_f32 v112, v112
    v_exp_f32 v113, v113
    v_exp_f32 v114, v114
    v_exp_f32 v115, v115
    v_smfmac_f32_32x32x32_bf16 v[32:47], v[156:159], v[104:111], v20
    v_exp_f32 v116, v116
    v_exp_f32 v117, v117
    v_exp_f32 v118, v118
    v_exp_f32 v119, v119
    v_mfma_f32_32x32x16_bf16 v[80:95], v[128:131], v[12:15], 0
    v_exp_f32 v120, v120
    v_exp_f32 v121, v121
    v_exp_f32 v122, v122
    v_exp_f32 v123, v123
    v_smfmac_f32_32x32x32_bf16 v[48:63], v[152:155], v[112:119], v20
    v_exp_f32 v124, v124
    v_exp_f32 v125, v125
    v_exp_f32 v126, v126
    v_exp_f32 v127, v127
    v_mfma_f32_32x32x8_bf16 v[80:95], v[140:141], v[18:19], v[80:95]
    v_exp_f32 v64, v64
    v_exp_f32 v65, v65
    v_exp_f32 v66, v66
    v_exp_f32 v67, v67
    v_smfmac_f32_32x32x32_bf16 v[48:63], v[156:159], v[120:127], v20
    s_waitcnt lgkmcnt(0)
    s_cmp_lt_u32 s3, 4
    s_cbranch_scc1 P2_s3
P2_s3r:
    s_barrier
    v_add_u32 v3, 20480, v3
    ds_read_b128 v[128:131], v2 offset:20480
    v_exp_f32 v68, v68
    v_exp_f32 v69, v69
    v_exp_f32 v70, v70
    v_exp_f32 v71, v71
    v_mfma_f32_32x32x16_bf16 v[96:111], v[132:135], v[8:11], 0
    s_mov_b64 exec, s[52:53]
    ds_read_b128 v[152:155], v4 offset:3840
    ds_read_b128 v[156:159], v4 offset:4480
    s_mov_b64 exec, s[54:55]
    ds_read2_b64 v[136:139], v3 offset0:0 offset1:32
    s_mov_b64 exec, -1
    v_exp_f32 v72, v72
    v_exp_f32 v73, v73
    v_exp_f32 v74, v74
    v_exp_f32 v75, v75
    v_smfmac_f32_32x32x32_bf16 v[32:47], v[144:147], v[64:71], v20
    v_exp_f32 v76, v76
    v_exp_f32 v77, v77
    v_exp_f32 v78, v78
    v_exp_f32 v79, v79
    v_mfma_f32_32x32x8_bf16 v[96:111], v[142:143], v[16:17], v[96:111]
    s_waitcnt vmcnt(0)
    buffer_store_dwordx4 v[180:183], v175, s[32:35], s60 offen offset:0 sc1
    v_exp_f32 v80, v80
    v_exp_f32 v81, v81
    v_exp_f32 v82, v82
    v_exp_f32 v83, v83
    v_smfmac_f32_32x32x32_bf16 v[32:47], v[148:151], v[72:79], v20
    v_exp_f32 v84, v84
    v_exp_f32 v85, v85
    v_exp_f32 v86, v86
    v_exp_f32 v87, v87
    v_mfma_f32_32x32x16_bf16 v[112:127], v[132:135], v[12:15], 0
    buffer_store_dwordx4 v[184:187], v175, s[32:35], s60 offen offset:1024 sc1
    v_exp_f32 v88, v88
    v_exp_f32 v89, v89
    v_exp_f32 v90, v90
    v_exp_f32 v91, v91
    v_smfmac_f32_32x32x32_bf16 v[48:63], v[144:147], v[80:87], v20
    v_exp_f32 v92, v92
    v_exp_f32 v93, v93
    v_exp_f32 v94, v94
    v_exp_f32 v95, v95
    v_mfma_f32_32x32x8_bf16 v[112:127], v[142:143], v[18:19], v[112:127]
    buffer_store_dwordx4 v[188:191], v175, s[32:35], s60 offen offset:2048 sc1
    v_exp_f32 v96, v96
    v_exp_f32 v97, v97
    v_exp_f32 v98, v98
    v_exp_f32 v99, v99
    v_smfmac_f32_32x32x32_bf16 v[48:63], v[148:151], v[88:95], v20
    s_waitcnt lgkmcnt(0)
    ds_read_b128 v[132:135], v2 offset:21504
    v_exp_f32 v100, v100
    v_exp_f32 v101, v101
    v_exp_f32 v102, v102
    v_exp_f32 v103, v103
    v_mfma_f32_32x32x16_bf16 v[64:79], v[128:131], v[8:11], 0
    s_mov_b64 exec, s[52:53]
    ds_read_b128 v[144:147], v4 offset:20480
    ds_read_b128 v[148:151], v4 offset:21120
    s_mov_b64 exec, -1
    v_exp_f32 v104, v104
    v_exp_f32 v105, v105
    v_exp_f32 v106, v106
    v_exp_f32 v107, v107
    v_smfmac_f32_32x32x32_bf16 v[32:47], v[152:155], v[96:103], v20
    buffer_store_dwordx4 v[192:195], v176, s[32:35], s60 offen offset:3072 sc1
    v_exp_f32 v108, v108
    v_exp_f32 v109, v109
    v_exp_f32 v110, v110
    v_exp_f32 v111, v111
    v_mfma_f32_32x32x8_bf16 v[64:79], v[136:137], v[16:17], v[64:79]
    v_exp_f32 v112, v112
    v_exp_f32 v113, v113
    v_exp_f32 v114, v114
    v_exp_f32 v115, v115
    v_smfmac_f32_32x32x32_bf16 v[32:47], v[156:159], v[104:111], v20
    buffer_store_dwordx4 v[196:199], v177, s[32:35], s60 offen offset:0 sc1
    v_exp_f32 v116, v116
    v_exp_f32 v117, v117
    v_exp_f32 v118, v118
    v_exp_f32 v119, v119
    v_mfma_f32_32x32x16_bf16 v[80:95], v[128:131], v[12:15], 0
    v_exp_f32 v120, v120
    v_exp_f32 v121, v121
    v_exp_f32 v122, v122
    v_exp_f32 v123, v123
    v_smfmac_f32_32x32x32_bf16 v[48:63], v[152:155], v[112:119], v20
    v_exp_f32 v124, v124
    v_exp_f32 v125, v125
    v_exp_f32 v126, v126
    v_exp_f32 v127, v127
    v_mfma_f32_32x32x8_bf16 v[80:95], v[136:137], v[18:19], v[80:95]
    v_add_u32 v2, 20480, v2
    v_add_u32 v4, 20480, v4
    v_exp_f32 v64, v64
    v_exp_f32 v65, v65
    v_exp_f32 v66, v66
    v_exp_f32 v67, v67
    v_smfmac_f32_32x32x32_bf16 v[48:63], v[156:159], v[120:127], v20
    s_waitcnt lgkmcnt(0)
    ds_read_b128 v[128:131], v2 offset:2048
    v_exp_f32 v68, v68
    v_exp_f32 v69, v69
    v_exp_f32 v70, v70
    v_exp_f32 v71, v71
    v_mfma_f32_32x32x16_bf16 v[96:111], v[132:135], v[8:11], 0
    s_mov_b64 exec, s[52:53]
    ds_read_b128 v[152:155], v4 offset:1280
    ds_read_b128 v[156:159], v4 offset:1920
    s_mov_b64 exec, s[54:55]
    ds_read2_b64 v[140:143], v3 offset0:64 offset1:96
    s_mov_b64 exec, -1
    v_exp_f32 v72, v72
    v_exp_f32 v73, v73
    v_exp_f32 v74, v74
    v_exp_f32 v75, v75
    v_smfmac_f32_32x32x32_bf16 v[32:47], v[144:147], v[64:71], v20
    v_exp_f32 v76, v76
    v_exp_f32 v77, v77
    v_exp_f32 v78, v78
    v_exp_f32 v79, v79
    v_mfma_f32_32x32x8_bf16 v[96:111], v[138:139], v[16:17], v[96:111]
    v_exp_f32 v80, v80
    v_exp_f32 v81, v81
    v_exp_f32 v82, v82
    v_exp_f32 v83, v83
    v_smfmac_f32_32x32x32_bf16 v[32:47], v[148:151], v[72:79], v20
    v_exp_f32 v84, v84
    v_exp_f32 v85, v85
    v_exp_f32 v86, v86
    v_exp_f32 v87, v87
    v_mfma_f32_32x32x16_bf16 v[112:127], v[132:135], v[12:15], 0
    v_exp_f32 v88, v88
    v_exp_f32 v89, v89
    v_exp_f32 v90, v90
    v_exp_f32 v91, v91
    v_smfmac_f32_32x32x32_bf16 v[48:63], v[144:147], v[80:87], v20
    v_exp_f32 v92, v92
    v_exp_f32 v93, v93
    v_exp_f32 v94, v94
    v_exp_f32 v95, v95
    v_mfma_f32_32x32x8_bf16 v[112:127], v[138:139], v[18:19], v[112:127]
    v_exp_f32 v96, v96
    v_exp_f32 v97, v97
    v_exp_f32 v98, v98
    v_exp_f32 v99, v99
    v_smfmac_f32_32x32x32_bf16 v[48:63], v[148:151], v[88:95], v20
    s_waitcnt lgkmcnt(0)
    ds_read_b128 v[132:135], v2 offset:3072
    v_exp_f32 v100, v100
    v_exp_f32 v101, v101
    v_exp_f32 v102, v102
    v_exp_f32 v103, v103
    v_mfma_f32_32x32x16_bf16 v[64:79], v[128:131], v[8:11], 0
    s_mov_b64 exec, s[52:53]
    ds_read_b128 v[144:147], v4 offset:2560
    ds_read_b128 v[148:151], v4 offset:3200
    s_mov_b64 exec, -1
    v_exp_f32 v104, v104
    v_exp_f32 v105, v105
    v_exp_f32 v106, v106
    v_exp_f32 v107, v107
    v_smfmac_f32_32x32x32_bf16 v[32:47], v[152:155], v[96:103], v20
    v_exp_f32 v108, v108
    v_exp_f32 v109, v109
    v_exp_f32 v110, v110
    v_exp_f32 v111, v111
    v_mfma_f32_32x32x8_bf16 v[64:79], v[140:141], v[16:17], v[64:79]
    v_exp_f32 v112, v112
    v_exp_f32 v113, v113
    v_exp_f32 v114, v114
    v_exp_f32 v115, v115
    v_smfmac_f32_32x32x32_bf16 v[32:47], v[156:159], v[104:111], v20
    v_exp_f32 v116, v116
    v_exp_f32 v117, v117
    v_exp_f32 v118, v118
    v_exp_f32 v119, v119
    v_mfma_f32_32x32x16_bf16 v[80:95], v[128:131], v[12:15], 0
    v_exp_f32 v120, v120
    v_exp_f32 v121, v121
    v_exp_f32 v122, v122
    v_exp_f32 v123, v123
    v_smfmac_f32_32x32x32_bf16 v[48:63], v[152:155], v[112:119], v20
    v_exp_f32 v124, v124
    v_exp_f32 v125, v125
    v_exp_f32 v126, v126
    v_exp_f32 v127, v127
    v_mfma_f32_32x32x8_bf16 v[80:95], v[140:141], v[18:19], v[80:95]
    v_exp_f32 v64, v64
    v_exp_f32 v65, v65
    v_exp_f32 v66, v66
    v_exp_f32 v67, v67
    v_smfmac_f32_32x32x32_bf16 v[48:63], v[156:159], v[120:127], v20
    s_waitcnt lgkmcnt(0)
    s_barrier
    v_add_u32 v3, 20480, v3
    ds_read_b128 v[128:131], v2 offset:20480
    v_exp_f32 v68, v68
    v_exp_f32 v69, v69
    v_exp_f32 v70, v70
    v_exp_f32 v71, v71
    v_mfma_f32_32x32x16_bf16 v[96:111], v[132:135], v[8:11], 0
    s_mov_b64 exec, s[52:53]
    ds_read_b128 v[152:155], v4 offset:3840
    ds_read_b128 v[156:159], v4 offset:4480
    s_mov_b64 exec, s[54:55]
    ds_read2_b64 v[136:139], v3 offset0:0 offset1:32
    s_mov_b64 exec, -1
    v_exp_f32 v72, v72
    v_exp_f32 v73, v73
    v_exp_f32 v74, v74
    v_exp_f32 v75, v75
    v_smfmac_f32_32x32x32_bf16 v[32:47], v[144:147], v[64:71], v20
    v_exp_f32 v76, v76
    v_exp_f32 v77, v77
    v_exp_f32 v78, v78
    v_exp_f32 v79, v79
    v_mfma_f32_32x32x8_bf16 v[96:111], v[142:143], v[16:17], v[96:111]
    v_exp_f32 v80, v80
    v_exp_f32 v81, v81
    v_exp_f32 v82, v82
    v_exp_f32 v83, v83
    v_smfmac_f32_32x32x32_bf16 v[32:47], v[148:151], v[72:79], v20
    v_exp_f32 v84, v84
    v_exp_f32 v85, v85
    v_exp_f32 v86, v86
    v_exp_f32 v87, v87
    v_mfma_f32_32x32x16_bf16 v[112:127], v[132:135], v[12:15], 0
    v_exp_f32 v88, v88
    v_exp_f32 v89, v89
    v_exp_f32 v90, v90
    v_exp_f32 v91, v91
    v_smfmac_f32_32x32x32_bf16 v[48:63], v[144:147], v[80:87], v20
    v_exp_f32 v92, v92
    v_exp_f32 v93, v93
    v_exp_f32 v94, v94
    v_exp_f32 v95, v95
    v_mfma_f32_32x32x8_bf16 v[112:127], v[142:143], v[18:19], v[112:127]
    v_exp_f32 v96, v96
    v_exp_f32 v97, v97
    v_exp_f32 v98, v98
    v_exp_f32 v99, v99
    v_smfmac_f32_32x32x32_bf16 v[48:63], v[148:151], v[88:95], v20
    s_waitcnt lgkmcnt(0)
    ds_read_b128 v[132:135], v2 offset:21504
    v_exp_f32 v100, v100
    v_exp_f32 v101, v101
    v_exp_f32 v102, v102
    v_exp_f32 v103, v103
    v_mfma_f32_32x32x16_bf16 v[64:79], v[128:131], v[8:11], 0
    s_mov_b64 exec, s[52:53]
    ds_read_b128 v[144:147], v4 offset:20480
    ds_read_b128 v[148:151], v4 offset:21120
    s_mov_b64 exec, -1
    v_exp_f32 v104, v104
    v_exp_f32 v105, v105
    v_exp_f32 v106, v106
    v_exp_f32 v107, v107
    v_smfmac_f32_32x32x32_bf16 v[32:47], v[152:155], v[96:103], v20
    v_exp_f32 v108, v108
    v_exp_f32 v109, v109
    v_exp_f32 v110, v110
    v_exp_f32 v111, v111
    v_mfma_f32_32x32x8_bf16 v[64:79], v[136:137], v[16:17], v[64:79]
    v_exp_f32 v112, v112
    v_exp_f32 v113, v113
    v_exp_f32 v114, v114
    v_exp_f32 v115, v115
    v_smfmac_f32_32x32x32_bf16 v[32:47], v[156:159], v[104:111], v20
    v_exp_f32 v116, v116
    v_exp_f32 v117, v117
    v_exp_f32 v118, v118
    v_exp_f32 v119, v119
    v_mfma_f32_32x32x16_bf16 v[80:95], v[128:131], v[12:15], 0
    v_exp_f32 v120, v120
    v_exp_f32 v121, v121
    v_exp_f32 v122, v122
    v_exp_f32 v123, v123
    v_smfmac_f32_32x32x32_bf16 v[48:63], v[152:155], v[112:119], v20
    v_exp_f32 v124, v124
    v_exp_f32 v125, v125
    v_exp_f32 v126, v126
    v_exp_f32 v127, v127
    v_mfma_f32_32x32x8_bf16 v[80:95], v[136:137], v[18:19], v[80:95]
    v_add_u32 v2, 20480, v2
    v_add_u32 v4, 20480, v4
    v_exp_f32 v64, v64
    v_exp_f32 v65, v65
    v_exp_f32 v66, v66
    v_exp_f32 v67, v67
    v_smfmac_f32_32x32x32_bf16 v[48:63], v[156:159], v[120:127], v20
    s_waitcnt lgkmcnt(0)
    ds_read_b128 v[128:131], v2 offset:2048
    v_exp_f32 v68, v68
    v_exp_f32 v69, v69
    v_exp_f32 v70, v70
    v_exp_f32 v71, v71
    v_mfma_f32_32x32x16_bf16 v[96:111], v[132:135], v[8:11], 0
    s_mov_b64 exec, s[52:53]
    ds_read_b128 v[152:155], v4 offset:1280
    ds_read_b128 v[156:159], v4 offset:1920
    s_mov_b64 exec, s[54:55]
    ds_read2_b64 v[140:143], v3 offset0:64 offset1:96
    s_mov_b64 exec, -1
    v_exp_f32 v72, v72
    v_exp_f32 v73, v73
    v_exp_f32 v74, v74
    v_exp_f32 v75, v75
    v_smfmac_f32_32x32x32_bf16 v[32:47], v[144:147], v[64:71], v20
    v_exp_f32 v76, v76
    v_exp_f32 v77, v77
    v_exp_f32 v78, v78
    v_exp_f32 v79, v79
    v_mfma_f32_32x32x8_bf16 v[96:111], v[138:139], v[16:17], v[96:111]
    v_exp_f32 v80, v80
    v_exp_f32 v81, v81
    v_exp_f32 v82, v82
    v_exp_f32 v83, v83
    v_smfmac_f32_32x32x32_bf16 v[32:47], v[148:151], v[72:79], v20
    v_exp_f32 v84, v84
    v_exp_f32 v85, v85
    v_exp_f32 v86, v86
    v_exp_f32 v87, v87
    v_mfma_f32_32x32x16_bf16 v[112:127], v[132:135], v[12:15], 0
    v_exp_f32 v88, v88
    v_exp_f32 v89, v89
    v_exp_f32 v90, v90
    v_exp_f32 v91, v91
    v_smfmac_f32_32x32x32_bf16 v[48:63], v[144:147], v[80:87], v20
    v_exp_f32 v92, v92
    v_exp_f32 v93, v93
    v_exp_f32 v94, v94
    v_exp_f32 v95, v95
    v_mfma_f32_32x32x8_bf16 v[112:127], v[138:139], v[18:19], v[112:127]
    v_exp_f32 v96, v96
    v_exp_f32 v97, v97
    v_exp_f32 v98, v98
    v_exp_f32 v99, v99
    v_smfmac_f32_32x32x32_bf16 v[48:63], v[148:151], v[88:95], v20
    s_waitcnt lgkmcnt(0)
    ds_read_b128 v[132:135], v2 offset:3072
    v_exp_f32 v100, v100
    v_exp_f32 v101, v101
    v_exp_f32 v102, v102
    v_exp_f32 v103, v103
    v_mfma_f32_32x32x16_bf16 v[64:79], v[128:131], v[8:11], 0
    s_mov_b64 exec, s[52:53]
    ds_read_b128 v[144:147], v4 offset:2560
    ds_read_b128 v[148:151], v4 offset:3200
    s_mov_b64 exec, -1
    v_exp_f32 v104, v104
    v_exp_f32 v105, v105
    v_exp_f32 v106, v106
    v_exp_f32 v107, v107
    v_smfmac_f32_32x32x32_bf16 v[32:47], v[152:155], v[96:103], v20
    v_exp_f32 v108, v108
    v_exp_f32 v109, v109
    v_exp_f32 v110, v110
    v_exp_f32 v111, v111
    v_mfma_f32_32x32x8_bf16 v[64:79], v[140:141], v[16:17], v[64:79]
    v_exp_f32 v112, v112
    v_exp_f32 v113, v113
    v_exp_f32 v114, v114
    v_exp_f32 v115, v115
    v_smfmac_f32_32x32x32_bf16 v[32:47], v[156:159], v[104:111], v20
    v_exp_f32 v116, v116
    v_exp_f32 v117, v117
    v_exp_f32 v118, v118
    v_exp_f32 v119, v119
    v_mfma_f32_32x32x16_bf16 v[80:95], v[128:131], v[12:15], 0
    v_exp_f32 v120, v120
    v_exp_f32 v121, v121
    v_exp_f32 v122, v122
    v_exp_f32 v123, v123
    v_smfmac_f32_32x32x32_bf16 v[48:63], v[152:155], v[112:119], v20
    v_exp_f32 v124, v124
    v_exp_f32 v125, v125
    v_exp_f32 v126, v126
    v_exp_f32 v127, v127
    v_mfma_f32_32x32x8_bf16 v[80:95], v[140:141], v[18:19], v[80:95]
    v_exp_f32 v64, v64
    v_exp_f32 v65, v65
    v_exp_f32 v66, v66
    v_exp_f32 v67, v67
    v_smfmac_f32_32x32x32_bf16 v[48:63], v[156:159], v[120:127], v20
    s_waitcnt lgkmcnt(0)
    s_waitcnt vmcnt(0)
    s_barrier
    s_cmp_lt_u32 s3, 4
    s_cbranch_scc1 P2_s5b
P2_s5br:
    v_add_u32 v3, 20480, v3
    ds_read_b128 v[128:131], v2 offset:20480
    v_exp_f32 v68, v68
    v_exp_f32 v69, v69
    v_exp_f32 v70, v70
    v_exp_f32 v71, v71
    v_mfma_f32_32x32x16_bf16 v[96:111], v[132:135], v[8:11], 0
    s_mov_b64 exec, s[52:53]
    ds_read_b128 v[152:155], v4 offset:3840
    ds_read_b128 v[156:159], v4 offset:4480
    s_mov_b64 exec, s[54:55]
    ds_read2_b64 v[136:139], v3 offset0:0 offset1:32
    s_mov_b64 exec, -1
    v_exp_f32 v72, v72
    v_exp_f32 v73, v73
    v_exp_f32 v74, v74
    v_exp_f32 v75, v75
    v_smfmac_f32_32x32x32_bf16 v[32:47], v[144:147], v[64:71], v20
    s_add_u32 m0, s94, 0
    s_nop 0
    buffer_load_dwordx4 v218, s[12:15], s61 offen lds
    v_exp_f32 v76, v76
    v_exp_f32 v77, v77
    v_exp_f32 v78, v78
    v_exp_f32 v79, v79
    v_mfma_f32_32x32x8_bf16 v[96:111], v[142:143], v[16:17], v[96:111]
    v_exp_f32 v80, v80
    v_exp_f32 v81, v81
    v_exp_f32 v82, v82
    v_exp_f32 v83, v83
    v_smfmac_f32_32x32x32_bf16 v[32:47], v[148:151], v[72:79], v20
    v_exp_f32 v84, v84
    v_exp_f32 v85, v85
    v_exp_f32 v86, v86
    v_exp_f32 v87, v87
    v_mfma_f32_32x32x16_bf16 v[112:127], v[132:135], v[12:15], 0
    s_add_u32 m0, s94, 1024
    s_nop 0
    buffer_load_dwordx4 v219, s[12:15], s61 offen lds
    v_exp_f32 v88, v88
    v_exp_f32 v89, v89
    v_exp_f32 v90, v90
    v_exp_f32 v91, v91
    v_smfmac_f32_32x32x32_bf16 v[48:63], v[144:147], v[80:87], v20
    v_exp_f32 v92, v92
    v_exp_f32 v93, v93
    v_exp_f32 v94, v94
    v_exp_f32 v95, v95
    v_mfma_f32_32x32x8_bf16 v[112:127], v[142:143], v[18:19], v[112:127]
    v_exp_f32 v96, v96
    v_exp_f32 v97, v97
    v_exp_f32 v98, v98
    v_exp_f32 v99, v99
    v_smfmac_f32_32x32x32_bf16 v[48:63], v[148:151], v[88:95], v20
    s_waitcnt lgkmcnt(0)
    ds_read_b128 v[132:135], v2 offset:21504
    v_exp_f32 v100, v100
    v_exp_f32 v101, v101
    v_exp_f32 v102, v102
    v_exp_f32 v103, v103
    v_mfma_f32_32x32x16_bf16 v[64:79], v[128:131], v[8:11], 0
    s_mov_b64 exec, s[52:53]
    ds_read_b128 v[144:147], v4 offset:20480
    ds_read_b128 v[148:151], v4 offset:21120
    s_mov_b64 exec, -1
    v_exp_f32 v104, v104
    v_exp_f32 v105, v105
    v_exp_f32 v106, v106
    v_exp_f32 v107, v107
    v_smfmac_f32_32x32x32_bf16 v[32:47], v[152:155], v[96:103], v20
    s_add_u32 m0, s94, 2048
    s_nop 0
    buffer_load_dwordx4 v220, s[12:15], s61 offen lds
    v_exp_f32 v108, v108
    v_exp_f32 v109, v109
    v_exp_f32 v110, v110
    v_exp_f32 v111, v111
    v_mfma_f32_32x32x8_bf16 v[64:79], v[136:137], v[16:17], v[64:79]
    v_exp_f32 v112, v112
    v_exp_f32 v113, v113
    v_exp_f32 v114, v114
    v_exp_f32 v115, v115
    v_smfmac_f32_32x32x32_bf16 v[32:47], v[156:159], v[104:111], v20
    v_exp_f32 v116, v116
    v_exp_f32 v117, v117
    v_exp_f32 v118, v118
    v_exp_f32 v119, v119
    v_mfma_f32_32x32x16_bf16 v[80:95], v[128:131], v[12:15], 0
    s_add_u32 m0, s94, 3072
    s_nop 0
    buffer_load_dwordx4 v221, s[12:15], s61 offen lds
    v_exp_f32 v120, v120
    v_exp_f32 v121, v121
    v_exp_f32 v122, v122
    v_exp_f32 v123, v123
    v_smfmac_f32_32x32x32_bf16 v[48:63], v[152:155], v[112:119], v20
    v_exp_f32 v124, v124
    v_exp_f32 v125, v125
    v_exp_f32 v126, v126
    v_exp_f32 v127, v127
    v_mfma_f32_32x32x8_bf16 v[80:95], v[136:137], v[18:19], v[80:95]
    v_add_u32 v2, 20480, v2
    v_add_u32 v4, 20480, v4
    v_exp_f32 v64, v64
    v_exp_f32 v65, v65
    v_exp_f32 v66, v66
    v_exp_f32 v67, v67
    v_smfmac_f32_32x32x32_bf16 v[48:63], v[156:159], v[120:127], v20
    s_waitcnt lgkmcnt(0)
    ds_read_b128 v[128:131], v2 offset:2048
    v_exp_f32 v68, v68
    v_exp_f32 v69, v69
    v_exp_f32 v70, v70
    v_exp_f32 v71, v71
    v_mfma_f32_32x32x16_bf16 v[96:111], v[132:135], v[8:11], 0
    s_mov_b64 exec, s[52:53]
    ds_read_b128 v[152:155], v4 offset:1280
    ds_read_b128 v[156:159], v4 offset:1920
    s_mov_b64 exec, s[54:55]
    ds_read2_b64 v[140:143], v3 offset0:64 offset1:96
    s_mov_b64 exec, -1
    v_exp_f32 v72, v72
    v_exp_f32 v73, v73
    v_exp_f32 v74, v74
    v_exp_f32 v75, v75
    v_smfmac_f32_32x32x32_bf16 v[32:47], v[144:147], v[64:71], v20
    s_add_u32 m0, s94, 4096
    s_nop 0
    buffer_load_dwordx4 v222, s[12:15], s61 offen lds
    v_exp_f32 v76, v76
    v_exp_f32 v77, v77
    v_exp_f32 v78, v78
    v_exp_f32 v79, v79
    v_mfma_f32_32x32x8_bf16 v[96:111], v[138:139], v[16:17], v[96:111]
    v_exp_f32 v80, v80
    v_exp_f32 v81, v81
    v_exp_f32 v82, v82
    v_exp_f32 v83, v83
    v_smfmac_f32_32x32x32_bf16 v[32:47], v[148:151], v[72:79], v20
    v_exp_f32 v84, v84
    v_exp_f32 v85, v85
    v_exp_f32 v86, v86
    v_exp_f32 v87, v87
    v_mfma_f32_32x32x16_bf16 v[112:127], v[132:135], v[12:15], 0
    v_exp_f32 v88, v88
    v_exp_f32 v89, v89
    v_exp_f32 v90, v90
    v_exp_f32 v91, v91
    v_smfmac_f32_32x32x32_bf16 v[48:63], v[144:147], v[80:87], v20
    v_exp_f32 v92, v92
    v_exp_f32 v93, v93
    v_exp_f32 v94, v94
    v_exp_f32 v95, v95
    v_mfma_f32_32x32x8_bf16 v[112:127], v[138:139], v[18:19], v[112:127]
    v_exp_f32 v96, v96
    v_exp_f32 v97, v97
    v_exp_f32 v98, v98
    v_exp_f32 v99, v99
    v_smfmac_f32_32x32x32_bf16 v[48:63], v[148:151], v[88:95], v20
    s_waitcnt lgkmcnt(0)
    ds_read_b128 v[132:135], v2 offset:3072
    v_exp_f32 v100, v100
    v_exp_f32 v101, v101
    v_exp_f32 v102, v102
    v_exp_f32 v103, v103
    v_mfma_f32_32x32x16_bf16 v[64:79], v[128:131], v[8:11], 0
    s_mov_b64 exec, s[52:53]
    ds_read_b128 v[144:147], v4 offset:2560
    ds_read_b128 v[148:151], v4 offset:3200
    s_mov_b64 exec, -1
    v_exp_f32 v104, v104
    v_exp_f32 v105, v105
    v_exp_f32 v106, v106
    v_exp_f32 v107, v107
    v_smfmac_f32_32x32x32_bf16 v[32:47], v[152:155], v[96:103], v20
    v_exp_f32 v108, v108
    v_exp_f32 v109, v109
    v_exp_f32 v110, v110
    v_exp_f32 v111, v111
    v_mfma_f32_32x32x8_bf16 v[64:79], v[140:141], v[16:17], v[64:79]
    v_exp_f32 v112, v112
    v_exp_f32 v113, v113
    v_exp_f32 v114, v114
    v_exp_f32 v115, v115
    v_smfmac_f32_32x32x32_bf16 v[32:47], v[156:159], v[104:111], v20
    v_exp_f32 v116, v116
    v_exp_f32 v117, v117
    v_exp_f32 v118, v118
    v_exp_f32 v119, v119
    v_mfma_f32_32x32x16_bf16 v[80:95], v[128:131], v[12:15], 0
    v_exp_f32 v120, v120
    v_exp_f32 v121, v121
    v_exp_f32 v122, v122
    v_exp_f32 v123, v123
    v_smfmac_f32_32x32x32_bf16 v[48:63], v[152:155], v[112:119], v20
    v_exp_f32 v124, v124
    v_exp_f32 v125, v125
    v_exp_f32 v126, v126
    v_exp_f32 v127, v127
    v_mfma_f32_32x32x8_bf16 v[80:95], v[140:141], v[18:19], v[80:95]
    v_exp_f32 v64, v64
    v_exp_f32 v65, v65
    v_exp_f32 v66, v66
    v_exp_f32 v67, v67
    v_smfmac_f32_32x32x32_bf16 v[48:63], v[156:159], v[120:127], v20
    s_waitcnt lgkmcnt(0)
    s_cmp_lt_u32 s3, 4
    s_cbranch_scc1 P2_s6
P2_s6r:
    s_barrier
    v_add_u32 v3, 20480, v3
    ds_read_b128 v[128:131], v2 offset:20480
    v_exp_f32 v68, v68
    v_exp_f32 v69, v69
    v_exp_f32 v70, v70
    v_exp_f32 v71, v71
    v_mfma_f32_32x32x16_bf16 v[96:111], v[132:135], v[8:11], 0
    s_mov_b64 exec, s[52:53]
    ds_read_b128 v[152:155], v4 offset:3840
    ds_read_b128 v[156:159], v4 offset:4480
    s_mov_b64 exec, s[54:55]
    ds_read2_b64 v[136:139], v3 offset0:0 offset1:32
    s_mov_b64 exec, -1
    v_exp_f32 v72, v72
    v_exp_f32 v73, v73
    v_exp_f32 v74, v74
    v_exp_f32 v75, v75
    v_smfmac_f32_32x32x32_bf16 v[32:47], v[144:147], v[64:71], v20
    s_add_u32 m0, s94, 40960
    s_nop 0
    buffer_load_dwordx4 v213, s[12:15], s42 offen lds
    v_exp_f32 v76, v76
    v_exp_f32 v77, v77
    v_exp_f32 v78, v78
    v_exp_f32 v79, v79
    v_mfma_f32_32x32x8_bf16 v[96:111], v[142:143], v[16:17], v[96:111]
    v_exp_f32 v80, v80
    v_exp_f32 v81, v81
    v_exp_f32 v82, v82
    v_exp_f32 v83, v83
    v_smfmac_f32_32x32x32_bf16 v[32:47], v[148:151], v[72:79], v20
    s_mov_b64 exec, 0x3ff
    buffer_load_dword v165, v162, s[32:35], 0 offen sc1
    s_mov_b64 exec, -1
    v_add_u32 v162, 1280, v162
    v_exp_f32 v84, v84
    v_exp_f32 v85, v85
    v_exp_f32 v86, v86
    v_exp_f32 v87, v87
    v_mfma_f32_32x32x16_bf16 v[112:127], v[132:135], v[12:15], 0
    v_exp_f32 v88, v88
    v_exp_f32 v89, v89
    v_exp_f32 v90, v90
    v_exp_f32 v91, v91
    v_smfmac_f32_32x32x32_bf16 v[48:63], v[144:147], v[80:87], v20
    s_add_u32 m0, s94, 41984
    s_nop 0
    buffer_load_dwordx4 v214, s[12:15], s42 offen lds
    v_exp_f32 v92, v92
    v_exp_f32 v93, v93
    v_exp_f32 v94, v94
    v_exp_f32 v95, v95
    v_mfma_f32_32x32x8_bf16 v[112:127], v[142:143], v[18:19], v[112:127]
    v_exp_f32 v96, v96
    v_exp_f32 v97, v97
    v_exp_f32 v98, v98
    v_exp_f32 v99, v99
    v_smfmac_f32_32x32x32_bf16 v[48:63], v[148:151], v[88:95], v20
    s_waitcnt lgkmcnt(0)
    ds_read_b128 v[132:135], v2 offset:21504
    v_exp_f32 v100, v100
    v_exp_f32 v101, v101
    v_exp_f32 v102, v102
    v_exp_f32 v103, v103
    v_mfma_f32_32x32x16_bf16 v[64:79], v[128:131], v[8:11], 0
    s_mov_b64 exec, s[52:53]
    ds_read_b128 v[144:147], v4 offset:20480
    ds_read_b128 v[148:151], v4 offset:21120
    s_mov_b64 exec, -1
    v_exp_f32 v104, v104
    v_exp_f32 v105, v105
    v_exp_f32 v106, v106
    v_exp_f32 v107, v107
    v_smfmac_f32_32x32x32_bf16 v[32:47], v[152:155], v[96:103], v20
    s_add_u32 m0, s94, 43008
    s_nop 0
    buffer_load_dwordx4 v215, s[12:15], s42 offen lds
    v_exp_f32 v108, v108
    v_exp_f32 v109, v109
    v_exp_f32 v110, v110
    v_exp_f32 v111, v111
    v_mfma_f32_32x32x8_bf16 v[64:79], v[136:137], v[16:17], v[64:79]
    v_exp_f32 v112, v112
    v_exp_f32 v113, v113
    v_exp_f32 v114, v114
    v_exp_f32 v115, v115
    v_smfmac_f32_32x32x32_bf16 v[32:47], v[156:159], v[104:111], v20
    s_mov_b64 exec, 0x3ff
    buffer_load_dword v165, v162, s[32:35], 0 offen sc1
    s_mov_b64 exec, -1
    v_add_u32 v162, 1280, v162
    v_exp_f32 v116, v116
    v_exp_f32 v117, v117
    v_exp_f32 v118, v118
    v_exp_f32 v119, v119
    v_mfma_f32_32x32x16_bf16 v[80:95], v[128:131], v[12:15], 0
    v_exp_f32 v120, v120
    v_exp_f32 v121, v121
    v_exp_f32 v122, v122
    v_exp_f32 v123, v123
    v_smfmac_f32_32x32x32_bf16 v[48:63], v[152:155], v[112:119], v20
    s_add_u32 m0, s94, 44032
    s_nop 0
    buffer_load_dwordx4 v216, s[12:15], s42 offen lds
    v_exp_f32 v124, v124
    v_exp_f32 v125, v125
    v_exp_f32 v126, v126
    v_exp_f32 v127, v127
    v_mfma_f32_32x32x8_bf16 v[80:95], v[136:137], v[18:19], v[80:95]
    v_add_u32 v2, 20480, v2
    v_add_u32 v4, 20480, v4
    v_exp_f32 v64, v64
    v_exp_f32 v65, v65
    v_exp_f32 v66, v66
    v_exp_f32 v67, v67
    v_smfmac_f32_32x32x32_bf16 v[48:63], v[156:159], v[120:127], v20
    s_waitcnt lgkmcnt(0)
    ds_read_b128 v[128:131], v2 offset:2048
    v_exp_f32 v68, v68
    v_exp_f32 v69, v69
    v_exp_f32 v70, v70
    v_exp_f32 v71, v71
    v_mfma_f32_32x32x16_bf16 v[96:111], v[132:135], v[8:11], 0
    s_mov_b64 exec, s[52:53]
    ds_read_b128 v[152:155], v4 offset:1280
    ds_read_b128 v[156:159], v4 offset:1920
    s_mov_b64 exec, s[54:55]
    ds_read2_b64 v[140:143], v3 offset0:64 offset1:96
    s_mov_b64 exec, -1
    v_exp_f32 v72, v72
    v_exp_f32 v73, v73
    v_exp_f32 v74, v74
    v_exp_f32 v75, v75
    v_smfmac_f32_32x32x32_bf16 v[32:47], v[144:147], v[64:71], v20
    s_add_u32 m0, s94, 45056
    s_nop 0
    buffer_load_dwordx4 v217, s[12:15], s42 offen lds
    v_exp_f32 v76, v76
    v_exp_f32 v77, v77
    v_exp_f32 v78, v78
    v_exp_f32 v79, v79
    v_mfma_f32_32x32x8_bf16 v[96:111], v[138:139], v[16:17], v[96:111]
    v_exp_f32 v80, v80
    v_exp_f32 v81, v81
    v_exp_f32 v82, v82
    v_exp_f32 v83, v83
    v_smfmac_f32_32x32x32_bf16 v[32:47], v[148:151], v[72:79], v20
    s_mov_b64 exec, 0x3ff
    buffer_load_dword v165, v162, s[32:35], 0 offen sc1
    s_mov_b64 exec, -1
    v_add_u32 v162, 1280, v162
    v_exp_f32 v84, v84
    v_exp_f32 v85, v85
    v_exp_f32 v86, v86
    v_exp_f32 v87, v87
    v_mfma_f32_32x32x16_bf16 v[112:127], v[132:135], v[12:15], 0
    v_exp_f32 v88, v88
    v_exp_f32 v89, v89
    v_exp_f32 v90, v90
    v_exp_f32 v91, v91
    v_smfmac_f32_32x32x32_bf16 v[48:63], v[144:147], v[80:87], v20
    v_exp_f32 v92, v92
    v_exp_f32 v93, v93
    v_exp_f32 v94, v94
    v_exp_f32 v95, v95
    v_mfma_f32_32x32x8_bf16 v[112:127], v[138:139], v[18:19], v[112:127]
    v_exp_f32 v96, v96
    v_exp_f32 v97, v97
    v_exp_f32 v98, v98
    v_exp_f32 v99, v99
    v_smfmac_f32_32x32x32_bf16 v[48:63], v[148:151], v[88:95], v20
    s_waitcnt lgkmcnt(0)
    ds_read_b128 v[132:135], v2 offset:3072
    v_exp_f32 v100, v100
    v_exp_f32 v101, v101
    v_exp_f32 v102, v102
    v_exp_f32 v103, v103
    v_mfma_f32_32x32x16_bf16 v[64:79], v[128:131], v[8:11], 0
    s_mov_b64 exec, s[52:53]
    ds_read_b128 v[144:147], v4 offset:2560
    ds_read_b128 v[148:151], v4 offset:3200
    s_mov_b64 exec, -1
    v_exp_f32 v104, v104
    v_exp_f32 v105, v105
    v_exp_f32 v106, v106
    v_exp_f32 v107, v107
    v_smfmac_f32_32x32x32_bf16 v[32:47], v[152:155], v[96:103], v20
    s_mov_b64 exec, 0x3ff
    buffer_load_dword v165, v162, s[32:35], 0 offen sc1
    s_mov_b64 exec, -1
    v_add_u32 v162, 1280, v162
    v_exp_f32 v108, v108
    v_exp_f32 v109, v109
    v_exp_f32 v110, v110
    v_exp_f32 v111, v111
    v_mfma_f32_32x32x8_bf16 v[64:79], v[140:141], v[16:17], v[64:79]
    v_exp_f32 v112, v112
    v_exp_f32 v113, v113
    v_exp_f32 v114, v114
    v_exp_f32 v115, v115
    v_smfmac_f32_32x32x32_bf16 v[32:47], v[156:159], v[104:111], v20
    v_exp_f32 v116, v116
    v_exp_f32 v117, v117
    v_exp_f32 v118, v118
    v_exp_f32 v119, v119
    v_mfma_f32_32x32x16_bf16 v[80:95], v[128:131], v[12:15], 0
    s_mov_b64 exec, 0x3ff
    buffer_load_dword v165, v162, s[32:35], 0 offen sc1
    s_mov_b64 exec, -1
    v_add_u32 v162, 1280, v162
    v_exp_f32 v120, v120
    v_exp_f32 v121, v121
    v_exp_f32 v122, v122
    v_exp_f32 v123, v123
    v_smfmac_f32_32x32x32_bf16 v[48:63], v[152:155], v[112:119], v20
    v_exp_f32 v124, v124
    v_exp_f32 v125, v125
    v_exp_f32 v126, v126
    v_exp_f32 v127, v127
    v_mfma_f32_32x32x8_bf16 v[80:95], v[140:141], v[18:19], v[80:95]
    v_exp_f32 v64, v64
    v_exp_f32 v65, v65
    v_exp_f32 v66, v66
    v_exp_f32 v67, v67
    v_smfmac_f32_32x32x32_bf16 v[48:63], v[156:159], v[120:127], v20
    s_waitcnt lgkmcnt(0)
    v_add_u32 v3, 20480, v3
    ds_read_b128 v[128:131], v2 offset:20480
    v_exp_f32 v68, v68
    v_exp_f32 v69, v69
    v_exp_f32 v70, v70
    v_exp_f32 v71, v71
    v_mfma_f32_32x32x16_bf16 v[96:111], v[132:135], v[8:11], 0
    s_mov_b64 exec, s[52:53]
    ds_read_b128 v[152:155], v4 offset:3840
    ds_read_b128 v[156:159], v4 offset:4480
    s_mov_b64 exec, s[54:55]
    ds_read2_b64 v[136:139], v3 offset0:0 offset1:32
    s_mov_b64 exec, -1
    v_exp_f32 v72, v72
    v_exp_f32 v73, v73
    v_exp_f32 v74, v74
    v_exp_f32 v75, v75
    v_smfmac_f32_32x32x32_bf16 v[32:47], v[144:147], v[64:71], v20
    s_mov_b64 exec, 0x3ff
    buffer_load_dword v165, v162, s[32:35], 0 offen sc1
    s_mov_b64 exec, -1
    v_add_u32 v162, 1280, v162
    v_exp_f32 v76, v76
    v_exp_f32 v77, v77
    v_exp_f32 v78, v78
    v_exp_f32 v79, v79
    v_mfma_f32_32x32x8_bf16 v[96:111], v[142:143], v[16:17], v[96:111]
    v_exp_f32 v80, v80
    v_exp_f32 v81, v81
    v_exp_f32 v82, v82
    v_exp_f32 v83, v83
    v_smfmac_f32_32x32x32_bf16 v[32:47], v[148:151], v[72:79], v20
    v_exp_f32 v84, v84
    v_exp_f32 v85, v85
    v_exp_f32 v86, v86
    v_exp_f32 v87, v87
    v_mfma_f32_32x32x16_bf16 v[112:127], v[132:135], v[12:15], 0
    v_exp_f32 v88, v88
    v_exp_f32 v89, v89
    v_exp_f32 v90, v90
    v_exp_f32 v91, v91
    v_smfmac_f32_32x32x32_bf16 v[48:63], v[144:147], v[80:87], v20
    v_exp_f32 v92, v92
    v_exp_f32 v93, v93
    v_exp_f32 v94, v94
    v_exp_f32 v95, v95
    v_mfma_f32_32x32x8_bf16 v[112:127], v[142:143], v[18:19], v[112:127]
    v_exp_f32 v96, v96
    v_exp_f32 v97, v97
    v_exp_f32 v98, v98
    v_exp_f32 v99, v99
    v_smfmac_f32_32x32x32_bf16 v[48:63], v[148:151], v[88:95], v20
    s_waitcnt lgkmcnt(0)
    ds_read_b128 v[132:135], v2 offset:21504
    v_exp_f32 v100, v100
    v_exp_f32 v101, v101
    v_exp_f32 v102, v102
    v_exp_f32 v103, v103
    v_mfma_f32_32x32x16_bf16 v[64:79], v[128:131], v[8:11], 0
    s_mov_b64 exec, s[52:53]
    ds_read_b128 v[144:147], v4 offset:20480
    ds_read_b128 v[148:151], v4 offset:21120
    s_mov_b64 exec, -1
    v_exp_f32 v104, v104
    v_exp_f32 v105, v105
    v_exp_f32 v106, v106
    v_exp_f32 v107, v107
    v_smfmac_f32_32x32x32_bf16 v[32:47], v[152:155], v[96:103], v20
    v_exp_f32 v108, v108
    v_exp_f32 v109, v109
    v_exp_f32 v110, v110
    v_exp_f32 v111, v111
    v_mfma_f32_32x32x8_bf16 v[64:79], v[136:137], v[16:17], v[64:79]
    v_exp_f32 v112, v112
    v_exp_f32 v113, v113
    v_exp_f32 v114, v114
    v_exp_f32 v115, v115
    v_smfmac_f32_32x32x32_bf16 v[32:47], v[156:159], v[104:111], v20
    v_exp_f32 v116, v116
    v_exp_f32 v117, v117
    v_exp_f32 v118, v118
    v_exp_f32 v119, v119
    v_mfma_f32_32x32x16_bf16 v[80:95], v[128:131], v[12:15], 0
    v_exp_f32 v120, v120
    v_exp_f32 v121, v121
    v_exp_f32 v122, v122
    v_exp_f32 v123, v123
    v_smfmac_f32_32x32x32_bf16 v[48:63], v[152:155], v[112:119], v20
    v_exp_f32 v124, v124
    v_exp_f32 v125, v125
    v_exp_f32 v126, v126
    v_exp_f32 v127, v127
    v_mfma_f32_32x32x8_bf16 v[80:95], v[136:137], v[18:19], v[80:95]
    v_add_u32 v2, 20480, v2
    v_add_u32 v4, 20480, v4
    s_nop 0
    v_smfmac_f32_32x32x32_bf16 v[48:63], v[156:159], v[120:127], v20
    s_setprio 0
P2_merge:
L_pad0:
    s_cbranch_execz L_pad4
    s_lshl_b32 s46, s40, 13
    v_add_u32 v21, s46, v5
    s_cmp_eq_u32 s41, 0
    s_cbranch_scc0 P2_fin
    s_nop 7
    ds_write_b128 v21, v[32:35] offset:0
    ds_write_b128 v21, v[36:39] offset:1024
    ds_write_b128 v21, v[40:43] offset:2048
    ds_write_b32 v21, v44 offset:3072
    ds_write_b128 v21, v[48:51] offset:4096
    ds_write_b128 v21, v[52:55] offset:5120
    ds_write_b128 v21, v[56:59] offset:6144
    ds_write_b32 v21, v60 offset:7168
    s_waitcnt lgkmcnt(0)
    s_and_b32 s44, s2, 7
    s_lshr_b32 s45, s2, 3
    s_lshr_b32 s38, s44, 0
    s_lshl_b32 s38, s38, 2
    s_and_b32 s39, s44, 0
    s_lshl_b32 s39, s39, 3
    s_and_b32 s44, s45, 3
    s_add_u32 s38, s38, s44
    s_lshr_b32 s44, s45, 2
    s_add_u32 s39, s39, s44
    s_and_b32 s42, s3, 3
    s_and_b32 s40, s3, 1
    s_lshr_b32 s41, s42, 1
    v_and_b32 v10, 15, v1
    v_lshrrev_b32 v11, 4, v1
    s_lshl_b32 s44, s38, 1
    s_add_u32 s44, s44, s40
    v_lshlrev_b32 v5, 4, v1
    s_mul_i32 s45, s44, 40960
    s_mul_i32 s46, s39, 160
    s_add_u32 s45, s45, s46
    s_add_u32 s46, s45, 20480
    v_mul_u32_u24 v7, 1280, v10
    v_lshl_add_u32 v7, v11, 3, v7
    s_lshl_b32 s47, s44, 9
    s_add_u32 s47, s47, 0x1000
    v_lshlrev_b32 v2, 4, v10
    buffer_load_dword v252, v2, s[32:35], s47 offen sc1
    buffer_load_dword v253, v2, s[32:35], s47 offen offset:256 sc1
    s_cmp_eq_u32 s41, 0
    s_cbranch_scc0 P3_rs1
    buffer_load_dwordx2 v[12:13], v7, s[4:7], s45 offen offset:0
    buffer_load_dwordx2 v[14:15], v7, s[4:7], s45 offen offset:32
    buffer_load_dwordx2 v[16:17], v7, s[4:7], s46 offen offset:0
    buffer_load_dwordx2 v[18:19], v7, s[4:7], s46 offen offset:32
    buffer_load_dwordx2 v[20:21], v7, s[4:7], s45 offen offset:128
    buffer_load_dwordx2 v[22:23], v7, s[4:7], s46 offen offset:128
    s_branch P3_rs2
P3_rs1:
    buffer_load_dwordx2 v[12:13], v7, s[4:7], s45 offen offset:64
    buffer_load_dwordx2 v[14:15], v7, s[4:7], s45 offen offset:96
    buffer_load_dwordx2 v[16:17], v7, s[4:7], s46 offen offset:64
    buffer_load_dwordx2 v[18:19], v7, s[4:7], s46 offen offset:96
P3_rs2:
    v_lshrrev_b32 v2, 1, v11
    v_lshlrev_b32 v2, 4, v2
    v_and_b32 v3, 1, v11
    v_lshl_add_u32 v2, v3, 2, v2
    v_bfe_u32 v3, v1, 2, 2
    v_add_u32 v2, v2, v3
    v_mul_u32_u24 v2, 160, v2
    v_and_b32 v3, 3, v1
    v_lshl_add_u32 v2, v3, 3, v2
    s_mul_i32 s45, s41, 5120
    s_add_u32 s45, s45, 40960
    v_add_u32 v2, s45, v2
    v_add_u32 v3, 61440, v2
    v_add_u32 v4, 61440, v3
    v_and_b32 v8, 1, v11
    v_lshrrev_b32 v9, 1, v11
    v_lshlrev_b32 v9, 9, v9
    v_lshl_add_u32 v9, v10, 4, v9
    v_lshl_add_u32 v60, v8, 8, v9
    v_lshl_add_u32 v8, v8, 10, v9
    v_add_u32 v9, 4096, v60
    s_mul_i32 s49, s44, 40960
    s_mul_i32 s46, s39, 5120
    s_add_u32 s49, s49, s46
    s_add_u32 s49, s49, 0xc00000
    s_lshl_b32 s47, s44, 11
    s_lshl_b32 s46, s39, 8
    s_add_u32 s47, s47, s46
    s_lshl_b32 s46, s41, 7
    s_add_u32 s47, s47, s46
    s_add_u32 s47, s47, 0xf00000
    s_lshl_b32 s53, s44, 13
    s_add_u32 s53, s53, 0xb00000
    v_lshlrev_b32 v6, 8, v11
    v_lshl_add_u32 v6, v10, 3, v6
    s_lshr_b32 s54, s38, 2
    s_mul_i32 s54, s54, 2560
    s_add_u32 s54, s54, 0xa0000
    v_and_b32 v60, 1, v1
    v_lshlrev_b32 v60, 6, v60
    v_lshl_add_u32 v60, v11, 4, v60
    v_bfe_u32 v61, v1, 1, 1
    v_lshl_add_u32 v254, v61, 30, v60
    s_lshl_b32 s45, s44, 12
    s_add_u32 s45, s45, 0x2220000
    v_mov_b32 v184, 0
    v_mov_b32 v185, 0
    v_mov_b32 v186, 0
    v_mov_b32 v187, 0
    v_mov_b32 v188, 0
    v_mov_b32 v189, 0
    v_mov_b32 v190, 0
    v_mov_b32 v191, 0
    v_mov_b32 v24, 0
    v_mov_b32 v25, 0
    v_mov_b32 v26, 0
    v_mov_b32 v27, 0
    v_mov_b32 v28, 0
    v_mov_b32 v29, 0
    v_mov_b32 v30, 0
    v_mov_b32 v31, 0
    v_mov_b32 v32, 0
    v_mov_b32 v33, 0
    v_mov_b32 v34, 0
    v_mov_b32 v35, 0
    v_mov_b32 v36, 0
    v_mov_b32 v37, 0
    v_mov_b32 v38, 0
    v_mov_b32 v39, 0
    v_mov_b32 v40, 0
    v_mov_b32 v41, 0
    v_mov_b32 v42, 0
    v_mov_b32 v43, 0
    v_mov_b32 v44, 0
    v_mov_b32 v45, 0
    v_mov_b32 v46, 0
    v_mov_b32 v47, 0
    v_mov_b32 v48, 0
    v_mov_b32 v49, 0
    v_mov_b32 v50, 0
    v_mov_b32 v51, 0
    v_mov_b32 v52, 0
    v_mov_b32 v53, 0
    v_mov_b32 v54, 0
    v_mov_b32 v55, 0
    v_mov_b32 v56, 0
    v_mov_b32 v57, 0
    v_mov_b32 v58, 0
    v_mov_b32 v59, 0
    v_mov_b32 v60, 0
    v_mov_b32 v61, 0
    v_mov_b32 v62, 0
    v_mov_b32 v63, 0
    v_lshlrev_b32 v246, 5, v1
    v_add_u32 v247, 16384, v5
    s_mul_i32 s48, s44, 32768
    s_add_u32 s48, s48, 0x900000
    s_waitcnt vmcnt(0)
    s_barrier
    s_branch P2_dec
P2_fin:
    s_add_u32 s45, s94, 61440
    s_add_u32 s46, s42, 102400
    s_barrier
    ds_read_b32 v76, v21 offset:3072
    ds_read_b128 v[64:67], v21 offset:0
    ds_read_b128 v[68:71], v21 offset:1024
    ds_read_b128 v[72:75], v21 offset:2048
    ds_read_b32 v92, v21 offset:7168
    ds_read_b128 v[80:83], v21 offset:4096
    ds_read_b128 v[84:87], v21 offset:5120
    ds_read_b128 v[88:91], v21 offset:6144
    s_add_u32 m0, s45, 0
    s_nop 0
    buffer_load_dwordx4 v213, s[12:15], s46 offen lds
    s_add_u32 m0, s45, 1024
    s_nop 0
    buffer_load_dwordx4 v214, s[12:15], s46 offen lds
    s_add_u32 m0, s45, 2048
    s_nop 0
    buffer_load_dwordx4 v215, s[12:15], s46 offen lds
    s_add_u32 m0, s45, 3072
    s_nop 0
    buffer_load_dwordx4 v216, s[12:15], s46 offen lds
    s_add_u32 m0, s45, 4096
    s_nop 0
    buffer_load_dwordx4 v217, s[12:15], s46 offen lds
    s_waitcnt lgkmcnt(7)
L_pad1:
    s_cbranch_execz L_pad5
    v_add_f32 v76, v76, v44
    v_rcp_f32 v78, v76
    s_waitcnt lgkmcnt(4)
    v_pk_add_f32 v[64:65], v[64:65], v[32:33]
    v_pk_add_f32 v[66:67], v[66:67], v[34:35]
    v_pk_add_f32 v[68:69], v[68:69], v[36:37]
    v_pk_add_f32 v[70:71], v[70:71], v[38:39]
    v_pk_add_f32 v[72:73], v[72:73], v[40:41]
    v_pk_add_f32 v[74:75], v[74:75], v[42:43]
    v_mov_b32 v79, v78
    v_pk_mul_f32 v[96:97], v[64:65], v[78:79]
    v_pk_mul_f32 v[98:99], v[66:67], v[78:79]
    v_pk_mul_f32 v[100:101], v[68:69], v[78:79]
    v_pk_mul_f32 v[102:103], v[70:71], v[78:79]
    v_pk_mul_f32 v[104:105], v[72:73], v[78:79]
    v_pk_mul_f32 v[106:107], v[74:75], v[78:79]
    v_cvt_pk_bf16_f32 v128, v96, v97
    v_cvt_pk_bf16_f32 v129, v98, v99
    v_cvt_pk_bf16_f32 v130, v100, v101
    v_cvt_pk_bf16_f32 v131, v102, v103
    v_cvt_pk_bf16_f32 v132, v104, v105
    v_cvt_pk_bf16_f32 v133, v106, v107
    buffer_store_dwordx4 v[128:131], v200, s[32:35], s68 offen sc1
    buffer_store_dwordx2 v[132:133], v201, s[32:35], s69 offen sc1
    s_waitcnt lgkmcnt(3)
    v_add_f32 v92, v92, v60
    v_rcp_f32 v94, v92
    s_waitcnt lgkmcnt(0)
    v_pk_add_f32 v[80:81], v[80:81], v[48:49]
    v_pk_add_f32 v[82:83], v[82:83], v[50:51]
    v_pk_add_f32 v[84:85], v[84:85], v[52:53]
    v_pk_add_f32 v[86:87], v[86:87], v[54:55]
    v_pk_add_f32 v[88:89], v[88:89], v[56:57]
    v_pk_add_f32 v[90:91], v[90:91], v[58:59]
    v_mov_b32 v95, v94
    v_pk_mul_f32 v[112:113], v[80:81], v[94:95]
    v_pk_mul_f32 v[114:115], v[82:83], v[94:95]
    v_pk_mul_f32 v[116:117], v[84:85], v[94:95]
    v_pk_mul_f32 v[118:119], v[86:87], v[94:95]
    v_pk_mul_f32 v[120:121], v[88:89], v[94:95]
    v_pk_mul_f32 v[122:123], v[90:91], v[94:95]
    v_cvt_pk_bf16_f32 v136, v112, v113
    v_cvt_pk_bf16_f32 v137, v114, v115
    v_cvt_pk_bf16_f32 v138, v116, v117
    v_cvt_pk_bf16_f32 v139, v118, v119
    v_cvt_pk_bf16_f32 v140, v120, v121
    v_cvt_pk_bf16_f32 v141, v122, v123
    buffer_store_dwordx4 v[136:139], v202, s[32:35], s68 offen sc1
    buffer_store_dwordx2 v[140:141], v203, s[32:35], s69 offen sc1
    v_maximum3_f32 v24, abs(v64), abs(v65), abs(v66)
    v_maximum3_f32 v24, v24, abs(v67), abs(v68)
    v_maximum3_f32 v24, v24, abs(v69), abs(v70)
    v_maximum3_f32 v24, v24, abs(v71), abs(v72)
    v_maximum3_f32 v24, v24, abs(v73), abs(v74)
    v_maximum3_f32 v24, v24, abs(v75), abs(v75)
    v_maximum3_f32 v25, abs(v80), abs(v81), abs(v82)
    v_maximum3_f32 v25, v25, abs(v83), abs(v84)
    v_maximum3_f32 v25, v25, abs(v85), abs(v86)
    v_maximum3_f32 v25, v25, abs(v87), abs(v88)
    v_maximum3_f32 v25, v25, abs(v89), abs(v90)
    v_maximum3_f32 v25, v25, abs(v91), abs(v91)
    v_maximum3_f32 v24, v24, v25, v25
    v_maximum3_f32 v25, v76, v92, v92
    v_minimum3_f32 v26, v76, v92, v92
    v_cmp_nge_f32 vcc, 0x71800000, v24
    s_lshl_b32 s44, s40, 2
    v_mov_b32 v23, s44
    s_mov_b64 s[48:49], vcc
    v_cmp_nge_f32 vcc, 0x5d800000, v25
    s_nop 1
    s_or_b64 s[48:49], s[48:49], vcc
    v_cmp_nle_f32 vcc, 0x30800000, v26
    s_nop 1
    s_or_b64 s[48:49], s[48:49], vcc
    s_cselect_b32 s44, 1, 0
    v_mov_b32 v24, s44
    ds_write_b32 v23, v24 offset:32768
    s_waitcnt lgkmcnt(0)
P2_dec:
    s_barrier
    v_mov_b32 v84, 32768
    ds_read_b128 v[80:83], v84
    s_xor_b32 s96, s98, 1
    s_waitcnt lgkmcnt(0)
    v_or3_b32 v80, v80, v81, v82
    v_or_b32 v80, v80, v83
    s_nop 0
    v_readfirstlane_b32 s97, v80
    s_nop 0
    s_and_b32 s97, s97, s96
    s_cbranch_scc0 P2_ok
    s_mov_b32 s98, 1
    s_waitcnt vmcnt(0)
    s_branch P2_begin
P2_ok:
    s_cmp_lt_u32 s3, 4
    s_cbranch_scc0 P2_pub
    s_waitcnt vmcnt(0)
    s_barrier
    s_branch P2_end
P2_pub:
    v_mov_b32 v24, s36
    v_mov_b32 v25, s37
    v_and_b32 v26, 1, v1
    v_lshlrev_b32 v26, 12, v26
    v_lshrrev_b32 v27, 1, v1
    v_lshl_add_u32 v26, v27, 20, v26
    s_waitcnt vmcnt(0)
    s_mov_b64 exec, 0x3
    buffer_store_dwordx2 v[24:25], v26, s[32:35], s51 offen sc1
    s_mov_b64 exec, -1
    s_waitcnt vmcnt(0)
    s_barrier
    s_branch P2_end
P2_side:
P2_s3:
    s_branch P2_s3r
P2_s5b:
    s_cmp_eq_u32 s3, 0
    s_cselect_b32 s46, 0, 0x40000000
    s_lshl_b32 s47, s2, 5
    s_add_u32 s46, s46, s47
    v_mov_b32 v163, s46
    v_mov_b32 v168, s36
    v_mov_b32 v169, s37
    s_mov_b32 s62, 0xa8000
    s_mov_b64 exec, 1
    buffer_store_dwordx2 v[168:169], v163, s[32:35], s62 offen sc1
    s_mov_b64 exec, -1
    s_branch P2_s5br
P2_s6:
    s_cmp_lg_u32 s3, 0
    s_cbranch_scc1 P2_s6r
    v_lshlrev_b32 v167, 5, v1
    s_mov_b32 s99, 0x80000
    s_mov_b32 s62, 0xa8000
    s_mov_b32 s63, 0xa9000
L_frw_6:
    buffer_load_dwordx2 v[180:181], v167, s[32:35], s62 offen offset:0 sc1
    buffer_load_dwordx2 v[182:183], v167, s[32:35], s62 offen offset:2048 sc1
    buffer_load_dwordx2 v[184:185], v167, s[32:35], s63 offen offset:0 sc1
    buffer_load_dwordx2 v[186:187], v167, s[32:35], s63 offen offset:2048 sc1
    s_waitcnt vmcnt(0)
    v_xor_b32 v180, s36, v180
    v_xor_b32 v181, s37, v181
    v_xor_b32 v182, s36, v182
    v_xor_b32 v183, s37, v183
    v_xor_b32 v184, s36, v184
    v_xor_b32 v185, s37, v185
    v_xor_b32 v186, s36, v186
    v_xor_b32 v187, s37, v187
    v_or3_b32 v180, v180, v181, v182
    v_or3_b32 v183, v183, v184, v185
    v_or3_b32 v180, v180, v186, v187
    v_or_b32 v180, v180, v183
    v_cmp_ne_u32 vcc, 0, v180
    s_nop 1
    s_cbranch_vccz P2_s6r
    s_sleep 2
    s_sub_u32 s99, s99, 1
    s_cbranch_scc0 L_frw_6
    s_branch P2_s6r
P2_end:
L_pad2:
    s_cbranch_execz L_pad6
    s_cmp_lt_u32 s3, 4
    s_cbranch_scc1 P3_go
    s_and_b32 s44, s2, 7
    s_lshr_b32 s45, s2, 3
    s_lshr_b32 s38, s44, 0
    s_lshl_b32 s38, s38, 2
    s_and_b32 s39, s44, 0
    s_lshl_b32 s39, s39, 3
    s_and_b32 s44, s45, 3
    s_add_u32 s38, s38, s44
    s_lshr_b32 s44, s45, 2
    s_add_u32 s39, s39, s44
    s_and_b32 s42, s3, 3
    s_and_b32 s40, s3, 1
    s_lshr_b32 s41, s42, 1
    s_branch P3_loader
P3_go:
    ds_read_b64_tr_b16 v[64:65], v2 offset:0
    ds_read_b64_tr_b16 v[66:67], v2 offset:1280
    ds_read_b64_tr_b16 v[68:69], v2 offset:32
    ds_read_b64_tr_b16 v[70:71], v2 offset:1312
    ds_read_b64_tr_b16 v[72:73], v2 offset:64
    ds_read_b64_tr_b16 v[74:75], v2 offset:1344
    ds_read_b64_tr_b16 v[76:77], v2 offset:96
    ds_read_b64_tr_b16 v[78:79], v2 offset:1376
    ds_read_b64_tr_b16 v[80:81], v2 offset:128
    ds_read_b64_tr_b16 v[82:83], v2 offset:1408
    ds_read_b64_tr_b16 v[84:85], v2 offset:10240
    ds_read_b64_tr_b16 v[86:87], v2 offset:11520
    ds_read_b64_tr_b16 v[88:89], v2 offset:10272
    ds_read_b64_tr_b16 v[90:91], v2 offset:11552
    ds_read_b64_tr_b16 v[92:93], v2 offset:10304
    ds_read_b64_tr_b16 v[94:95], v2 offset:11584
    ds_read_b64_tr_b16 v[96:97], v2 offset:10336
    ds_read_b64_tr_b16 v[98:99], v2 offset:11616
    ds_read_b64_tr_b16 v[100:101], v2 offset:10368
    ds_read_b64_tr_b16 v[102:103], v2 offset:11648
    s_waitcnt vmcnt(0)
    s_mov_b32 exec_lo, 0xffffffff
    s_mov_b32 exec_hi, 0x0
    s_mov_b32 s99, 0x80000
    s_add_u32 s97, s45, 0x0
L_poll_7:
    buffer_load_dwordx2 v[248:249], v246, s[32:35], s45 offen sc1
    s_waitcnt vmcnt(0)
    v_xor_b32 v248, s36, v248
    v_xor_b32 v249, s37, v249
    v_or_b32 v248, v248, v249
    v_cmp_ne_u32 vcc, 0, v248
    s_nop 1
    s_and_b64 exec, exec, vcc
    s_cbranch_execz L_polld_8
    s_add_u32 s45, s45, 0x100000
    s_min_u32 s45, s45, s97
    s_sleep 1
    s_sub_u32 s99, s99, 1
    s_cbranch_scc0 L_poll_7
L_polld_8:
    s_mov_b64 exec, -1
    s_cmp_eq_u32 s41, 0
    s_cbranch_scc0 P3_m1
    s_add_u32 s52, s48, 0
    buffer_load_dwordx4 v[104:107], v5, s[32:35], s52 offen offset:0 sc1
    buffer_load_dwordx4 v[108:111], v247, s[32:35], s52 offen offset:0 sc1
    buffer_load_dwordx4 v[192:195], v254, s[32:35], s54 offen offset:0 sc1
    buffer_load_dwordx4 v[112:115], v5, s[32:35], s52 offen offset:1024 sc1
    buffer_load_dwordx4 v[116:119], v247, s[32:35], s52 offen offset:1024 sc1
    buffer_load_dwordx4 v[196:199], v254, s[32:35], s54 offen offset:128 sc1
    buffer_load_dwordx4 v[120:123], v5, s[32:35], s52 offen offset:2048 sc1
    buffer_load_dwordx4 v[124:127], v247, s[32:35], s52 offen offset:2048 sc1
    buffer_load_dwordx4 v[200:203], v254, s[32:35], s54 offen offset:256 sc1
    buffer_load_dwordx4 v[128:131], v5, s[32:35], s52 offen offset:3072 sc1
    buffer_load_dwordx4 v[132:135], v247, s[32:35], s52 offen offset:3072 sc1
    buffer_load_dwordx4 v[204:207], v254, s[32:35], s54 offen offset:384 sc1
    s_waitcnt vmcnt(9) lgkmcnt(0)
    v_mfma_f32_16x16x32_bf16 v[24:27], v[64:67], v[104:107], v[24:27]
    v_mfma_f32_16x16x32_bf16 v[44:47], v[64:67], v[108:111], v[44:47]
    s_add_u32 s52, s48, 4096
    buffer_load_dwordx4 v[136:139], v5, s[32:35], s52 offen offset:0 sc1
    v_mfma_f32_16x16x32_bf16 v[28:31], v[68:71], v[104:107], v[28:31]
    v_mfma_f32_16x16x32_bf16 v[48:51], v[68:71], v[108:111], v[48:51]
    buffer_load_dwordx4 v[140:143], v247, s[32:35], s52 offen offset:0 sc1
    v_mfma_f32_16x16x32_bf16 v[32:35], v[72:75], v[104:107], v[32:35]
    v_mfma_f32_16x16x32_bf16 v[52:55], v[72:75], v[108:111], v[52:55]
    buffer_load_dwordx4 v[208:211], v254, s[32:35], s54 offen offset:512 sc1
    v_mfma_f32_16x16x32_bf16 v[36:39], v[76:79], v[104:107], v[36:39]
    v_mfma_f32_16x16x32_bf16 v[56:59], v[76:79], v[108:111], v[56:59]
    buffer_load_dwordx4 v[144:147], v5, s[32:35], s52 offen offset:1024 sc1
    v_mfma_f32_16x16x32_bf16 v[40:43], v[80:83], v[104:107], v[40:43]
    v_mfma_f32_16x16x32_bf16 v[60:63], v[80:83], v[108:111], v[60:63]
    buffer_load_dwordx4 v[148:151], v247, s[32:35], s52 offen offset:1024 sc1
    v_mfma_f32_16x16x32_bf16 v[184:187], v[192:195], v[104:107], v[184:187]
    buffer_load_dwordx4 v[212:215], v254, s[32:35], s54 offen offset:640 sc1
    v_mfma_f32_16x16x32_bf16 v[188:191], v[192:195], v[108:111], v[188:191]
    s_waitcnt vmcnt(12) lgkmcnt(0)
    v_mfma_f32_16x16x32_bf16 v[24:27], v[84:87], v[112:115], v[24:27]
    ds_read_b64_tr_b16 v[64:65], v2 offset:20480
    v_mfma_f32_16x16x32_bf16 v[44:47], v[84:87], v[116:119], v[44:47]
    ds_read_b64_tr_b16 v[66:67], v2 offset:21760
    buffer_load_dwordx4 v[152:155], v5, s[32:35], s52 offen offset:2048 sc1
    v_mfma_f32_16x16x32_bf16 v[28:31], v[88:91], v[112:115], v[28:31]
    ds_read_b64_tr_b16 v[68:69], v2 offset:20512
    v_mfma_f32_16x16x32_bf16 v[48:51], v[88:91], v[116:119], v[48:51]
    ds_read_b64_tr_b16 v[70:71], v2 offset:21792
    buffer_load_dwordx4 v[156:159], v247, s[32:35], s52 offen offset:2048 sc1
    v_mfma_f32_16x16x32_bf16 v[32:35], v[92:95], v[112:115], v[32:35]
    ds_read_b64_tr_b16 v[72:73], v2 offset:20544
    v_mfma_f32_16x16x32_bf16 v[52:55], v[92:95], v[116:119], v[52:55]
    ds_read_b64_tr_b16 v[74:75], v2 offset:21824
    buffer_load_dwordx4 v[216:219], v254, s[32:35], s54 offen offset:768 sc1
    v_mfma_f32_16x16x32_bf16 v[36:39], v[96:99], v[112:115], v[36:39]
    ds_read_b64_tr_b16 v[76:77], v2 offset:20576
    v_mfma_f32_16x16x32_bf16 v[56:59], v[96:99], v[116:119], v[56:59]
    ds_read_b64_tr_b16 v[78:79], v2 offset:21856
    v_mfma_f32_16x16x32_bf16 v[40:43], v[100:103], v[112:115], v[40:43]
    ds_read_b64_tr_b16 v[80:81], v2 offset:20608
    v_mfma_f32_16x16x32_bf16 v[60:63], v[100:103], v[116:119], v[60:63]
    ds_read_b64_tr_b16 v[82:83], v2 offset:21888
    v_mfma_f32_16x16x32_bf16 v[184:187], v[196:199], v[112:115], v[184:187]
    v_mfma_f32_16x16x32_bf16 v[188:191], v[196:199], v[116:119], v[188:191]
    s_waitcnt vmcnt(12) lgkmcnt(8)
    v_mfma_f32_16x16x32_bf16 v[24:27], v[64:67], v[120:123], v[24:27]
    ds_read_b64_tr_b16 v[84:85], v2 offset:30720
    v_mfma_f32_16x16x32_bf16 v[44:47], v[64:67], v[124:127], v[44:47]
    ds_read_b64_tr_b16 v[86:87], v2 offset:32000
    buffer_load_dwordx4 v[160:163], v5, s[32:35], s52 offen offset:3072 sc1
    s_waitcnt lgkmcnt(8)
    v_mfma_f32_16x16x32_bf16 v[28:31], v[68:71], v[120:123], v[28:31]
    ds_read_b64_tr_b16 v[88:89], v2 offset:30752
    v_mfma_f32_16x16x32_bf16 v[48:51], v[68:71], v[124:127], v[48:51]
    ds_read_b64_tr_b16 v[90:91], v2 offset:32032
    buffer_load_dwordx4 v[164:167], v247, s[32:35], s52 offen offset:3072 sc1
    s_waitcnt lgkmcnt(8)
    v_mfma_f32_16x16x32_bf16 v[32:35], v[72:75], v[120:123], v[32:35]
    ds_read_b64_tr_b16 v[92:93], v2 offset:30784
    v_mfma_f32_16x16x32_bf16 v[52:55], v[72:75], v[124:127], v[52:55]
    ds_read_b64_tr_b16 v[94:95], v2 offset:32064
    buffer_load_dwordx4 v[220:223], v254, s[32:35], s54 offen offset:896 sc1
    s_waitcnt lgkmcnt(8)
    v_mfma_f32_16x16x32_bf16 v[36:39], v[76:79], v[120:123], v[36:39]
    ds_read_b64_tr_b16 v[96:97], v2 offset:30816
    v_mfma_f32_16x16x32_bf16 v[56:59], v[76:79], v[124:127], v[56:59]
    ds_read_b64_tr_b16 v[98:99], v2 offset:32096
    s_waitcnt lgkmcnt(8)
    v_mfma_f32_16x16x32_bf16 v[40:43], v[80:83], v[120:123], v[40:43]
    ds_read_b64_tr_b16 v[100:101], v2 offset:30848
    v_mfma_f32_16x16x32_bf16 v[60:63], v[80:83], v[124:127], v[60:63]
    ds_read_b64_tr_b16 v[102:103], v2 offset:32128
    v_mfma_f32_16x16x32_bf16 v[184:187], v[200:203], v[120:123], v[184:187]
    v_mfma_f32_16x16x32_bf16 v[188:191], v[200:203], v[124:127], v[188:191]
    s_waitcnt vmcnt(12) lgkmcnt(8)
    v_mfma_f32_16x16x32_bf16 v[24:27], v[84:87], v[128:131], v[24:27]
L_pad3:
    s_cbranch_execz L_pad7
    ds_read_b64_tr_b16 v[64:65], v2 offset:40960
    v_mfma_f32_16x16x32_bf16 v[44:47], v[84:87], v[132:135], v[44:47]
    ds_read_b64_tr_b16 v[66:67], v2 offset:42240
    s_add_u32 s52, s48, 8192
    buffer_load_dwordx4 v[168:171], v5, s[32:35], s52 offen offset:0 sc1
    s_waitcnt lgkmcnt(8)
    v_mfma_f32_16x16x32_bf16 v[28:31], v[88:91], v[128:131], v[28:31]
    ds_read_b64_tr_b16 v[68:69], v2 offset:40992
    v_mfma_f32_16x16x32_bf16 v[48:51], v[88:91], v[132:135], v[48:51]
    ds_read_b64_tr_b16 v[70:71], v2 offset:42272
    buffer_load_dwordx4 v[172:175], v247, s[32:35], s52 offen offset:0 sc1
    s_waitcnt lgkmcnt(8)
    v_mfma_f32_16x16x32_bf16 v[32:35], v[92:95], v[128:131], v[32:35]
    ds_read_b64_tr_b16 v[72:73], v2 offset:41024
    v_mfma_f32_16x16x32_bf16 v[52:55], v[92:95], v[132:135], v[52:55]
    ds_read_b64_tr_b16 v[74:75], v2 offset:42304
    buffer_load_dwordx4 v[224:227], v254, s[32:35], s54 offen offset:1024 sc1
    s_waitcnt lgkmcnt(8)
    v_mfma_f32_16x16x32_bf16 v[36:39], v[96:99], v[128:131], v[36:39]
    ds_read_b64_tr_b16 v[76:77], v2 offset:41056
    v_mfma_f32_16x16x32_bf16 v[56:59], v[96:99], v[132:135], v[56:59]
    ds_read_b64_tr_b16 v[78:79], v2 offset:42336
    s_waitcnt lgkmcnt(8)
    v_mfma_f32_16x16x32_bf16 v[40:43], v[100:103], v[128:131], v[40:43]
    ds_read_b64_tr_b16 v[80:81], v2 offset:41088
    v_mfma_f32_16x16x32_bf16 v[60:63], v[100:103], v[132:135], v[60:63]
    ds_read_b64_tr_b16 v[82:83], v2 offset:42368
    v_mfma_f32_16x16x32_bf16 v[184:187], v[204:207], v[128:131], v[184:187]
    v_mfma_f32_16x16x32_bf16 v[188:191], v[204:207], v[132:135], v[188:191]
    s_waitcnt vmcnt(12) lgkmcnt(8)
    v_mfma_f32_16x16x32_bf16 v[24:27], v[64:67], v[136:139], v[24:27]
    ds_read_b64_tr_b16 v[84:85], v2 offset:51200
    v_mfma_f32_16x16x32_bf16 v[44:47], v[64:67], v[140:143], v[44:47]
    ds_read_b64_tr_b16 v[86:87], v2 offset:52480
    buffer_load_dwordx4 v[176:179], v5, s[32:35], s52 offen offset:1024 sc1
    s_waitcnt lgkmcnt(8)
    v_mfma_f32_16x16x32_bf16 v[28:31], v[68:71], v[136:139], v[28:31]
    ds_read_b64_tr_b16 v[88:89], v2 offset:51232
    v_mfma_f32_16x16x32_bf16 v[48:51], v[68:71], v[140:143], v[48:51]
    ds_read_b64_tr_b16 v[90:91], v2 offset:52512
    buffer_load_dwordx4 v[180:183], v247, s[32:35], s52 offen offset:1024 sc1
    s_waitcnt lgkmcnt(8)
    v_mfma_f32_16x16x32_bf16 v[32:35], v[72:75], v[136:139], v[32:35]
    ds_read_b64_tr_b16 v[92:93], v2 offset:51264
    v_mfma_f32_16x16x32_bf16 v[52:55], v[72:75], v[140:143], v[52:55]
    ds_read_b64_tr_b16 v[94:95], v2 offset:52544
    buffer_load_dwordx4 v[228:231], v254, s[32:35], s54 offen offset:1152 sc1
    s_waitcnt lgkmcnt(8)
    v_mfma_f32_16x16x32_bf16 v[36:39], v[76:79], v[136:139], v[36:39]
    ds_read_b64_tr_b16 v[96:97], v2 offset:51296
    v_mfma_f32_16x16x32_bf16 v[56:59], v[76:79], v[140:143], v[56:59]
    ds_read_b64_tr_b16 v[98:99], v2 offset:52576
    s_waitcnt lgkmcnt(8)
    v_mfma_f32_16x16x32_bf16 v[40:43], v[80:83], v[136:139], v[40:43]
    ds_read_b64_tr_b16 v[100:101], v2 offset:51328
    v_mfma_f32_16x16x32_bf16 v[60:63], v[80:83], v[140:143], v[60:63]
    ds_read_b64_tr_b16 v[102:103], v2 offset:52608
    v_mfma_f32_16x16x32_bf16 v[184:187], v[208:211], v[136:139], v[184:187]
    v_mfma_f32_16x16x32_bf16 v[188:191], v[208:211], v[140:143], v[188:191]
    s_waitcnt vmcnt(12) lgkmcnt(8)
    v_mfma_f32_16x16x32_bf16 v[24:27], v[84:87], v[144:147], v[24:27]
    ds_read_b64_tr_b16 v[64:65], v3 offset:0
    v_mfma_f32_16x16x32_bf16 v[44:47], v[84:87], v[148:151], v[44:47]
    ds_read_b64_tr_b16 v[66:67], v3 offset:1280
    s_waitcnt lgkmcnt(8)
    v_mfma_f32_16x16x32_bf16 v[28:31], v[88:91], v[144:147], v[28:31]
    ds_read_b64_tr_b16 v[68:69], v3 offset:32
    v_mfma_f32_16x16x32_bf16 v[48:51], v[88:91], v[148:151], v[48:51]
    ds_read_b64_tr_b16 v[70:71], v3 offset:1312
    s_waitcnt lgkmcnt(8)
    v_mfma_f32_16x16x32_bf16 v[32:35], v[92:95], v[144:147], v[32:35]
    ds_read_b64_tr_b16 v[72:73], v3 offset:64
    v_mfma_f32_16x16x32_bf16 v[52:55], v[92:95], v[148:151], v[52:55]
    ds_read_b64_tr_b16 v[74:75], v3 offset:1344
    s_waitcnt lgkmcnt(8)
    v_mfma_f32_16x16x32_bf16 v[36:39], v[96:99], v[144:147], v[36:39]
    ds_read_b64_tr_b16 v[76:77], v3 offset:96
    v_mfma_f32_16x16x32_bf16 v[56:59], v[96:99], v[148:151], v[56:59]
    ds_read_b64_tr_b16 v[78:79], v3 offset:1376
    s_waitcnt lgkmcnt(8)
    v_mfma_f32_16x16x32_bf16 v[40:43], v[100:103], v[144:147], v[40:43]
    ds_read_b64_tr_b16 v[80:81], v3 offset:128
    v_mfma_f32_16x16x32_bf16 v[60:63], v[100:103], v[148:151], v[60:63]
    ds_read_b64_tr_b16 v[82:83], v3 offset:1408
    v_mfma_f32_16x16x32_bf16 v[184:187], v[212:215], v[144:147], v[184:187]
    v_mfma_f32_16x16x32_bf16 v[188:191], v[212:215], v[148:151], v[188:191]
    s_waitcnt vmcnt(9) lgkmcnt(8)
    v_mfma_f32_16x16x32_bf16 v[24:27], v[64:67], v[152:155], v[24:27]
    ds_read_b64_tr_b16 v[84:85], v3 offset:10240
    v_mfma_f32_16x16x32_bf16 v[44:47], v[64:67], v[156:159], v[44:47]
    ds_read_b64_tr_b16 v[86:87], v3 offset:11520
    s_waitcnt lgkmcnt(8)
    v_mfma_f32_16x16x32_bf16 v[28:31], v[68:71], v[152:155], v[28:31]
    ds_read_b64_tr_b16 v[88:89], v3 offset:10272
    v_mfma_f32_16x16x32_bf16 v[48:51], v[68:71], v[156:159], v[48:51]
    ds_read_b64_tr_b16 v[90:91], v3 offset:11552
    s_waitcnt lgkmcnt(8)
    v_mfma_f32_16x16x32_bf16 v[32:35], v[72:75], v[152:155], v[32:35]
    ds_read_b64_tr_b16 v[92:93], v3 offset:10304
    v_mfma_f32_16x16x32_bf16 v[52:55], v[72:75], v[156:159], v[52:55]
    ds_read_b64_tr_b16 v[94:95], v3 offset:11584
    s_waitcnt lgkmcnt(8)
    v_mfma_f32_16x16x32_bf16 v[36:39], v[76:79], v[152:155], v[36:39]
    ds_read_b64_tr_b16 v[96:97], v3 offset:10336
    v_mfma_f32_16x16x32_bf16 v[56:59], v[76:79], v[156:159], v[56:59]
    ds_read_b64_tr_b16 v[98:99], v3 offset:11616
    s_waitcnt lgkmcnt(8)
    v_mfma_f32_16x16x32_bf16 v[40:43], v[80:83], v[152:155], v[40:43]
    ds_read_b64_tr_b16 v[100:101], v3 offset:10368
    v_mfma_f32_16x16x32_bf16 v[60:63], v[80:83], v[156:159], v[60:63]
    ds_read_b64_tr_b16 v[102:103], v3 offset:11648
    v_mfma_f32_16x16x32_bf16 v[184:187], v[216:219], v[152:155], v[184:187]
    v_mfma_f32_16x16x32_bf16 v[188:191], v[216:219], v[156:159], v[188:191]
    s_waitcnt vmcnt(6) lgkmcnt(8)
    v_mfma_f32_16x16x32_bf16 v[24:27], v[84:87], v[160:163], v[24:27]
    ds_read_b64_tr_b16 v[64:65], v3 offset:20480
    v_mfma_f32_16x16x32_bf16 v[44:47], v[84:87], v[164:167], v[44:47]
    ds_read_b64_tr_b16 v[66:67], v3 offset:21760
    s_waitcnt lgkmcnt(8)
    v_mfma_f32_16x16x32_bf16 v[28:31], v[88:91], v[160:163], v[28:31]
    ds_read_b64_tr_b16 v[68:69], v3 offset:20512
    v_mfma_f32_16x16x32_bf16 v[48:51], v[88:91], v[164:167], v[48:51]
    ds_read_b64_tr_b16 v[70:71], v3 offset:21792
    s_waitcnt lgkmcnt(8)
    v_mfma_f32_16x16x32_bf16 v[32:35], v[92:95], v[160:163], v[32:35]
    ds_read_b64_tr_b16 v[72:73], v3 offset:20544
    v_mfma_f32_16x16x32_bf16 v[52:55], v[92:95], v[164:167], v[52:55]
    ds_read_b64_tr_b16 v[74:75], v3 offset:21824
    s_waitcnt lgkmcnt(8)
    v_mfma_f32_16x16x32_bf16 v[36:39], v[96:99], v[160:163], v[36:39]
    ds_read_b64_tr_b16 v[76:77], v3 offset:20576
    v_mfma_f32_16x16x32_bf16 v[56:59], v[96:99], v[164:167], v[56:59]
    ds_read_b64_tr_b16 v[78:79], v3 offset:21856
    s_waitcnt lgkmcnt(8)
    v_mfma_f32_16x16x32_bf16 v[40:43], v[100:103], v[160:163], v[40:43]
    ds_read_b64_tr_b16 v[80:81], v3 offset:20608
    v_mfma_f32_16x16x32_bf16 v[60:63], v[100:103], v[164:167], v[60:63]
    ds_read_b64_tr_b16 v[82:83], v3 offset:21888
    v_mfma_f32_16x16x32_bf16 v[184:187], v[220:223], v[160:163], v[184:187]
    v_mfma_f32_16x16x32_bf16 v[188:191], v[220:223], v[164:167], v[188:191]
L_pad4:
    s_cbranch_execz L_pad8
    s_waitcnt vmcnt(3) lgkmcnt(8)
    v_mfma_f32_16x16x32_bf16 v[24:27], v[64:67], v[168:171], v[24:27]
    ds_read_b64_tr_b16 v[84:85], v3 offset:30720
    v_mfma_f32_16x16x32_bf16 v[44:47], v[64:67], v[172:175], v[44:47]
    ds_read_b64_tr_b16 v[86:87], v3 offset:32000
    s_waitcnt lgkmcnt(8)
    v_mfma_f32_16x16x32_bf16 v[28:31], v[68:71], v[168:171], v[28:31]
    ds_read_b64_tr_b16 v[88:89], v3 offset:30752
    v_mfma_f32_16x16x32_bf16 v[48:51], v[68:71], v[172:175], v[48:51]
    ds_read_b64_tr_b16 v[90:91], v3 offset:32032
    s_waitcnt lgkmcnt(8)
    v_mfma_f32_16x16x32_bf16 v[32:35], v[72:75], v[168:171], v[32:35]
    ds_read_b64_tr_b16 v[92:93], v3 offset:30784
    v_mfma_f32_16x16x32_bf16 v[52:55], v[72:75], v[172:175], v[52:55]
    ds_read_b64_tr_b16 v[94:95], v3 offset:32064
    s_waitcnt lgkmcnt(8)
    v_mfma_f32_16x16x32_bf16 v[36:39], v[76:79], v[168:171], v[36:39]
    ds_read_b64_tr_b16 v[96:97], v3 offset:30816
    v_mfma_f32_16x16x32_bf16 v[56:59], v[76:79], v[172:175], v[56:59]
    ds_read_b64_tr_b16 v[98:99], v3 offset:32096
    s_waitcnt lgkmcnt(8)
    v_mfma_f32_16x16x32_bf16 v[40:43], v[80:83], v[168:171], v[40:43]
    ds_read_b64_tr_b16 v[100:101], v3 offset:30848
    v_mfma_f32_16x16x32_bf16 v[60:63], v[80:83], v[172:175], v[60:63]
    ds_read_b64_tr_b16 v[102:103], v3 offset:32128
    v_mfma_f32_16x16x32_bf16 v[184:187], v[224:227], v[168:171], v[184:187]
    v_mfma_f32_16x16x32_bf16 v[188:191], v[224:227], v[172:175], v[188:191]
    s_waitcnt vmcnt(0) lgkmcnt(8)
    v_mfma_f32_16x16x32_bf16 v[24:27], v[84:87], v[176:179], v[24:27]
    v_mfma_f32_16x16x32_bf16 v[44:47], v[84:87], v[180:183], v[44:47]
    s_waitcnt lgkmcnt(6)
    v_mfma_f32_16x16x32_bf16 v[28:31], v[88:91], v[176:179], v[28:31]
    v_mfma_f32_16x16x32_bf16 v[48:51], v[88:91], v[180:183], v[48:51]
    s_waitcnt lgkmcnt(4)
    v_mfma_f32_16x16x32_bf16 v[32:35], v[92:95], v[176:179], v[32:35]
    v_mfma_f32_16x16x32_bf16 v[52:55], v[92:95], v[180:183], v[52:55]
    s_waitcnt lgkmcnt(2)
    v_mfma_f32_16x16x32_bf16 v[36:39], v[96:99], v[176:179], v[36:39]
    v_mfma_f32_16x16x32_bf16 v[56:59], v[96:99], v[180:183], v[56:59]
    s_waitcnt lgkmcnt(0)
    v_mfma_f32_16x16x32_bf16 v[40:43], v[100:103], v[176:179], v[40:43]
    v_mfma_f32_16x16x32_bf16 v[60:63], v[100:103], v[180:183], v[60:63]
    v_mfma_f32_16x16x32_bf16 v[184:187], v[228:231], v[176:179], v[184:187]
    v_mfma_f32_16x16x32_bf16 v[188:191], v[228:231], v[180:183], v[188:191]
    s_branch P3_m2
P3_m1:
    buffer_load_dwordx2 v[104:105], v6, s[32:35], s53 offen offset:0 sc1
    buffer_load_dwordx2 v[106:107], v6, s[32:35], s53 offen offset:128 sc1
    s_add_u32 s50, s53, 4096
    buffer_load_dwordx2 v[108:109], v6, s[32:35], s50 offen offset:0 sc1
    buffer_load_dwordx2 v[110:111], v6, s[32:35], s50 offen offset:128 sc1
    buffer_load_dwordx4 v[192:195], v254, s[32:35], s54 offen offset:2048 sc1
    buffer_load_dwordx2 v[112:113], v6, s[32:35], s53 offen offset:1024 sc1
    buffer_load_dwordx2 v[114:115], v6, s[32:35], s53 offen offset:1152 sc1
    s_add_u32 s50, s53, 4096
    buffer_load_dwordx2 v[116:117], v6, s[32:35], s50 offen offset:1024 sc1
    buffer_load_dwordx2 v[118:119], v6, s[32:35], s50 offen offset:1152 sc1
    buffer_load_dwordx4 v[196:199], v254, s[32:35], s54 offen offset:2176 sc1
    buffer_load_dwordx2 v[120:121], v6, s[32:35], s53 offen offset:2048 sc1
    buffer_load_dwordx2 v[122:123], v6, s[32:35], s53 offen offset:2176 sc1
    s_add_u32 s50, s53, 4096
    buffer_load_dwordx2 v[124:125], v6, s[32:35], s50 offen offset:2048 sc1
    buffer_load_dwordx2 v[126:127], v6, s[32:35], s50 offen offset:2176 sc1
    buffer_load_dwordx4 v[200:203], v254, s[32:35], s54 offen offset:2304 sc1
    buffer_load_dwordx2 v[128:129], v6, s[32:35], s53 offen offset:3072 sc1
    buffer_load_dwordx2 v[130:131], v6, s[32:35], s53 offen offset:3200 sc1
    s_add_u32 s50, s53, 4096
    buffer_load_dwordx2 v[132:133], v6, s[32:35], s50 offen offset:3072 sc1
    buffer_load_dwordx2 v[134:135], v6, s[32:35], s50 offen offset:3200 sc1
    buffer_load_dwordx4 v[204:207], v254, s[32:35], s54 offen offset:2432 sc1
    s_waitcnt vmcnt(15) lgkmcnt(0)
    v_mfma_f32_16x16x32_bf16 v[24:27], v[64:67], v[104:107], v[24:27]
    v_mfma_f32_16x16x32_bf16 v[44:47], v[64:67], v[108:111], v[44:47]
    s_add_u32 s52, s48, 8192
    buffer_load_dwordx4 v[136:139], v5, s[32:35], s52 offen offset:2048 sc1
    v_mfma_f32_16x16x32_bf16 v[28:31], v[68:71], v[104:107], v[28:31]
    v_mfma_f32_16x16x32_bf16 v[48:51], v[68:71], v[108:111], v[48:51]
    buffer_load_dwordx4 v[140:143], v247, s[32:35], s52 offen offset:2048 sc1
    v_mfma_f32_16x16x32_bf16 v[32:35], v[72:75], v[104:107], v[32:35]
    v_mfma_f32_16x16x32_bf16 v[52:55], v[72:75], v[108:111], v[52:55]
    buffer_load_dwordx4 v[208:211], v254, s[32:35], s54 offen offset:1280 sc1
    v_mfma_f32_16x16x32_bf16 v[36:39], v[76:79], v[104:107], v[36:39]
    v_mfma_f32_16x16x32_bf16 v[56:59], v[76:79], v[108:111], v[56:59]
    buffer_load_dwordx4 v[144:147], v5, s[32:35], s52 offen offset:3072 sc1
    v_mfma_f32_16x16x32_bf16 v[40:43], v[80:83], v[104:107], v[40:43]
    v_mfma_f32_16x16x32_bf16 v[60:63], v[80:83], v[108:111], v[60:63]
    buffer_load_dwordx4 v[148:151], v247, s[32:35], s52 offen offset:3072 sc1
    v_mfma_f32_16x16x32_bf16 v[184:187], v[192:195], v[104:107], v[184:187]
    buffer_load_dwordx4 v[212:215], v254, s[32:35], s54 offen offset:1408 sc1
    v_mfma_f32_16x16x32_bf16 v[188:191], v[192:195], v[108:111], v[188:191]
    s_waitcnt vmcnt(16) lgkmcnt(0)
    v_mfma_f32_16x16x32_bf16 v[24:27], v[84:87], v[112:115], v[24:27]
    ds_read_b64_tr_b16 v[64:65], v2 offset:20480
    v_mfma_f32_16x16x32_bf16 v[44:47], v[84:87], v[116:119], v[44:47]
    ds_read_b64_tr_b16 v[66:67], v2 offset:21760
    s_add_u32 s52, s48, 12288
    buffer_load_dwordx4 v[152:155], v5, s[32:35], s52 offen offset:0 sc1
    v_mfma_f32_16x16x32_bf16 v[28:31], v[88:91], v[112:115], v[28:31]
    ds_read_b64_tr_b16 v[68:69], v2 offset:20512
    v_mfma_f32_16x16x32_bf16 v[48:51], v[88:91], v[116:119], v[48:51]
    ds_read_b64_tr_b16 v[70:71], v2 offset:21792
    buffer_load_dwordx4 v[156:159], v247, s[32:35], s52 offen offset:0 sc1
    v_mfma_f32_16x16x32_bf16 v[32:35], v[92:95], v[112:115], v[32:35]
    ds_read_b64_tr_b16 v[72:73], v2 offset:20544
    v_mfma_f32_16x16x32_bf16 v[52:55], v[92:95], v[116:119], v[52:55]
    ds_read_b64_tr_b16 v[74:75], v2 offset:21824
    buffer_load_dwordx4 v[216:219], v254, s[32:35], s54 offen offset:1536 sc1
    v_mfma_f32_16x16x32_bf16 v[36:39], v[96:99], v[112:115], v[36:39]
    ds_read_b64_tr_b16 v[76:77], v2 offset:20576
    v_mfma_f32_16x16x32_bf16 v[56:59], v[96:99], v[116:119], v[56:59]
    ds_read_b64_tr_b16 v[78:79], v2 offset:21856
    v_mfma_f32_16x16x32_bf16 v[40:43], v[100:103], v[112:115], v[40:43]
    ds_read_b64_tr_b16 v[80:81], v2 offset:20608
    v_mfma_f32_16x16x32_bf16 v[60:63], v[100:103], v[116:119], v[60:63]
    ds_read_b64_tr_b16 v[82:83], v2 offset:21888
    v_mfma_f32_16x16x32_bf16 v[184:187], v[196:199], v[112:115], v[184:187]
    v_mfma_f32_16x16x32_bf16 v[188:191], v[196:199], v[116:119], v[188:191]
    s_waitcnt vmcnt(14) lgkmcnt(8)
    v_mfma_f32_16x16x32_bf16 v[24:27], v[64:67], v[120:123], v[24:27]
    ds_read_b64_tr_b16 v[84:85], v2 offset:30720
    v_mfma_f32_16x16x32_bf16 v[44:47], v[64:67], v[124:127], v[44:47]
    ds_read_b64_tr_b16 v[86:87], v2 offset:32000
    buffer_load_dwordx4 v[160:163], v5, s[32:35], s52 offen offset:1024 sc1
    s_waitcnt lgkmcnt(8)
    v_mfma_f32_16x16x32_bf16 v[28:31], v[68:71], v[120:123], v[28:31]
    ds_read_b64_tr_b16 v[88:89], v2 offset:30752
    v_mfma_f32_16x16x32_bf16 v[48:51], v[68:71], v[124:127], v[48:51]
    ds_read_b64_tr_b16 v[90:91], v2 offset:32032
    buffer_load_dwordx4 v[164:167], v247, s[32:35], s52 offen offset:1024 sc1
    s_waitcnt lgkmcnt(8)
    v_mfma_f32_16x16x32_bf16 v[32:35], v[72:75], v[120:123], v[32:35]
    ds_read_b64_tr_b16 v[92:93], v2 offset:30784
    v_mfma_f32_16x16x32_bf16 v[52:55], v[72:75], v[124:127], v[52:55]
    ds_read_b64_tr_b16 v[94:95], v2 offset:32064
    buffer_load_dwordx4 v[220:223], v254, s[32:35], s54 offen offset:1664 sc1
    s_waitcnt lgkmcnt(8)
    v_mfma_f32_16x16x32_bf16 v[36:39], v[76:79], v[120:123], v[36:39]
L_pad5:
    s_cbranch_execz L_pad9
    ds_read_b64_tr_b16 v[96:97], v2 offset:30816
    v_mfma_f32_16x16x32_bf16 v[56:59], v[76:79], v[124:127], v[56:59]
    ds_read_b64_tr_b16 v[98:99], v2 offset:32096
    s_waitcnt lgkmcnt(8)
    v_mfma_f32_16x16x32_bf16 v[40:43], v[80:83], v[120:123], v[40:43]
    ds_read_b64_tr_b16 v[100:101], v2 offset:30848
    v_mfma_f32_16x16x32_bf16 v[60:63], v[80:83], v[124:127], v[60:63]
    ds_read_b64_tr_b16 v[102:103], v2 offset:32128
    v_mfma_f32_16x16x32_bf16 v[184:187], v[200:203], v[120:123], v[184:187]
    v_mfma_f32_16x16x32_bf16 v[188:191], v[200:203], v[124:127], v[188:191]
    s_waitcnt vmcnt(12) lgkmcnt(8)
    v_mfma_f32_16x16x32_bf16 v[24:27], v[84:87], v[128:131], v[24:27]
    ds_read_b64_tr_b16 v[64:65], v2 offset:40960
    v_mfma_f32_16x16x32_bf16 v[44:47], v[84:87], v[132:135], v[44:47]
    ds_read_b64_tr_b16 v[66:67], v2 offset:42240
    buffer_load_dwordx4 v[168:171], v5, s[32:35], s52 offen offset:2048 sc1
    s_waitcnt lgkmcnt(8)
    v_mfma_f32_16x16x32_bf16 v[28:31], v[88:91], v[128:131], v[28:31]
    ds_read_b64_tr_b16 v[68:69], v2 offset:40992
    v_mfma_f32_16x16x32_bf16 v[48:51], v[88:91], v[132:135], v[48:51]
    ds_read_b64_tr_b16 v[70:71], v2 offset:42272
    buffer_load_dwordx4 v[172:175], v247, s[32:35], s52 offen offset:2048 sc1
    s_waitcnt lgkmcnt(8)
    v_mfma_f32_16x16x32_bf16 v[32:35], v[92:95], v[128:131], v[32:35]
    ds_read_b64_tr_b16 v[72:73], v2 offset:41024
    v_mfma_f32_16x16x32_bf16 v[52:55], v[92:95], v[132:135], v[52:55]
    ds_read_b64_tr_b16 v[74:75], v2 offset:42304
    buffer_load_dwordx4 v[224:227], v254, s[32:35], s54 offen offset:1792 sc1
    s_waitcnt lgkmcnt(8)
    v_mfma_f32_16x16x32_bf16 v[36:39], v[96:99], v[128:131], v[36:39]
    ds_read_b64_tr_b16 v[76:77], v2 offset:41056
    v_mfma_f32_16x16x32_bf16 v[56:59], v[96:99], v[132:135], v[56:59]
    ds_read_b64_tr_b16 v[78:79], v2 offset:42336
    s_waitcnt lgkmcnt(8)
    v_mfma_f32_16x16x32_bf16 v[40:43], v[100:103], v[128:131], v[40:43]
    ds_read_b64_tr_b16 v[80:81], v2 offset:41088
    v_mfma_f32_16x16x32_bf16 v[60:63], v[100:103], v[132:135], v[60:63]
    ds_read_b64_tr_b16 v[82:83], v2 offset:42368
    v_mfma_f32_16x16x32_bf16 v[184:187], v[204:207], v[128:131], v[184:187]
    v_mfma_f32_16x16x32_bf16 v[188:191], v[204:207], v[132:135], v[188:191]
    s_waitcnt vmcnt(12) lgkmcnt(8)
    v_mfma_f32_16x16x32_bf16 v[24:27], v[64:67], v[136:139], v[24:27]
    ds_read_b64_tr_b16 v[84:85], v2 offset:51200
    v_mfma_f32_16x16x32_bf16 v[44:47], v[64:67], v[140:143], v[44:47]
    ds_read_b64_tr_b16 v[86:87], v2 offset:52480
    buffer_load_dwordx4 v[176:179], v5, s[32:35], s52 offen offset:3072 sc1
    s_waitcnt lgkmcnt(8)
    v_mfma_f32_16x16x32_bf16 v[28:31], v[68:71], v[136:139], v[28:31]
    ds_read_b64_tr_b16 v[88:89], v2 offset:51232
    v_mfma_f32_16x16x32_bf16 v[48:51], v[68:71], v[140:143], v[48:51]
    ds_read_b64_tr_b16 v[90:91], v2 offset:52512
    buffer_load_dwordx4 v[180:183], v247, s[32:35], s52 offen offset:3072 sc1
    s_waitcnt lgkmcnt(8)
    v_mfma_f32_16x16x32_bf16 v[32:35], v[72:75], v[136:139], v[32:35]
    ds_read_b64_tr_b16 v[92:93], v2 offset:51264
    v_mfma_f32_16x16x32_bf16 v[52:55], v[72:75], v[140:143], v[52:55]
    ds_read_b64_tr_b16 v[94:95], v2 offset:52544
    buffer_load_dwordx4 v[228:231], v254, s[32:35], s54 offen offset:1920 sc1
    s_waitcnt lgkmcnt(8)
    v_mfma_f32_16x16x32_bf16 v[36:39], v[76:79], v[136:139], v[36:39]
    ds_read_b64_tr_b16 v[96:97], v2 offset:51296
    v_mfma_f32_16x16x32_bf16 v[56:59], v[76:79], v[140:143], v[56:59]
    ds_read_b64_tr_b16 v[98:99], v2 offset:52576
    s_waitcnt lgkmcnt(8)
    v_mfma_f32_16x16x32_bf16 v[40:43], v[80:83], v[136:139], v[40:43]
    ds_read_b64_tr_b16 v[100:101], v2 offset:51328
    v_mfma_f32_16x16x32_bf16 v[60:63], v[80:83], v[140:143], v[60:63]
    ds_read_b64_tr_b16 v[102:103], v2 offset:52608
    v_mfma_f32_16x16x32_bf16 v[184:187], v[208:211], v[136:139], v[184:187]
    v_mfma_f32_16x16x32_bf16 v[188:191], v[208:211], v[140:143], v[188:191]
    s_waitcnt vmcnt(12) lgkmcnt(8)
    v_mfma_f32_16x16x32_bf16 v[24:27], v[84:87], v[144:147], v[24:27]
    ds_read_b64_tr_b16 v[64:65], v3 offset:0
    v_mfma_f32_16x16x32_bf16 v[44:47], v[84:87], v[148:151], v[44:47]
    ds_read_b64_tr_b16 v[66:67], v3 offset:1280
    s_waitcnt lgkmcnt(8)
    v_mfma_f32_16x16x32_bf16 v[28:31], v[88:91], v[144:147], v[28:31]
    ds_read_b64_tr_b16 v[68:69], v3 offset:32
    v_mfma_f32_16x16x32_bf16 v[48:51], v[88:91], v[148:151], v[48:51]
    ds_read_b64_tr_b16 v[70:71], v3 offset:1312
    s_waitcnt lgkmcnt(8)
    v_mfma_f32_16x16x32_bf16 v[32:35], v[92:95], v[144:147], v[32:35]
    ds_read_b64_tr_b16 v[72:73], v3 offset:64
    v_mfma_f32_16x16x32_bf16 v[52:55], v[92:95], v[148:151], v[52:55]
    ds_read_b64_tr_b16 v[74:75], v3 offset:1344
    s_waitcnt lgkmcnt(8)
    v_mfma_f32_16x16x32_bf16 v[36:39], v[96:99], v[144:147], v[36:39]
    ds_read_b64_tr_b16 v[76:77], v3 offset:96
    v_mfma_f32_16x16x32_bf16 v[56:59], v[96:99], v[148:151], v[56:59]
    ds_read_b64_tr_b16 v[78:79], v3 offset:1376
    s_waitcnt lgkmcnt(8)
    v_mfma_f32_16x16x32_bf16 v[40:43], v[100:103], v[144:147], v[40:43]
    ds_read_b64_tr_b16 v[80:81], v3 offset:128
    v_mfma_f32_16x16x32_bf16 v[60:63], v[100:103], v[148:151], v[60:63]
    ds_read_b64_tr_b16 v[82:83], v3 offset:1408
    v_mfma_f32_16x16x32_bf16 v[184:187], v[212:215], v[144:147], v[184:187]
    v_mfma_f32_16x16x32_bf16 v[188:191], v[212:215], v[148:151], v[188:191]
    s_waitcnt vmcnt(9) lgkmcnt(8)
    v_mfma_f32_16x16x32_bf16 v[24:27], v[64:67], v[152:155], v[24:27]
    ds_read_b64_tr_b16 v[84:85], v3 offset:10240
    v_mfma_f32_16x16x32_bf16 v[44:47], v[64:67], v[156:159], v[44:47]
    ds_read_b64_tr_b16 v[86:87], v3 offset:11520
    s_waitcnt lgkmcnt(8)
    v_mfma_f32_16x16x32_bf16 v[28:31], v[68:71], v[152:155], v[28:31]
    ds_read_b64_tr_b16 v[88:89], v3 offset:10272
    v_mfma_f32_16x16x32_bf16 v[48:51], v[68:71], v[156:159], v[48:51]
    ds_read_b64_tr_b16 v[90:91], v3 offset:11552
    s_waitcnt lgkmcnt(8)
    v_mfma_f32_16x16x32_bf16 v[32:35], v[72:75], v[152:155], v[32:35]
    ds_read_b64_tr_b16 v[92:93], v3 offset:10304
    v_mfma_f32_16x16x32_bf16 v[52:55], v[72:75], v[156:159], v[52:55]
    ds_read_b64_tr_b16 v[94:95], v3 offset:11584
    s_waitcnt lgkmcnt(8)
    v_mfma_f32_16x16x32_bf16 v[36:39], v[76:79], v[152:155], v[36:39]
    ds_read_b64_tr_b16 v[96:97], v3 offset:10336
    v_mfma_f32_16x16x32_bf16 v[56:59], v[76:79], v[156:159], v[56:59]
    ds_read_b64_tr_b16 v[98:99], v3 offset:11616
    s_waitcnt lgkmcnt(8)
    v_mfma_f32_16x16x32_bf16 v[40:43], v[80:83], v[152:155], v[40:43]
    ds_read_b64_tr_b16 v[100:101], v3 offset:10368
    v_mfma_f32_16x16x32_bf16 v[60:63], v[80:83], v[156:159], v[60:63]
    ds_read_b64_tr_b16 v[102:103], v3 offset:11648
    v_mfma_f32_16x16x32_bf16 v[184:187], v[216:219], v[152:155], v[184:187]
    v_mfma_f32_16x16x32_bf16 v[188:191], v[216:219], v[156:159], v[188:191]
    s_waitcnt vmcnt(6) lgkmcnt(8)
    v_mfma_f32_16x16x32_bf16 v[24:27], v[84:87], v[160:163], v[24:27]
    ds_read_b64_tr_b16 v[64:65], v3 offset:20480
    v_mfma_f32_16x16x32_bf16 v[44:47], v[84:87], v[164:167], v[44:47]
    ds_read_b64_tr_b16 v[66:67], v3 offset:21760
    s_waitcnt lgkmcnt(8)
    v_mfma_f32_16x16x32_bf16 v[28:31], v[88:91], v[160:163], v[28:31]
    ds_read_b64_tr_b16 v[68:69], v3 offset:20512
    v_mfma_f32_16x16x32_bf16 v[48:51], v[88:91], v[164:167], v[48:51]
    ds_read_b64_tr_b16 v[70:71], v3 offset:21792
    s_waitcnt lgkmcnt(8)
    v_mfma_f32_16x16x32_bf16 v[32:35], v[92:95], v[160:163], v[32:35]
    ds_read_b64_tr_b16 v[72:73], v3 offset:20544
    v_mfma_f32_16x16x32_bf16 v[52:55], v[92:95], v[164:167], v[52:55]
    ds_read_b64_tr_b16 v[74:75], v3 offset:21824
    s_waitcnt lgkmcnt(8)
L_pad6:
    s_cbranch_execz L_pad10
    v_mfma_f32_16x16x32_bf16 v[36:39], v[96:99], v[160:163], v[36:39]
    ds_read_b64_tr_b16 v[76:77], v3 offset:20576
    v_mfma_f32_16x16x32_bf16 v[56:59], v[96:99], v[164:167], v[56:59]
    ds_read_b64_tr_b16 v[78:79], v3 offset:21856
    s_waitcnt lgkmcnt(8)
    v_mfma_f32_16x16x32_bf16 v[40:43], v[100:103], v[160:163], v[40:43]
    ds_read_b64_tr_b16 v[80:81], v3 offset:20608
    v_mfma_f32_16x16x32_bf16 v[60:63], v[100:103], v[164:167], v[60:63]
    ds_read_b64_tr_b16 v[82:83], v3 offset:21888
    v_mfma_f32_16x16x32_bf16 v[184:187], v[220:223], v[160:163], v[184:187]
    v_mfma_f32_16x16x32_bf16 v[188:191], v[220:223], v[164:167], v[188:191]
    s_waitcnt vmcnt(3) lgkmcnt(8)
    v_mfma_f32_16x16x32_bf16 v[24:27], v[64:67], v[168:171], v[24:27]
    ds_read_b64_tr_b16 v[84:85], v3 offset:30720
    v_mfma_f32_16x16x32_bf16 v[44:47], v[64:67], v[172:175], v[44:47]
    ds_read_b64_tr_b16 v[86:87], v3 offset:32000
    s_waitcnt lgkmcnt(8)
    v_mfma_f32_16x16x32_bf16 v[28:31], v[68:71], v[168:171], v[28:31]
    ds_read_b64_tr_b16 v[88:89], v3 offset:30752
    v_mfma_f32_16x16x32_bf16 v[48:51], v[68:71], v[172:175], v[48:51]
    ds_read_b64_tr_b16 v[90:91], v3 offset:32032
    s_waitcnt lgkmcnt(8)
    v_mfma_f32_16x16x32_bf16 v[32:35], v[72:75], v[168:171], v[32:35]
    ds_read_b64_tr_b16 v[92:93], v3 offset:30784
    v_mfma_f32_16x16x32_bf16 v[52:55], v[72:75], v[172:175], v[52:55]
    ds_read_b64_tr_b16 v[94:95], v3 offset:32064
    s_waitcnt lgkmcnt(8)
    v_mfma_f32_16x16x32_bf16 v[36:39], v[76:79], v[168:171], v[36:39]
    ds_read_b64_tr_b16 v[96:97], v3 offset:30816
    v_mfma_f32_16x16x32_bf16 v[56:59], v[76:79], v[172:175], v[56:59]
    ds_read_b64_tr_b16 v[98:99], v3 offset:32096
    s_waitcnt lgkmcnt(8)
    v_mfma_f32_16x16x32_bf16 v[40:43], v[80:83], v[168:171], v[40:43]
    ds_read_b64_tr_b16 v[100:101], v3 offset:30848
    v_mfma_f32_16x16x32_bf16 v[60:63], v[80:83], v[172:175], v[60:63]
    ds_read_b64_tr_b16 v[102:103], v3 offset:32128
    v_mfma_f32_16x16x32_bf16 v[184:187], v[224:227], v[168:171], v[184:187]
    v_mfma_f32_16x16x32_bf16 v[188:191], v[224:227], v[172:175], v[188:191]
    s_waitcnt vmcnt(0) lgkmcnt(8)
    v_mfma_f32_16x16x32_bf16 v[24:27], v[84:87], v[176:179], v[24:27]
    v_mfma_f32_16x16x32_bf16 v[44:47], v[84:87], v[180:183], v[44:47]
    s_waitcnt lgkmcnt(6)
    v_mfma_f32_16x16x32_bf16 v[28:31], v[88:91], v[176:179], v[28:31]
    v_mfma_f32_16x16x32_bf16 v[48:51], v[88:91], v[180:183], v[48:51]
    s_waitcnt lgkmcnt(4)
    v_mfma_f32_16x16x32_bf16 v[32:35], v[92:95], v[176:179], v[32:35]
    v_mfma_f32_16x16x32_bf16 v[52:55], v[92:95], v[180:183], v[52:55]
    s_waitcnt lgkmcnt(2)
    v_mfma_f32_16x16x32_bf16 v[36:39], v[96:99], v[176:179], v[36:39]
    v_mfma_f32_16x16x32_bf16 v[56:59], v[96:99], v[180:183], v[56:59]
    s_waitcnt lgkmcnt(0)
    v_mfma_f32_16x16x32_bf16 v[40:43], v[100:103], v[176:179], v[40:43]
    v_mfma_f32_16x16x32_bf16 v[60:63], v[100:103], v[180:183], v[60:63]
    v_mfma_f32_16x16x32_bf16 v[184:187], v[228:231], v[176:179], v[184:187]
    v_mfma_f32_16x16x32_bf16 v[188:191], v[228:231], v[180:183], v[188:191]
P3_m2:
    s_mul_i32 s45, s40, 10240
    s_add_u32 s45, s45, 143360
    s_lshl_b32 s46, s41, 12
    s_add_u32 s45, s45, s46
    s_xor_b32 s46, s41, 1
    s_sub_u32 s46, s46, s41
    s_lshl_b32 s46, s46, 12
    s_add_u32 s46, s46, s45
    v_add_u32 v2, s45, v5
    v_add_u32 v3, s46, v5
    s_lshl_b32 s45, s3, 9
    s_xor_b32 s46, s45, 1024
    v_lshl_add_u32 v4, v1, 3, s45
    v_lshl_add_u32 v7, v1, 3, s46
    v_add_f32 v184, v184, v185
    v_add_f32 v185, v188, v189
    ds_write_b64 v4, v[184:185]
    s_cmp_eq_u32 s41, 0
    s_cbranch_scc0 P3_e1
    ds_write_b128 v2, v[32:35] offset:0
    ds_write_b128 v2, v[36:39] offset:1024
    ds_write_b128 v2, v[52:55] offset:2048
    ds_write_b128 v2, v[56:59] offset:3072
    s_waitcnt lgkmcnt(0)
    s_barrier
    ds_read_b64 v[186:187], v7
    ds_read_b128 v[64:67], v3 offset:0
    ds_read_b128 v[68:71], v3 offset:1024
    ds_read_b128 v[72:75], v3 offset:2048
    ds_read_b128 v[76:79], v3 offset:3072
    ds_read_b128 v[80:83], v3 offset:4096
    ds_read_b128 v[84:87], v3 offset:5120
    v_lshlrev_b32 v100, 16, v12
    v_and_b32 v101, 0xffff0000, v12
    v_pk_add_f32 v[24:25], v[24:25], v[100:101]
    v_lshlrev_b32 v100, 16, v13
    v_and_b32 v101, 0xffff0000, v13
    v_pk_add_f32 v[26:27], v[26:27], v[100:101]
    v_lshlrev_b32 v100, 16, v14
    v_and_b32 v101, 0xffff0000, v14
    v_pk_add_f32 v[28:29], v[28:29], v[100:101]
    v_lshlrev_b32 v100, 16, v15
    v_and_b32 v101, 0xffff0000, v15
    v_pk_add_f32 v[30:31], v[30:31], v[100:101]
    v_lshlrev_b32 v100, 16, v16
    v_and_b32 v101, 0xffff0000, v16
    v_pk_add_f32 v[44:45], v[44:45], v[100:101]
    v_lshlrev_b32 v100, 16, v17
    v_and_b32 v101, 0xffff0000, v17
    v_pk_add_f32 v[46:47], v[46:47], v[100:101]
    v_lshlrev_b32 v100, 16, v18
    v_and_b32 v101, 0xffff0000, v18
    v_pk_add_f32 v[48:49], v[48:49], v[100:101]
    v_lshlrev_b32 v100, 16, v19
    v_and_b32 v101, 0xffff0000, v19
    v_pk_add_f32 v[50:51], v[50:51], v[100:101]
    v_lshlrev_b32 v100, 16, v20
    v_and_b32 v101, 0xffff0000, v20
    v_pk_add_f32 v[40:41], v[40:41], v[100:101]
    v_lshlrev_b32 v100, 16, v21
    v_and_b32 v101, 0xffff0000, v21
    v_pk_add_f32 v[42:43], v[42:43], v[100:101]
    v_lshlrev_b32 v100, 16, v22
    v_and_b32 v101, 0xffff0000, v22
    v_pk_add_f32 v[60:61], v[60:61], v[100:101]
    v_lshlrev_b32 v100, 16, v23
    v_and_b32 v101, 0xffff0000, v23
    v_pk_add_f32 v[62:63], v[62:63], v[100:101]
    s_waitcnt lgkmcnt(6)
    s_mov_b32 s45, 0xbacccccd
    v_pk_add_f32 v[184:185], v[184:185], v[186:187]
    v_fma_f32 v188, v184, s45, -v252
    v_fma_f32 v190, v185, s45, -v253
    v_mov_b32 v96, 0
    v_mov_b32 v97, 0
    v_mov_b32 v189, v188
    v_mov_b32 v191, v190
    s_waitcnt lgkmcnt(5)
    v_pk_add_f32 v[24:25], v[24:25], v[64:65]
    v_pk_add_f32 v[26:27], v[26:27], v[66:67]
    v_cvt_pk_bf16_f32 v232, v24, v25
    v_cvt_pk_bf16_f32 v233, v26, v27
    v_pk_add_f32 v[24:25], v[24:25], v[188:189]
    v_pk_add_f32 v[26:27], v[26:27], v[188:189]
    v_cvt_pk_bf16_f32 v104, v24, v25
    v_cvt_pk_bf16_f32 v105, v26, v27
    s_waitcnt lgkmcnt(4)
    v_pk_add_f32 v[28:29], v[28:29], v[68:69]
    v_pk_add_f32 v[30:31], v[30:31], v[70:71]
    v_cvt_pk_bf16_f32 v234, v28, v29
    v_cvt_pk_bf16_f32 v235, v30, v31
    v_pk_add_f32 v[28:29], v[28:29], v[188:189]
    v_pk_add_f32 v[30:31], v[30:31], v[188:189]
    v_cvt_pk_bf16_f32 v106, v28, v29
    v_cvt_pk_bf16_f32 v107, v30, v31
L_pad7:
    s_cbranch_execz L_pad11
    s_waitcnt lgkmcnt(3)
    v_pk_add_f32 v[44:45], v[44:45], v[72:73]
    v_pk_add_f32 v[46:47], v[46:47], v[74:75]
    v_cvt_pk_bf16_f32 v236, v44, v45
    v_cvt_pk_bf16_f32 v237, v46, v47
    v_pk_add_f32 v[44:45], v[44:45], v[190:191]
    v_pk_add_f32 v[46:47], v[46:47], v[190:191]
    v_cvt_pk_bf16_f32 v108, v44, v45
    v_cvt_pk_bf16_f32 v109, v46, v47
    s_waitcnt lgkmcnt(2)
    v_pk_add_f32 v[48:49], v[48:49], v[76:77]
    v_pk_add_f32 v[50:51], v[50:51], v[78:79]
    v_cvt_pk_bf16_f32 v238, v48, v49
    v_cvt_pk_bf16_f32 v239, v50, v51
    v_pk_add_f32 v[48:49], v[48:49], v[190:191]
    v_pk_add_f32 v[50:51], v[50:51], v[190:191]
    v_cvt_pk_bf16_f32 v110, v48, v49
    v_cvt_pk_bf16_f32 v111, v50, v51
    s_waitcnt lgkmcnt(1)
    v_pk_add_f32 v[40:41], v[40:41], v[80:81]
    v_pk_add_f32 v[42:43], v[42:43], v[82:83]
    v_cvt_pk_bf16_f32 v240, v40, v41
    v_cvt_pk_bf16_f32 v241, v42, v43
    v_pk_add_f32 v[40:41], v[40:41], v[188:189]
    v_pk_add_f32 v[42:43], v[42:43], v[188:189]
    v_cvt_pk_bf16_f32 v112, v40, v41
    v_cvt_pk_bf16_f32 v113, v42, v43
    s_waitcnt lgkmcnt(0)
    v_pk_add_f32 v[60:61], v[60:61], v[84:85]
    v_pk_add_f32 v[62:63], v[62:63], v[86:87]
    v_cvt_pk_bf16_f32 v242, v60, v61
    v_cvt_pk_bf16_f32 v243, v62, v63
    v_pk_add_f32 v[60:61], v[60:61], v[190:191]
    v_pk_add_f32 v[62:63], v[62:63], v[190:191]
    v_cvt_pk_bf16_f32 v114, v60, v61
    v_cvt_pk_bf16_f32 v115, v62, v63
    v_dot2_f32_bf16 v96, v104, v104, v96
    v_dot2_f32_bf16 v96, v105, v105, v96
    v_dot2_f32_bf16 v96, v106, v106, v96
    v_dot2_f32_bf16 v96, v107, v107, v96
    v_dot2_f32_bf16 v97, v108, v108, v97
    v_dot2_f32_bf16 v97, v109, v109, v97
    v_dot2_f32_bf16 v97, v110, v110, v97
    v_dot2_f32_bf16 v97, v111, v111, v97
    v_dot2_f32_bf16 v96, v112, v112, v96
    v_dot2_f32_bf16 v96, v113, v113, v96
    v_dot2_f32_bf16 v97, v114, v114, v97
    v_dot2_f32_bf16 v97, v115, v115, v97
    v_permlane16_swap_b32 v104, v106
    v_permlane16_swap_b32 v105, v107
    v_permlane16_swap_b32 v108, v110
    v_permlane16_swap_b32 v109, v111
    v_permlane16_swap_b32 v112, v114
    v_permlane16_swap_b32 v113, v115
    buffer_store_dwordx4 v[104:107], v8, s[32:35], s49 offen offset:0 sc1
    buffer_store_dwordx4 v[108:111], v8, s[32:35], s49 offen offset:256 sc1
    buffer_store_dwordx4 v[112:115], v9, s[32:35], s49 offen sc1
    v_permlane32_swap_b32 v96, v97
    v_lshrrev_b32 v2, 1, v11
    v_lshl_add_u32 v2, v2, 4, v10
    v_add_f32 v96, v96, v97
    v_lshlrev_b32 v2, 2, v2
    v_mov_b32 v97, v96
    s_lshl_b32 s45, s44, 4
    s_lshl_b32 s46, s39, 1
    v_permlane16_swap_b32 v96, v97
    s_add_u32 s45, s45, s46
    s_add_u32 s45, s45, s41
    v_add_f32 v96, v96, v97
    s_mov_b32 exec_lo, 0xffff
    s_mov_b32 exec_hi, 0xffff
    buffer_store_dword v96, v2, s[32:35], s47 offen sc1
    s_mov_b64 exec, -1
    s_lshl_b32 s45, s45, 5
    s_add_u32 s45, s45, 0x2260000
    v_mov_b32 v244, s36
    v_mov_b32 v245, s37
    v_lshlrev_b32 v246, 20, v1
    s_waitcnt vmcnt(0)
    s_mov_b64 exec, 0x1
    buffer_store_dwordx2 v[244:245], v246, s[32:35], s45 offen sc1
    s_mov_b64 exec, -1
    s_barrier
    s_branch P3_done
P3_e1:
    ds_write_b128 v2, v[24:27] offset:0
    ds_write_b128 v2, v[28:31] offset:1024
    ds_write_b128 v2, v[44:47] offset:2048
    ds_write_b128 v2, v[48:51] offset:3072
    ds_write_b128 v2, v[40:43] offset:4096
    ds_write_b128 v2, v[60:63] offset:5120
    s_waitcnt lgkmcnt(0)
    s_barrier
    ds_read_b64 v[186:187], v7
    ds_read_b128 v[64:67], v3 offset:0
    ds_read_b128 v[68:71], v3 offset:1024
    ds_read_b128 v[72:75], v3 offset:2048
    ds_read_b128 v[76:79], v3 offset:3072
    v_lshlrev_b32 v100, 16, v12
    v_and_b32 v101, 0xffff0000, v12
    v_pk_add_f32 v[32:33], v[32:33], v[100:101]
    v_lshlrev_b32 v100, 16, v13
    v_and_b32 v101, 0xffff0000, v13
    v_pk_add_f32 v[34:35], v[34:35], v[100:101]
    v_lshlrev_b32 v100, 16, v14
    v_and_b32 v101, 0xffff0000, v14
    v_pk_add_f32 v[36:37], v[36:37], v[100:101]
    v_lshlrev_b32 v100, 16, v15
    v_and_b32 v101, 0xffff0000, v15
    v_pk_add_f32 v[38:39], v[38:39], v[100:101]
    v_lshlrev_b32 v100, 16, v16
    v_and_b32 v101, 0xffff0000, v16
    v_pk_add_f32 v[52:53], v[52:53], v[100:101]
    v_lshlrev_b32 v100, 16, v17
    v_and_b32 v101, 0xffff0000, v17
    v_pk_add_f32 v[54:55], v[54:55], v[100:101]
    v_lshlrev_b32 v100, 16, v18
    v_and_b32 v101, 0xffff0000, v18
    v_pk_add_f32 v[56:57], v[56:57], v[100:101]
    v_lshlrev_b32 v100, 16, v19
    v_and_b32 v101, 0xffff0000, v19
    v_pk_add_f32 v[58:59], v[58:59], v[100:101]
    s_waitcnt lgkmcnt(4)
    s_mov_b32 s45, 0xbacccccd
    v_pk_add_f32 v[184:185], v[184:185], v[186:187]
    v_fma_f32 v188, v184, s45, -v252
    v_fma_f32 v190, v185, s45, -v253
    v_mov_b32 v96, 0
    v_mov_b32 v97, 0
    v_mov_b32 v189, v188
    v_mov_b32 v191, v190
    s_waitcnt lgkmcnt(3)
    v_pk_add_f32 v[32:33], v[32:33], v[64:65]
    v_pk_add_f32 v[34:35], v[34:35], v[66:67]
    v_cvt_pk_bf16_f32 v232, v32, v33
    v_cvt_pk_bf16_f32 v233, v34, v35
    v_pk_add_f32 v[32:33], v[32:33], v[188:189]
    v_pk_add_f32 v[34:35], v[34:35], v[188:189]
    v_cvt_pk_bf16_f32 v104, v32, v33
    v_cvt_pk_bf16_f32 v105, v34, v35
    s_waitcnt lgkmcnt(2)
    v_pk_add_f32 v[36:37], v[36:37], v[68:69]
    v_pk_add_f32 v[38:39], v[38:39], v[70:71]
    v_cvt_pk_bf16_f32 v234, v36, v37
    v_cvt_pk_bf16_f32 v235, v38, v39
    v_pk_add_f32 v[36:37], v[36:37], v[188:189]
    v_pk_add_f32 v[38:39], v[38:39], v[188:189]
    v_cvt_pk_bf16_f32 v106, v36, v37
    v_cvt_pk_bf16_f32 v107, v38, v39
    s_waitcnt lgkmcnt(1)
    v_pk_add_f32 v[52:53], v[52:53], v[72:73]
    v_pk_add_f32 v[54:55], v[54:55], v[74:75]
    v_cvt_pk_bf16_f32 v236, v52, v53
L_pad8:
    s_cbranch_execz L_warm0
    v_cvt_pk_bf16_f32 v237, v54, v55
    v_pk_add_f32 v[52:53], v[52:53], v[190:191]
    v_pk_add_f32 v[54:55], v[54:55], v[190:191]
    v_cvt_pk_bf16_f32 v108, v52, v53
    v_cvt_pk_bf16_f32 v109, v54, v55
    s_waitcnt lgkmcnt(0)
    v_pk_add_f32 v[56:57], v[56:57], v[76:77]
    v_pk_add_f32 v[58:59], v[58:59], v[78:79]
    v_cvt_pk_bf16_f32 v238, v56, v57
    v_cvt_pk_bf16_f32 v239, v58, v59
    v_pk_add_f32 v[56:57], v[56:57], v[190:191]
    v_pk_add_f32 v[58:59], v[58:59], v[190:191]
    v_cvt_pk_bf16_f32 v110, v56, v57
    v_cvt_pk_bf16_f32 v111, v58, v59
    v_dot2_f32_bf16 v96, v104, v104, v96
    v_dot2_f32_bf16 v96, v105, v105, v96
    v_dot2_f32_bf16 v96, v106, v106, v96
    v_dot2_f32_bf16 v96, v107, v107, v96
    v_dot2_f32_bf16 v97, v108, v108, v97
    v_dot2_f32_bf16 v97, v109, v109, v97
    v_dot2_f32_bf16 v97, v110, v110, v97
    v_dot2_f32_bf16 v97, v111, v111, v97
    v_permlane16_swap_b32 v104, v106
    v_permlane16_swap_b32 v105, v107
    v_permlane16_swap_b32 v108, v110
    v_permlane16_swap_b32 v109, v111
    buffer_store_dwordx4 v[104:107], v8, s[32:35], s49 offen offset:2048 sc1
    buffer_store_dwordx4 v[108:111], v8, s[32:35], s49 offen offset:2304 sc1
    v_permlane32_swap_b32 v96, v97
    v_lshrrev_b32 v2, 1, v11
    v_lshl_add_u32 v2, v2, 4, v10
    v_add_f32 v96, v96, v97
    v_lshlrev_b32 v2, 2, v2
    v_mov_b32 v97, v96
    s_lshl_b32 s45, s44, 4
    s_lshl_b32 s46, s39, 1
    v_permlane16_swap_b32 v96, v97
    s_add_u32 s45, s45, s46
    s_add_u32 s45, s45, s41
    v_add_f32 v96, v96, v97
    s_mov_b32 exec_lo, 0xffff
    s_mov_b32 exec_hi, 0xffff
    buffer_store_dword v96, v2, s[32:35], s47 offen sc1
    s_mov_b64 exec, -1
    s_lshl_b32 s45, s45, 5
    s_add_u32 s45, s45, 0x2260000
    v_mov_b32 v244, s36
    v_mov_b32 v245, s37
    v_lshlrev_b32 v246, 20, v1
    s_waitcnt vmcnt(0)
    s_mov_b64 exec, 0x1
    buffer_store_dwordx2 v[244:245], v246, s[32:35], s45 offen sc1
    s_mov_b64 exec, -1
    s_barrier
    s_branch P3_done
P3_loader:
P3_done:
    s_and_b32 s44, s2, 7
    s_lshr_b32 s45, s2, 3
    s_lshr_b32 s38, s44, 1
    s_lshl_b32 s38, s38, 2
    s_and_b32 s46, s45, 3
    s_add_u32 s38, s38, s46
    s_and_b32 s39, s44, 1
    s_lshl_b32 s39, s39, 3
    s_lshr_b32 s46, s45, 2
    s_add_u32 s39, s39, s46
    s_and_b32 s40, s3, 3
    v_bfe_u32 v3, v1, 2, 2
    v_lshrrev_b32 v4, 5, v1
    v_lshl_add_u32 v3, v4, 3, v3
    v_lshlrev_b32 v3, 6, v3
    v_bfe_u32 v5, v1, 4, 1
    v_lshl_add_u32 v3, v5, 5, v3
    v_and_b32 v5, 3, v1
    v_lshl_add_u32 v2, v5, 3, v3
    v_add_u32 v2, 2048, v2
    s_cmp_ge_u32 s3, 4
    s_cbranch_scc1 P4_loader
    s_lshl_b32 s44, s38, 2
    s_add_u32 s44, s44, s3
    s_mul_i32 s48, s44, 40960
    s_add_u32 s48, s48, 0xc00000
    v_lshlrev_b32 v3, 4, v1
    v_and_b32 v6, 31, v1
    v_lshrrev_b32 v7, 4, v6
    v_mul_u32_u24 v7, 49152, v7
    v_lshl_add_u32 v7, v4, 8, v7
    v_and_b32 v8, 15, v6
    v_lshl_add_u32 v5, v8, 4, v7
    s_mul_i32 s49, s44, 98304
    s_mul_i32 s45, s39, 3072
    s_add_u32 s49, s49, s45
    s_add_u32 s49, s49, 0x1000000
    v_lshlrev_b32 v7, 10, v4
    v_lshl_add_u32 v7, v6, 2, v7
    v_lshlrev_b32 v8, 5, v1
    s_lshl_b32 s46, s44, 9
    s_add_u32 s46, s46, 0x2260000
    s_lshl_b32 s45, s44, 11
    s_add_u32 s45, s45, 0xf00000
    v_mov_b32 v24, 0
    v_mov_b32 v25, 0
    v_mov_b32 v26, 0
    v_mov_b32 v27, 0
    v_mov_b32 v28, 0
    v_mov_b32 v29, 0
    v_mov_b32 v30, 0
    v_mov_b32 v31, 0
    v_mov_b32 v32, 0
    v_mov_b32 v33, 0
    v_mov_b32 v34, 0
    v_mov_b32 v35, 0
    v_mov_b32 v36, 0
    v_mov_b32 v37, 0
    v_mov_b32 v38, 0
    v_mov_b32 v39, 0
    v_mov_b32 v40, 0
    v_mov_b32 v41, 0
    v_mov_b32 v42, 0
    v_mov_b32 v43, 0
    v_mov_b32 v44, 0
    v_mov_b32 v45, 0
    v_mov_b32 v46, 0
    v_mov_b32 v47, 0
    v_mov_b32 v48, 0
    v_mov_b32 v49, 0
    v_mov_b32 v50, 0
    v_mov_b32 v51, 0
    v_mov_b32 v52, 0
    v_mov_b32 v53, 0
    v_mov_b32 v54, 0
    v_mov_b32 v55, 0
    v_mov_b32 v56, 0
    v_mov_b32 v57, 0
    v_mov_b32 v58, 0
    v_mov_b32 v59, 0
    v_mov_b32 v60, 0
    v_mov_b32 v61, 0
    v_mov_b32 v62, 0
    v_mov_b32 v63, 0
    v_mov_b32 v64, 0
    v_mov_b32 v65, 0
    v_mov_b32 v66, 0
    v_mov_b32 v67, 0
    v_mov_b32 v68, 0
    v_mov_b32 v69, 0
    v_mov_b32 v70, 0
    v_mov_b32 v71, 0
    v_mov_b32 v72, 0
    v_mov_b32 v73, 0
    v_mov_b32 v74, 0
    v_mov_b32 v75, 0
    v_mov_b32 v76, 0
    v_mov_b32 v77, 0
    v_mov_b32 v78, 0
    v_mov_b32 v79, 0
    v_mov_b32 v80, 0
    v_mov_b32 v81, 0
    v_mov_b32 v82, 0
    v_mov_b32 v83, 0
    v_mov_b32 v84, 0
    v_mov_b32 v85, 0
    v_mov_b32 v86, 0
    v_mov_b32 v87, 0
    v_mov_b32 v88, 0
    v_mov_b32 v89, 0
    v_mov_b32 v90, 0
    v_mov_b32 v91, 0
    v_mov_b32 v92, 0
    v_mov_b32 v93, 0
    v_mov_b32 v94, 0
    v_mov_b32 v95, 0
    v_mov_b32 v96, 0
    v_mov_b32 v97, 0
    v_mov_b32 v98, 0
    v_mov_b32 v99, 0
    v_mov_b32 v100, 0
    v_mov_b32 v101, 0
    v_mov_b32 v102, 0
    v_mov_b32 v103, 0
    v_mov_b32 v104, 0
    v_mov_b32 v105, 0
    v_mov_b32 v106, 0
    v_mov_b32 v107, 0
    v_mov_b32 v108, 0
    v_mov_b32 v109, 0
    v_mov_b32 v110, 0
    v_mov_b32 v111, 0
    v_mov_b32 v112, 0
    v_mov_b32 v113, 0
    v_mov_b32 v114, 0
    v_mov_b32 v115, 0
    v_mov_b32 v116, 0
    v_mov_b32 v117, 0
    v_mov_b32 v118, 0
    v_mov_b32 v119, 0
    s_and_b32 s47, s39, 7
    s_lshl_b32 s47, s47, 7
    s_add_u32 s47, s47, s48
    v_lshlrev_b32 v9, 10, v1
    s_mov_b64 exec, 0
    s_cmp_eq_u32 s3, 0
    s_cbranch_scc1 L_padg0
    s_cmp_eq_u32 s3, 1
    s_cbranch_scc1 L_padg1
    s_cmp_eq_u32 s3, 2
    s_cbranch_scc1 L_padg2
    s_cmp_eq_u32 s3, 3
    s_cbranch_scc1 L_padg3
L_warmg0:
    s_cmp_eq_u32 s3, 2
    s_cbranch_scc1 L_padg4
    s_cmp_eq_u32 s3, 3
    s_cbranch_scc1 L_padg5
L_warmg1:
    s_mov_b64 exec, -1
    s_waitcnt vmcnt(0)
L_pad9:
    s_cbranch_execz L_warm0
    s_mov_b32 exec_lo, 0xffff
    s_mov_b32 exec_hi, 0x0
    s_mov_b32 s99, 0x80000
    s_add_u32 s97, s46, 0x0
L_poll_9:
    buffer_load_dwordx2 v[248:249], v8, s[32:35], s46 offen sc1
    s_waitcnt vmcnt(0)
    v_xor_b32 v248, s36, v248
    v_xor_b32 v249, s37, v249
    v_or_b32 v248, v248, v249
    v_cmp_ne_u32 vcc, 0, v248
    s_nop 1
    s_and_b64 exec, exec, vcc
    s_cbranch_execz L_polld_10
    s_add_u32 s46, s46, 0x100000
    s_min_u32 s46, s46, s97
    s_sleep 1
    s_sub_u32 s99, s99, 1
    s_cbranch_scc0 L_poll_9
L_polld_10:
    s_mov_b64 exec, -1
    s_add_u32 s50, s48, 0
    buffer_load_dwordx4 v[168:171], v3, s[32:35], s50 offen offset:0 sc1
    buffer_load_dwordx4 v[172:175], v3, s[32:35], s50 offen offset:1024 sc1
    buffer_load_dwordx4 v[176:179], v3, s[32:35], s50 offen offset:2048 sc1
    buffer_load_dwordx4 v[180:183], v3, s[32:35], s50 offen offset:3072 sc1
    s_add_u32 s50, s48, 4096
    buffer_load_dwordx4 v[184:187], v3, s[32:35], s50 offen offset:0 sc1
    buffer_load_dwordx4 v[188:191], v3, s[32:35], s50 offen offset:1024 sc1
    ds_read_b64_tr_b16 v[120:121], v2 offset:0
    ds_read_b64_tr_b16 v[122:123], v2 offset:256
    ds_read_b64_tr_b16 v[124:125], v2 offset:1024
    ds_read_b64_tr_b16 v[126:127], v2 offset:1280
    ds_read_b64_tr_b16 v[128:129], v2 offset:2048
    ds_read_b64_tr_b16 v[130:131], v2 offset:2304
    ds_read_b64_tr_b16 v[132:133], v2 offset:3072
    ds_read_b64_tr_b16 v[134:135], v2 offset:3328
    ds_read_b64_tr_b16 v[136:137], v2 offset:4096
    ds_read_b64_tr_b16 v[138:139], v2 offset:4352
    ds_read_b64_tr_b16 v[140:141], v2 offset:5120
    ds_read_b64_tr_b16 v[142:143], v2 offset:5376
    s_waitcnt vmcnt(5) lgkmcnt(10)
    v_mfma_f32_32x32x16_bf16 v[24:39], v[120:123], v[168:171], v[24:39]
    ds_read_b64_tr_b16 v[144:145], v2 offset:6144
    ds_read_b64_tr_b16 v[146:147], v2 offset:6400
    s_waitcnt lgkmcnt(10)
    v_mfma_f32_32x32x16_bf16 v[40:55], v[124:127], v[168:171], v[40:55]
    ds_read_b64_tr_b16 v[148:149], v2 offset:7168
    ds_read_b64_tr_b16 v[150:151], v2 offset:7424
    s_waitcnt lgkmcnt(10)
    v_mfma_f32_32x32x16_bf16 v[56:71], v[128:131], v[168:171], v[56:71]
    buffer_load_dwordx4 v[192:195], v3, s[32:35], s50 offen offset:2048 sc1
    buffer_load_dwordx4 v[196:199], v3, s[32:35], s50 offen offset:3072 sc1
    buffer_load_dword v8, v7, s[32:35], s45 offen offset:0 sc1
    buffer_load_dword v9, v7, s[32:35], s45 offen offset:128 sc1
    buffer_load_dword v10, v7, s[32:35], s45 offen offset:256 sc1
    buffer_load_dword v11, v7, s[32:35], s45 offen offset:384 sc1
    buffer_load_dword v12, v7, s[32:35], s45 offen offset:512 sc1
    buffer_load_dword v13, v7, s[32:35], s45 offen offset:640 sc1
    buffer_load_dword v14, v7, s[32:35], s45 offen offset:768 sc1
    buffer_load_dword v15, v7, s[32:35], s45 offen offset:896 sc1
    ds_read_b64_tr_b16 v[152:153], v2 offset:8192
    ds_read_b64_tr_b16 v[154:155], v2 offset:8448
    s_waitcnt lgkmcnt(10)
    v_mfma_f32_32x32x16_bf16 v[72:87], v[132:135], v[168:171], v[72:87]
    ds_read_b64_tr_b16 v[156:157], v2 offset:9216
    ds_read_b64_tr_b16 v[158:159], v2 offset:9472
    s_waitcnt lgkmcnt(10)
    v_mfma_f32_32x32x16_bf16 v[88:103], v[136:139], v[168:171], v[88:103]
    ds_read_b64_tr_b16 v[160:161], v2 offset:10240
    ds_read_b64_tr_b16 v[162:163], v2 offset:10496
    s_waitcnt lgkmcnt(10)
    v_mfma_f32_32x32x16_bf16 v[104:119], v[140:143], v[168:171], v[104:119]
    ds_read_b64_tr_b16 v[164:165], v2 offset:11264
    ds_read_b64_tr_b16 v[166:167], v2 offset:11520
    s_waitcnt vmcnt(14) lgkmcnt(10)
    v_mfma_f32_32x32x16_bf16 v[24:39], v[144:147], v[172:175], v[24:39]
    ds_read_b64_tr_b16 v[120:121], v2 offset:12288
    ds_read_b64_tr_b16 v[122:123], v2 offset:12544
    s_waitcnt lgkmcnt(10)
    v_mfma_f32_32x32x16_bf16 v[40:55], v[148:151], v[172:175], v[40:55]
    ds_read_b64_tr_b16 v[124:125], v2 offset:13312
    ds_read_b64_tr_b16 v[126:127], v2 offset:13568
    s_waitcnt lgkmcnt(10)
    v_mfma_f32_32x32x16_bf16 v[56:71], v[152:155], v[172:175], v[56:71]
    s_add_u32 s50, s48, 8192
    buffer_load_dwordx4 v[200:203], v3, s[32:35], s50 offen offset:0 sc1
    buffer_load_dwordx4 v[204:207], v3, s[32:35], s50 offen offset:1024 sc1
    ds_read_b64_tr_b16 v[128:129], v2 offset:14336
    ds_read_b64_tr_b16 v[130:131], v2 offset:14592
    s_waitcnt lgkmcnt(10)
    v_mfma_f32_32x32x16_bf16 v[72:87], v[156:159], v[172:175], v[72:87]
    ds_read_b64_tr_b16 v[132:133], v2 offset:15360
    ds_read_b64_tr_b16 v[134:135], v2 offset:15616
    s_waitcnt lgkmcnt(10)
    v_mfma_f32_32x32x16_bf16 v[88:103], v[160:163], v[172:175], v[88:103]
    ds_read_b64_tr_b16 v[136:137], v2 offset:16384
    ds_read_b64_tr_b16 v[138:139], v2 offset:16640
    s_waitcnt lgkmcnt(10)
    v_mfma_f32_32x32x16_bf16 v[104:119], v[164:167], v[172:175], v[104:119]
    ds_read_b64_tr_b16 v[140:141], v2 offset:17408
    ds_read_b64_tr_b16 v[142:143], v2 offset:17664
    s_waitcnt vmcnt(15) lgkmcnt(10)
    v_mfma_f32_32x32x16_bf16 v[24:39], v[120:123], v[176:179], v[24:39]
    ds_read_b64_tr_b16 v[144:145], v2 offset:18432
    ds_read_b64_tr_b16 v[146:147], v2 offset:18688
    s_waitcnt lgkmcnt(10)
    v_mfma_f32_32x32x16_bf16 v[40:55], v[124:127], v[176:179], v[40:55]
    ds_read_b64_tr_b16 v[148:149], v2 offset:19456
    ds_read_b64_tr_b16 v[150:151], v2 offset:19712
    s_waitcnt lgkmcnt(10)
    v_mfma_f32_32x32x16_bf16 v[56:71], v[128:131], v[176:179], v[56:71]
    buffer_load_dwordx4 v[208:211], v3, s[32:35], s50 offen offset:2048 sc1
    buffer_load_dwordx4 v[212:215], v3, s[32:35], s50 offen offset:3072 sc1
    ds_read_b64_tr_b16 v[152:153], v2 offset:20480
    ds_read_b64_tr_b16 v[154:155], v2 offset:20736
    s_waitcnt lgkmcnt(10)
    v_mfma_f32_32x32x16_bf16 v[72:87], v[132:135], v[176:179], v[72:87]
    ds_read_b64_tr_b16 v[156:157], v2 offset:21504
    ds_read_b64_tr_b16 v[158:159], v2 offset:21760
    s_waitcnt lgkmcnt(10)
    v_mfma_f32_32x32x16_bf16 v[88:103], v[136:139], v[176:179], v[88:103]
    ds_read_b64_tr_b16 v[160:161], v2 offset:22528
    ds_read_b64_tr_b16 v[162:163], v2 offset:22784
    s_waitcnt lgkmcnt(10)
    v_mfma_f32_32x32x16_bf16 v[104:119], v[140:143], v[176:179], v[104:119]
    ds_read_b64_tr_b16 v[164:165], v2 offset:23552
    ds_read_b64_tr_b16 v[166:167], v2 offset:23808
    v_add_u32 v2, 0x6000, v2
    s_waitcnt vmcnt(16) lgkmcnt(10)
    v_mfma_f32_32x32x16_bf16 v[24:39], v[144:147], v[180:183], v[24:39]
    ds_read_b64_tr_b16 v[120:121], v2 offset:0
    ds_read_b64_tr_b16 v[122:123], v2 offset:256
    s_waitcnt lgkmcnt(10)
    v_mfma_f32_32x32x16_bf16 v[40:55], v[148:151], v[180:183], v[40:55]
    ds_read_b64_tr_b16 v[124:125], v2 offset:1024
    ds_read_b64_tr_b16 v[126:127], v2 offset:1280
    s_waitcnt lgkmcnt(10)
    v_mfma_f32_32x32x16_bf16 v[56:71], v[152:155], v[180:183], v[56:71]
    s_add_u32 s50, s48, 12288
    buffer_load_dwordx4 v[216:219], v3, s[32:35], s50 offen offset:0 sc1
    buffer_load_dwordx4 v[220:223], v3, s[32:35], s50 offen offset:1024 sc1
    ds_read_b64_tr_b16 v[128:129], v2 offset:2048
    ds_read_b64_tr_b16 v[130:131], v2 offset:2304
    s_waitcnt lgkmcnt(10)
    v_mfma_f32_32x32x16_bf16 v[72:87], v[156:159], v[180:183], v[72:87]
    ds_read_b64_tr_b16 v[132:133], v2 offset:3072
    ds_read_b64_tr_b16 v[134:135], v2 offset:3328
    s_waitcnt lgkmcnt(10)
L_pad10:
    s_cbranch_execz L_warm0
    v_mfma_f32_32x32x16_bf16 v[88:103], v[160:163], v[180:183], v[88:103]
    ds_read_b64_tr_b16 v[136:137], v2 offset:4096
    ds_read_b64_tr_b16 v[138:139], v2 offset:4352
    s_waitcnt lgkmcnt(10)
    v_mfma_f32_32x32x16_bf16 v[104:119], v[164:167], v[180:183], v[104:119]
    ds_read_b64_tr_b16 v[140:141], v2 offset:5120
    ds_read_b64_tr_b16 v[142:143], v2 offset:5376
    s_waitcnt vmcnt(17) lgkmcnt(10)
    v_mfma_f32_32x32x16_bf16 v[24:39], v[120:123], v[184:187], v[24:39]
    ds_read_b64_tr_b16 v[144:145], v2 offset:6144
    ds_read_b64_tr_b16 v[146:147], v2 offset:6400
    s_waitcnt lgkmcnt(10)
    v_mfma_f32_32x32x16_bf16 v[40:55], v[124:127], v[184:187], v[40:55]
    ds_read_b64_tr_b16 v[148:149], v2 offset:7168
    ds_read_b64_tr_b16 v[150:151], v2 offset:7424
    s_waitcnt lgkmcnt(10)
    v_mfma_f32_32x32x16_bf16 v[56:71], v[128:131], v[184:187], v[56:71]
    buffer_load_dwordx4 v[224:227], v3, s[32:35], s50 offen offset:2048 sc1
    ds_read_b64_tr_b16 v[152:153], v2 offset:8192
    ds_read_b64_tr_b16 v[154:155], v2 offset:8448
    s_waitcnt lgkmcnt(10)
    v_mfma_f32_32x32x16_bf16 v[72:87], v[132:135], v[184:187], v[72:87]
    ds_read_b64_tr_b16 v[156:157], v2 offset:9216
    ds_read_b64_tr_b16 v[158:159], v2 offset:9472
    s_waitcnt lgkmcnt(10)
    v_mfma_f32_32x32x16_bf16 v[88:103], v[136:139], v[184:187], v[88:103]
    ds_read_b64_tr_b16 v[160:161], v2 offset:10240
    ds_read_b64_tr_b16 v[162:163], v2 offset:10496
    s_waitcnt lgkmcnt(10)
    v_mfma_f32_32x32x16_bf16 v[104:119], v[140:143], v[184:187], v[104:119]
    ds_read_b64_tr_b16 v[164:165], v2 offset:11264
    ds_read_b64_tr_b16 v[166:167], v2 offset:11520
    s_waitcnt vmcnt(17) lgkmcnt(10)
    v_mfma_f32_32x32x16_bf16 v[24:39], v[144:147], v[188:191], v[24:39]
    ds_read_b64_tr_b16 v[120:121], v2 offset:12288
    ds_read_b64_tr_b16 v[122:123], v2 offset:12544
    s_waitcnt lgkmcnt(10)
    v_mfma_f32_32x32x16_bf16 v[40:55], v[148:151], v[188:191], v[40:55]
    ds_read_b64_tr_b16 v[124:125], v2 offset:13312
    ds_read_b64_tr_b16 v[126:127], v2 offset:13568
    s_waitcnt lgkmcnt(10)
    v_mfma_f32_32x32x16_bf16 v[56:71], v[152:155], v[188:191], v[56:71]
    buffer_load_dwordx4 v[228:231], v3, s[32:35], s50 offen offset:3072 sc1
    ds_read_b64_tr_b16 v[128:129], v2 offset:14336
    ds_read_b64_tr_b16 v[130:131], v2 offset:14592
    s_waitcnt lgkmcnt(10)
    v_mfma_f32_32x32x16_bf16 v[72:87], v[156:159], v[188:191], v[72:87]
    ds_read_b64_tr_b16 v[132:133], v2 offset:15360
    ds_read_b64_tr_b16 v[134:135], v2 offset:15616
    s_waitcnt lgkmcnt(10)
    v_mfma_f32_32x32x16_bf16 v[88:103], v[160:163], v[188:191], v[88:103]
    ds_read_b64_tr_b16 v[136:137], v2 offset:16384
    ds_read_b64_tr_b16 v[138:139], v2 offset:16640
    s_waitcnt lgkmcnt(10)
    v_mfma_f32_32x32x16_bf16 v[104:119], v[164:167], v[188:191], v[104:119]
    ds_read_b64_tr_b16 v[140:141], v2 offset:17408
    ds_read_b64_tr_b16 v[142:143], v2 offset:17664
    s_waitcnt vmcnt(17) lgkmcnt(10)
    v_mfma_f32_32x32x16_bf16 v[24:39], v[120:123], v[192:195], v[24:39]
    ds_read_b64_tr_b16 v[144:145], v2 offset:18432
    ds_read_b64_tr_b16 v[146:147], v2 offset:18688
    s_waitcnt lgkmcnt(10)
    v_mfma_f32_32x32x16_bf16 v[40:55], v[124:127], v[192:195], v[40:55]
    ds_read_b64_tr_b16 v[148:149], v2 offset:19456
    ds_read_b64_tr_b16 v[150:151], v2 offset:19712
    s_waitcnt lgkmcnt(10)
    v_mfma_f32_32x32x16_bf16 v[56:71], v[128:131], v[192:195], v[56:71]
    s_add_u32 s50, s48, 16384
    buffer_load_dwordx4 v[168:171], v3, s[32:35], s50 offen offset:0 sc1
    ds_read_b64_tr_b16 v[152:153], v2 offset:20480
    ds_read_b64_tr_b16 v[154:155], v2 offset:20736
    s_waitcnt lgkmcnt(10)
    v_mfma_f32_32x32x16_bf16 v[72:87], v[132:135], v[192:195], v[72:87]
    ds_read_b64_tr_b16 v[156:157], v2 offset:21504
    ds_read_b64_tr_b16 v[158:159], v2 offset:21760
    s_waitcnt lgkmcnt(10)
    v_mfma_f32_32x32x16_bf16 v[88:103], v[136:139], v[192:195], v[88:103]
    ds_read_b64_tr_b16 v[160:161], v2 offset:22528
    ds_read_b64_tr_b16 v[162:163], v2 offset:22784
    s_waitcnt lgkmcnt(10)
    v_mfma_f32_32x32x16_bf16 v[104:119], v[140:143], v[192:195], v[104:119]
    ds_read_b64_tr_b16 v[164:165], v2 offset:23552
    ds_read_b64_tr_b16 v[166:167], v2 offset:23808
    v_add_u32 v2, 0x6000, v2
    s_barrier
    s_waitcnt vmcnt(17) lgkmcnt(10)
    v_mfma_f32_32x32x16_bf16 v[24:39], v[144:147], v[196:199], v[24:39]
    ds_read_b64_tr_b16 v[120:121], v2 offset:0
    ds_read_b64_tr_b16 v[122:123], v2 offset:256
    s_waitcnt lgkmcnt(10)
    v_mfma_f32_32x32x16_bf16 v[40:55], v[148:151], v[196:199], v[40:55]
    ds_read_b64_tr_b16 v[124:125], v2 offset:1024
    ds_read_b64_tr_b16 v[126:127], v2 offset:1280
    s_waitcnt lgkmcnt(10)
    v_mfma_f32_32x32x16_bf16 v[56:71], v[152:155], v[196:199], v[56:71]
    buffer_load_dwordx4 v[172:175], v3, s[32:35], s50 offen offset:1024 sc1
    ds_read_b64_tr_b16 v[128:129], v2 offset:2048
    ds_read_b64_tr_b16 v[130:131], v2 offset:2304
    s_waitcnt lgkmcnt(10)
    v_mfma_f32_32x32x16_bf16 v[72:87], v[156:159], v[196:199], v[72:87]
    ds_read_b64_tr_b16 v[132:133], v2 offset:3072
    ds_read_b64_tr_b16 v[134:135], v2 offset:3328
    s_waitcnt lgkmcnt(10)
    v_mfma_f32_32x32x16_bf16 v[88:103], v[160:163], v[196:199], v[88:103]
    ds_read_b64_tr_b16 v[136:137], v2 offset:4096
    ds_read_b64_tr_b16 v[138:139], v2 offset:4352
    s_waitcnt lgkmcnt(10)
    v_mfma_f32_32x32x16_bf16 v[104:119], v[164:167], v[196:199], v[104:119]
    ds_read_b64_tr_b16 v[140:141], v2 offset:5120
    ds_read_b64_tr_b16 v[142:143], v2 offset:5376
    s_waitcnt vmcnt(9) lgkmcnt(10)
    v_mfma_f32_32x32x16_bf16 v[24:39], v[120:123], v[200:203], v[24:39]
    ds_read_b64_tr_b16 v[144:145], v2 offset:6144
    ds_read_b64_tr_b16 v[146:147], v2 offset:6400
    s_waitcnt lgkmcnt(10)
    v_mfma_f32_32x32x16_bf16 v[40:55], v[124:127], v[200:203], v[40:55]
    ds_read_b64_tr_b16 v[148:149], v2 offset:7168
    ds_read_b64_tr_b16 v[150:151], v2 offset:7424
    s_waitcnt lgkmcnt(10)
    v_mfma_f32_32x32x16_bf16 v[56:71], v[128:131], v[200:203], v[56:71]
    buffer_load_dwordx4 v[176:179], v3, s[32:35], s50 offen offset:2048 sc1
    ds_read_b64_tr_b16 v[152:153], v2 offset:8192
    ds_read_b64_tr_b16 v[154:155], v2 offset:8448
    s_waitcnt lgkmcnt(10)
    v_mfma_f32_32x32x16_bf16 v[72:87], v[132:135], v[200:203], v[72:87]
    ds_read_b64_tr_b16 v[156:157], v2 offset:9216
    ds_read_b64_tr_b16 v[158:159], v2 offset:9472
    s_waitcnt lgkmcnt(10)
    v_mfma_f32_32x32x16_bf16 v[88:103], v[136:139], v[200:203], v[88:103]
    ds_read_b64_tr_b16 v[160:161], v2 offset:10240
    ds_read_b64_tr_b16 v[162:163], v2 offset:10496
    s_waitcnt lgkmcnt(10)
    v_mfma_f32_32x32x16_bf16 v[104:119], v[140:143], v[200:203], v[104:119]
    ds_read_b64_tr_b16 v[164:165], v2 offset:11264
    ds_read_b64_tr_b16 v[166:167], v2 offset:11520
    s_waitcnt vmcnt(9) lgkmcnt(10)
    v_mfma_f32_32x32x16_bf16 v[24:39], v[144:147], v[204:207], v[24:39]
    ds_read_b64_tr_b16 v[120:121], v2 offset:12288
    ds_read_b64_tr_b16 v[122:123], v2 offset:12544
    s_waitcnt lgkmcnt(10)
    v_mfma_f32_32x32x16_bf16 v[40:55], v[148:151], v[204:207], v[40:55]
    ds_read_b64_tr_b16 v[124:125], v2 offset:13312
    ds_read_b64_tr_b16 v[126:127], v2 offset:13568
    s_waitcnt lgkmcnt(10)
    v_mfma_f32_32x32x16_bf16 v[56:71], v[152:155], v[204:207], v[56:71]
L_pad11:
    s_cbranch_execz L_warm0
    buffer_load_dwordx4 v[180:183], v3, s[32:35], s50 offen offset:3072 sc1
    ds_read_b64_tr_b16 v[128:129], v2 offset:14336
    ds_read_b64_tr_b16 v[130:131], v2 offset:14592
    s_waitcnt lgkmcnt(10)
    v_mfma_f32_32x32x16_bf16 v[72:87], v[156:159], v[204:207], v[72:87]
    ds_read_b64_tr_b16 v[132:133], v2 offset:15360
    ds_read_b64_tr_b16 v[134:135], v2 offset:15616
    s_waitcnt lgkmcnt(10)
    v_mfma_f32_32x32x16_bf16 v[88:103], v[160:163], v[204:207], v[88:103]
    ds_read_b64_tr_b16 v[136:137], v2 offset:16384
    ds_read_b64_tr_b16 v[138:139], v2 offset:16640
    s_waitcnt lgkmcnt(10)
    v_mfma_f32_32x32x16_bf16 v[104:119], v[164:167], v[204:207], v[104:119]
    ds_read_b64_tr_b16 v[140:141], v2 offset:17408
    ds_read_b64_tr_b16 v[142:143], v2 offset:17664
    s_waitcnt vmcnt(9) lgkmcnt(10)
    v_mfma_f32_32x32x16_bf16 v[24:39], v[120:123], v[208:211], v[24:39]
    ds_read_b64_tr_b16 v[144:145], v2 offset:18432
    ds_read_b64_tr_b16 v[146:147], v2 offset:18688
    s_waitcnt lgkmcnt(10)
    v_mfma_f32_32x32x16_bf16 v[40:55], v[124:127], v[208:211], v[40:55]
    ds_read_b64_tr_b16 v[148:149], v2 offset:19456
    ds_read_b64_tr_b16 v[150:151], v2 offset:19712
    s_waitcnt lgkmcnt(10)
    v_mfma_f32_32x32x16_bf16 v[56:71], v[128:131], v[208:211], v[56:71]
    s_add_u32 s50, s48, 20480
    buffer_load_dwordx4 v[184:187], v3, s[32:35], s50 offen offset:0 sc1
    ds_read_b64_tr_b16 v[152:153], v2 offset:20480
    ds_read_b64_tr_b16 v[154:155], v2 offset:20736
    s_waitcnt lgkmcnt(10)
    v_mfma_f32_32x32x16_bf16 v[72:87], v[132:135], v[208:211], v[72:87]
    ds_read_b64_tr_b16 v[156:157], v2 offset:21504
    ds_read_b64_tr_b16 v[158:159], v2 offset:21760
    s_waitcnt lgkmcnt(10)
    v_mfma_f32_32x32x16_bf16 v[88:103], v[136:139], v[208:211], v[88:103]
    ds_read_b64_tr_b16 v[160:161], v2 offset:22528
    ds_read_b64_tr_b16 v[162:163], v2 offset:22784
    s_waitcnt lgkmcnt(10)
    v_mfma_f32_32x32x16_bf16 v[104:119], v[140:143], v[208:211], v[104:119]
    ds_read_b64_tr_b16 v[164:165], v2 offset:23552
    ds_read_b64_tr_b16 v[166:167], v2 offset:23808
    v_add_u32 v2, 0x6000, v2
    s_waitcnt vmcnt(9) lgkmcnt(10)
    v_mfma_f32_32x32x16_bf16 v[24:39], v[144:147], v[212:215], v[24:39]
    ds_read_b64_tr_b16 v[120:121], v2 offset:0
    ds_read_b64_tr_b16 v[122:123], v2 offset:256
    s_waitcnt lgkmcnt(10)
    v_mfma_f32_32x32x16_bf16 v[40:55], v[148:151], v[212:215], v[40:55]
    ds_read_b64_tr_b16 v[124:125], v2 offset:1024
    ds_read_b64_tr_b16 v[126:127], v2 offset:1280
    s_waitcnt lgkmcnt(10)
    v_mfma_f32_32x32x16_bf16 v[56:71], v[152:155], v[212:215], v[56:71]
    buffer_load_dwordx4 v[188:191], v3, s[32:35], s50 offen offset:1024 sc1
    ds_read_b64_tr_b16 v[128:129], v2 offset:2048
    ds_read_b64_tr_b16 v[130:131], v2 offset:2304
    s_waitcnt lgkmcnt(10)
    v_mfma_f32_32x32x16_bf16 v[72:87], v[156:159], v[212:215], v[72:87]
    ds_read_b64_tr_b16 v[132:133], v2 offset:3072
    ds_read_b64_tr_b16 v[134:135], v2 offset:3328
    s_waitcnt lgkmcnt(10)
    v_mfma_f32_32x32x16_bf16 v[88:103], v[160:163], v[212:215], v[88:103]
    ds_read_b64_tr_b16 v[136:137], v2 offset:4096
    ds_read_b64_tr_b16 v[138:139], v2 offset:4352
    s_waitcnt lgkmcnt(10)
    v_mfma_f32_32x32x16_bf16 v[104:119], v[164:167], v[212:215], v[104:119]
    ds_read_b64_tr_b16 v[140:141], v2 offset:5120
    ds_read_b64_tr_b16 v[142:143], v2 offset:5376
    s_waitcnt vmcnt(9) lgkmcnt(10)
    v_mfma_f32_32x32x16_bf16 v[24:39], v[120:123], v[216:219], v[24:39]
    ds_read_b64_tr_b16 v[144:145], v2 offset:6144
    ds_read_b64_tr_b16 v[146:147], v2 offset:6400
    s_waitcnt lgkmcnt(10)
    v_mfma_f32_32x32x16_bf16 v[40:55], v[124:127], v[216:219], v[40:55]
    ds_read_b64_tr_b16 v[148:149], v2 offset:7168
    ds_read_b64_tr_b16 v[150:151], v2 offset:7424
    s_waitcnt lgkmcnt(10)
    v_mfma_f32_32x32x16_bf16 v[56:71], v[128:131], v[216:219], v[56:71]
    buffer_load_dwordx4 v[192:195], v3, s[32:35], s50 offen offset:2048 sc1
    ds_read_b64_tr_b16 v[152:153], v2 offset:8192
    ds_read_b64_tr_b16 v[154:155], v2 offset:8448
    s_waitcnt lgkmcnt(10)
    v_mfma_f32_32x32x16_bf16 v[72:87], v[132:135], v[216:219], v[72:87]
    ds_read_b64_tr_b16 v[156:157], v2 offset:9216
    ds_read_b64_tr_b16 v[158:159], v2 offset:9472
    s_waitcnt lgkmcnt(10)
    v_mfma_f32_32x32x16_bf16 v[88:103], v[136:139], v[216:219], v[88:103]
    ds_read_b64_tr_b16 v[160:161], v2 offset:10240
    ds_read_b64_tr_b16 v[162:163], v2 offset:10496
    s_waitcnt lgkmcnt(10)
    v_mfma_f32_32x32x16_bf16 v[104:119], v[140:143], v[216:219], v[104:119]
    ds_read_b64_tr_b16 v[164:165], v2 offset:11264
    ds_read_b64_tr_b16 v[166:167], v2 offset:11520
    v_add_f32 v8, v8, v9
    v_add_f32 v8, v8, v10
    v_add_f32 v8, v8, v11
    v_add_f32 v8, v8, v12
    v_add_f32 v8, v8, v13
    v_add_f32 v8, v8, v14
    v_add_f32 v8, v8, v15
    v_mov_b32 v10, v8
    s_waitcnt vmcnt(9) lgkmcnt(10)
    v_mfma_f32_32x32x16_bf16 v[24:39], v[144:147], v[220:223], v[24:39]
    ds_read_b64_tr_b16 v[120:121], v2 offset:12288
    ds_read_b64_tr_b16 v[122:123], v2 offset:12544
    s_waitcnt lgkmcnt(10)
    v_mfma_f32_32x32x16_bf16 v[40:55], v[148:151], v[220:223], v[40:55]
    ds_read_b64_tr_b16 v[124:125], v2 offset:13312
    ds_read_b64_tr_b16 v[126:127], v2 offset:13568
    s_waitcnt lgkmcnt(10)
    v_mfma_f32_32x32x16_bf16 v[56:71], v[152:155], v[220:223], v[56:71]
    buffer_load_dwordx4 v[196:199], v3, s[32:35], s50 offen offset:3072 sc1
    ds_read_b64_tr_b16 v[128:129], v2 offset:14336
    ds_read_b64_tr_b16 v[130:131], v2 offset:14592
    s_waitcnt lgkmcnt(10)
    v_mfma_f32_32x32x16_bf16 v[72:87], v[156:159], v[220:223], v[72:87]
    ds_read_b64_tr_b16 v[132:133], v2 offset:15360
    ds_read_b64_tr_b16 v[134:135], v2 offset:15616
    s_waitcnt lgkmcnt(10)
    v_mfma_f32_32x32x16_bf16 v[88:103], v[160:163], v[220:223], v[88:103]
    ds_read_b64_tr_b16 v[136:137], v2 offset:16384
    ds_read_b64_tr_b16 v[138:139], v2 offset:16640
    s_waitcnt lgkmcnt(10)
    v_mfma_f32_32x32x16_bf16 v[104:119], v[164:167], v[220:223], v[104:119]
    ds_read_b64_tr_b16 v[140:141], v2 offset:17408
    ds_read_b64_tr_b16 v[142:143], v2 offset:17664
    v_permlane32_swap_b32 v8, v10
    s_mov_b32 s46, 0x3acccccd
    v_mov_b32 v9, 0x3727c5ac
    v_add_f32 v8, v8, v10
    v_fma_f32 v10, v8, s46, v9
    v_rsq_f32 v9, v10
    v_mov_b32 v11, v10
    v_mul_f32 v12, 0xc0135761, v9
    v_mul_f32 v9, v9, v9
    v_mul_f32 v9, 0x3d372713, v9
    v_mul_f32 v14, v12, v9
    v_mov_b32 v13, v12
    v_mov_b32 v15, v14
    s_waitcnt vmcnt(9) lgkmcnt(10)
    v_mfma_f32_32x32x16_bf16 v[24:39], v[120:123], v[224:227], v[24:39]
    ds_read_b64_tr_b16 v[144:145], v2 offset:18432
    ds_read_b64_tr_b16 v[146:147], v2 offset:18688
    s_waitcnt lgkmcnt(10)
    v_mfma_f32_32x32x16_bf16 v[40:55], v[124:127], v[224:227], v[40:55]
    ds_read_b64_tr_b16 v[148:149], v2 offset:19456
    ds_read_b64_tr_b16 v[150:151], v2 offset:19712
    s_waitcnt lgkmcnt(10)
    v_mfma_f32_32x32x16_bf16 v[56:71], v[128:131], v[224:227], v[56:71]
    s_add_u32 s50, s48, 24576
    buffer_load_dwordx4 v[200:203], v3, s[32:35], s50 offen offset:0 sc1
    ds_read_b64_tr_b16 v[152:153], v2 offset:20480
L_pad12:
    s_cbranch_execz L_pad16
    ds_read_b64_tr_b16 v[154:155], v2 offset:20736
    s_waitcnt lgkmcnt(10)
    v_mfma_f32_32x32x16_bf16 v[72:87], v[132:135], v[224:227], v[72:87]
    ds_read_b64_tr_b16 v[156:157], v2 offset:21504
    ds_read_b64_tr_b16 v[158:159], v2 offset:21760
    s_waitcnt lgkmcnt(10)
    v_mfma_f32_32x32x16_bf16 v[88:103], v[136:139], v[224:227], v[88:103]
    ds_read_b64_tr_b16 v[160:161], v2 offset:22528
    ds_read_b64_tr_b16 v[162:163], v2 offset:22784
    s_waitcnt lgkmcnt(10)
    v_mfma_f32_32x32x16_bf16 v[104:119], v[140:143], v[224:227], v[104:119]
    ds_read_b64_tr_b16 v[164:165], v2 offset:23552
    ds_read_b64_tr_b16 v[166:167], v2 offset:23808
    v_add_u32 v2, 0x6000, v2
    s_barrier
    s_waitcnt vmcnt(9) lgkmcnt(10)
    v_mfma_f32_32x32x16_bf16 v[24:39], v[144:147], v[228:231], v[24:39]
    ds_read_b64_tr_b16 v[120:121], v2 offset:0
    ds_read_b64_tr_b16 v[122:123], v2 offset:256
    s_waitcnt lgkmcnt(10)
    v_mfma_f32_32x32x16_bf16 v[40:55], v[148:151], v[228:231], v[40:55]
    ds_read_b64_tr_b16 v[124:125], v2 offset:1024
    ds_read_b64_tr_b16 v[126:127], v2 offset:1280
    s_waitcnt lgkmcnt(10)
    v_mfma_f32_32x32x16_bf16 v[56:71], v[152:155], v[228:231], v[56:71]
    buffer_load_dwordx4 v[204:207], v3, s[32:35], s50 offen offset:1024 sc1
    ds_read_b64_tr_b16 v[128:129], v2 offset:2048
    ds_read_b64_tr_b16 v[130:131], v2 offset:2304
    s_waitcnt lgkmcnt(10)
    v_mfma_f32_32x32x16_bf16 v[72:87], v[156:159], v[228:231], v[72:87]
    ds_read_b64_tr_b16 v[132:133], v2 offset:3072
    ds_read_b64_tr_b16 v[134:135], v2 offset:3328
    s_waitcnt lgkmcnt(10)
    v_mfma_f32_32x32x16_bf16 v[88:103], v[160:163], v[228:231], v[88:103]
    ds_read_b64_tr_b16 v[136:137], v2 offset:4096
    ds_read_b64_tr_b16 v[138:139], v2 offset:4352
    s_waitcnt lgkmcnt(10)
    v_mfma_f32_32x32x16_bf16 v[104:119], v[164:167], v[228:231], v[104:119]
    ds_read_b64_tr_b16 v[140:141], v2 offset:5120
    ds_read_b64_tr_b16 v[142:143], v2 offset:5376
    s_waitcnt vmcnt(9) lgkmcnt(10)
    v_mfma_f32_32x32x16_bf16 v[24:39], v[120:123], v[168:171], v[24:39]
    ds_read_b64_tr_b16 v[144:145], v2 offset:6144
    ds_read_b64_tr_b16 v[146:147], v2 offset:6400
    s_waitcnt lgkmcnt(10)
    v_mfma_f32_32x32x16_bf16 v[40:55], v[124:127], v[168:171], v[40:55]
    ds_read_b64_tr_b16 v[148:149], v2 offset:7168
    ds_read_b64_tr_b16 v[150:151], v2 offset:7424
    s_waitcnt lgkmcnt(10)
    v_mfma_f32_32x32x16_bf16 v[56:71], v[128:131], v[168:171], v[56:71]
    buffer_load_dwordx4 v[208:211], v3, s[32:35], s50 offen offset:2048 sc1
    ds_read_b64_tr_b16 v[152:153], v2 offset:8192
    ds_read_b64_tr_b16 v[154:155], v2 offset:8448
    s_waitcnt lgkmcnt(10)
    v_mfma_f32_32x32x16_bf16 v[72:87], v[132:135], v[168:171], v[72:87]
    ds_read_b64_tr_b16 v[156:157], v2 offset:9216
    ds_read_b64_tr_b16 v[158:159], v2 offset:9472
    s_waitcnt lgkmcnt(10)
    v_mfma_f32_32x32x16_bf16 v[88:103], v[136:139], v[168:171], v[88:103]
    ds_read_b64_tr_b16 v[160:161], v2 offset:10240
    ds_read_b64_tr_b16 v[162:163], v2 offset:10496
    s_waitcnt lgkmcnt(10)
    v_mfma_f32_32x32x16_bf16 v[104:119], v[140:143], v[168:171], v[104:119]
    ds_read_b64_tr_b16 v[164:165], v2 offset:11264
    ds_read_b64_tr_b16 v[166:167], v2 offset:11520
    s_waitcnt vmcnt(9) lgkmcnt(10)
    v_mfma_f32_32x32x16_bf16 v[24:39], v[144:147], v[172:175], v[24:39]
    ds_read_b64_tr_b16 v[120:121], v2 offset:12288
    ds_read_b64_tr_b16 v[122:123], v2 offset:12544
    s_waitcnt lgkmcnt(10)
    v_mfma_f32_32x32x16_bf16 v[40:55], v[148:151], v[172:175], v[40:55]
    ds_read_b64_tr_b16 v[124:125], v2 offset:13312
    ds_read_b64_tr_b16 v[126:127], v2 offset:13568
    s_waitcnt lgkmcnt(10)
    v_mfma_f32_32x32x16_bf16 v[56:71], v[152:155], v[172:175], v[56:71]
    buffer_load_dwordx4 v[212:215], v3, s[32:35], s50 offen offset:3072 sc1
    ds_read_b64_tr_b16 v[128:129], v2 offset:14336
    ds_read_b64_tr_b16 v[130:131], v2 offset:14592
    s_waitcnt lgkmcnt(10)
    v_mfma_f32_32x32x16_bf16 v[72:87], v[156:159], v[172:175], v[72:87]
    ds_read_b64_tr_b16 v[132:133], v2 offset:15360
    ds_read_b64_tr_b16 v[134:135], v2 offset:15616
    s_waitcnt lgkmcnt(10)
    v_mfma_f32_32x32x16_bf16 v[88:103], v[160:163], v[172:175], v[88:103]
    ds_read_b64_tr_b16 v[136:137], v2 offset:16384
    ds_read_b64_tr_b16 v[138:139], v2 offset:16640
    s_waitcnt lgkmcnt(10)
    v_mfma_f32_32x32x16_bf16 v[104:119], v[164:167], v[172:175], v[104:119]
    ds_read_b64_tr_b16 v[140:141], v2 offset:17408
    ds_read_b64_tr_b16 v[142:143], v2 offset:17664
    s_waitcnt vmcnt(9) lgkmcnt(10)
    v_mfma_f32_32x32x16_bf16 v[24:39], v[120:123], v[176:179], v[24:39]
    ds_read_b64_tr_b16 v[144:145], v2 offset:18432
    ds_read_b64_tr_b16 v[146:147], v2 offset:18688
    s_waitcnt lgkmcnt(10)
    v_mfma_f32_32x32x16_bf16 v[40:55], v[124:127], v[176:179], v[40:55]
    ds_read_b64_tr_b16 v[148:149], v2 offset:19456
    ds_read_b64_tr_b16 v[150:151], v2 offset:19712
    s_waitcnt lgkmcnt(10)
    v_mfma_f32_32x32x16_bf16 v[56:71], v[128:131], v[176:179], v[56:71]
    s_add_u32 s50, s48, 28672
    buffer_load_dwordx4 v[216:219], v3, s[32:35], s50 offen offset:0 sc1
    ds_read_b64_tr_b16 v[152:153], v2 offset:20480
    ds_read_b64_tr_b16 v[154:155], v2 offset:20736
    s_waitcnt lgkmcnt(10)
    v_mfma_f32_32x32x16_bf16 v[72:87], v[132:135], v[176:179], v[72:87]
    ds_read_b64_tr_b16 v[156:157], v2 offset:21504
    ds_read_b64_tr_b16 v[158:159], v2 offset:21760
    s_waitcnt lgkmcnt(10)
    v_mfma_f32_32x32x16_bf16 v[88:103], v[136:139], v[176:179], v[88:103]
    ds_read_b64_tr_b16 v[160:161], v2 offset:22528
    ds_read_b64_tr_b16 v[162:163], v2 offset:22784
    s_waitcnt lgkmcnt(10)
    v_mfma_f32_32x32x16_bf16 v[104:119], v[140:143], v[176:179], v[104:119]
    ds_read_b64_tr_b16 v[164:165], v2 offset:23552
    ds_read_b64_tr_b16 v[166:167], v2 offset:23808
    v_add_u32 v2, 0x6000, v2
    s_waitcnt vmcnt(9) lgkmcnt(10)
    v_mfma_f32_32x32x16_bf16 v[24:39], v[144:147], v[180:183], v[24:39]
    ds_read_b64_tr_b16 v[120:121], v2 offset:0
    ds_read_b64_tr_b16 v[122:123], v2 offset:256
    s_waitcnt lgkmcnt(10)
    v_mfma_f32_32x32x16_bf16 v[40:55], v[148:151], v[180:183], v[40:55]
    ds_read_b64_tr_b16 v[124:125], v2 offset:1024
    ds_read_b64_tr_b16 v[126:127], v2 offset:1280
    s_waitcnt lgkmcnt(10)
    v_mfma_f32_32x32x16_bf16 v[56:71], v[152:155], v[180:183], v[56:71]
    buffer_load_dwordx4 v[220:223], v3, s[32:35], s50 offen offset:1024 sc1
    ds_read_b64_tr_b16 v[128:129], v2 offset:2048
    ds_read_b64_tr_b16 v[130:131], v2 offset:2304
    s_waitcnt lgkmcnt(10)
    v_mfma_f32_32x32x16_bf16 v[72:87], v[156:159], v[180:183], v[72:87]
    ds_read_b64_tr_b16 v[132:133], v2 offset:3072
    ds_read_b64_tr_b16 v[134:135], v2 offset:3328
    s_waitcnt lgkmcnt(10)
    v_mfma_f32_32x32x16_bf16 v[88:103], v[160:163], v[180:183], v[88:103]
    ds_read_b64_tr_b16 v[136:137], v2 offset:4096
    ds_read_b64_tr_b16 v[138:139], v2 offset:4352
    s_waitcnt lgkmcnt(10)
    v_mfma_f32_32x32x16_bf16 v[104:119], v[164:167], v[180:183], v[104:119]
    ds_read_b64_tr_b16 v[140:141], v2 offset:5120
    ds_read_b64_tr_b16 v[142:143], v2 offset:5376
    s_waitcnt vmcnt(9) lgkmcnt(10)
    v_mfma_f32_32x32x16_bf16 v[24:39], v[120:123], v[184:187], v[24:39]
    ds_read_b64_tr_b16 v[144:145], v2 offset:6144
L_pad13:
    s_cbranch_execz L_pad17
    ds_read_b64_tr_b16 v[146:147], v2 offset:6400
    s_waitcnt lgkmcnt(10)
    v_mfma_f32_32x32x16_bf16 v[40:55], v[124:127], v[184:187], v[40:55]
    ds_read_b64_tr_b16 v[148:149], v2 offset:7168
    ds_read_b64_tr_b16 v[150:151], v2 offset:7424
    s_waitcnt lgkmcnt(10)
    v_mfma_f32_32x32x16_bf16 v[56:71], v[128:131], v[184:187], v[56:71]
    buffer_load_dwordx4 v[224:227], v3, s[32:35], s50 offen offset:2048 sc1
    ds_read_b64_tr_b16 v[152:153], v2 offset:8192
    ds_read_b64_tr_b16 v[154:155], v2 offset:8448
    s_waitcnt lgkmcnt(10)
    v_mfma_f32_32x32x16_bf16 v[72:87], v[132:135], v[184:187], v[72:87]
    ds_read_b64_tr_b16 v[156:157], v2 offset:9216
    ds_read_b64_tr_b16 v[158:159], v2 offset:9472
    s_waitcnt lgkmcnt(10)
    v_mfma_f32_32x32x16_bf16 v[88:103], v[136:139], v[184:187], v[88:103]
    ds_read_b64_tr_b16 v[160:161], v2 offset:10240
    ds_read_b64_tr_b16 v[162:163], v2 offset:10496
    s_waitcnt lgkmcnt(10)
    v_mfma_f32_32x32x16_bf16 v[104:119], v[140:143], v[184:187], v[104:119]
    ds_read_b64_tr_b16 v[164:165], v2 offset:11264
    ds_read_b64_tr_b16 v[166:167], v2 offset:11520
    s_waitcnt vmcnt(9) lgkmcnt(10)
    v_mfma_f32_32x32x16_bf16 v[24:39], v[144:147], v[188:191], v[24:39]
    ds_read_b64_tr_b16 v[120:121], v2 offset:12288
    ds_read_b64_tr_b16 v[122:123], v2 offset:12544
    s_waitcnt lgkmcnt(10)
    v_mfma_f32_32x32x16_bf16 v[40:55], v[148:151], v[188:191], v[40:55]
    ds_read_b64_tr_b16 v[124:125], v2 offset:13312
    ds_read_b64_tr_b16 v[126:127], v2 offset:13568
    s_waitcnt lgkmcnt(10)
    v_mfma_f32_32x32x16_bf16 v[56:71], v[152:155], v[188:191], v[56:71]
    buffer_load_dwordx4 v[228:231], v3, s[32:35], s50 offen offset:3072 sc1
    ds_read_b64_tr_b16 v[128:129], v2 offset:14336
    ds_read_b64_tr_b16 v[130:131], v2 offset:14592
    s_waitcnt lgkmcnt(10)
    v_mfma_f32_32x32x16_bf16 v[72:87], v[156:159], v[188:191], v[72:87]
    ds_read_b64_tr_b16 v[132:133], v2 offset:15360
    ds_read_b64_tr_b16 v[134:135], v2 offset:15616
    s_waitcnt lgkmcnt(10)
    v_mfma_f32_32x32x16_bf16 v[88:103], v[160:163], v[188:191], v[88:103]
    ds_read_b64_tr_b16 v[136:137], v2 offset:16384
    ds_read_b64_tr_b16 v[138:139], v2 offset:16640
    s_waitcnt lgkmcnt(10)
    v_mfma_f32_32x32x16_bf16 v[104:119], v[164:167], v[188:191], v[104:119]
    ds_read_b64_tr_b16 v[140:141], v2 offset:17408
    ds_read_b64_tr_b16 v[142:143], v2 offset:17664
    s_waitcnt vmcnt(9) lgkmcnt(10)
    v_mfma_f32_32x32x16_bf16 v[24:39], v[120:123], v[192:195], v[24:39]
    ds_read_b64_tr_b16 v[144:145], v2 offset:18432
    ds_read_b64_tr_b16 v[146:147], v2 offset:18688
    s_waitcnt lgkmcnt(10)
    v_mfma_f32_32x32x16_bf16 v[40:55], v[124:127], v[192:195], v[40:55]
    ds_read_b64_tr_b16 v[148:149], v2 offset:19456
    ds_read_b64_tr_b16 v[150:151], v2 offset:19712
    s_waitcnt lgkmcnt(10)
    v_mfma_f32_32x32x16_bf16 v[56:71], v[128:131], v[192:195], v[56:71]
    s_add_u32 s50, s48, 32768
    buffer_load_dwordx4 v[168:171], v3, s[32:35], s50 offen offset:0 sc1
    ds_read_b64_tr_b16 v[152:153], v2 offset:20480
    ds_read_b64_tr_b16 v[154:155], v2 offset:20736
    s_waitcnt lgkmcnt(10)
    v_mfma_f32_32x32x16_bf16 v[72:87], v[132:135], v[192:195], v[72:87]
    ds_read_b64_tr_b16 v[156:157], v2 offset:21504
    ds_read_b64_tr_b16 v[158:159], v2 offset:21760
    s_waitcnt lgkmcnt(10)
    v_mfma_f32_32x32x16_bf16 v[88:103], v[136:139], v[192:195], v[88:103]
    ds_read_b64_tr_b16 v[160:161], v2 offset:22528
    ds_read_b64_tr_b16 v[162:163], v2 offset:22784
    s_waitcnt lgkmcnt(10)
    v_mfma_f32_32x32x16_bf16 v[104:119], v[140:143], v[192:195], v[104:119]
    ds_read_b64_tr_b16 v[164:165], v2 offset:23552
    ds_read_b64_tr_b16 v[166:167], v2 offset:23808
    v_add_u32 v2, 0xfffe2000, v2
    s_barrier
    s_waitcnt vmcnt(9) lgkmcnt(10)
    v_mfma_f32_32x32x16_bf16 v[24:39], v[144:147], v[196:199], v[24:39]
    ds_read_b64_tr_b16 v[120:121], v2 offset:0
    ds_read_b64_tr_b16 v[122:123], v2 offset:256
    s_waitcnt lgkmcnt(10)
    v_mfma_f32_32x32x16_bf16 v[40:55], v[148:151], v[196:199], v[40:55]
    ds_read_b64_tr_b16 v[124:125], v2 offset:1024
    ds_read_b64_tr_b16 v[126:127], v2 offset:1280
    s_waitcnt lgkmcnt(10)
    v_mfma_f32_32x32x16_bf16 v[56:71], v[152:155], v[196:199], v[56:71]
    buffer_load_dwordx4 v[172:175], v3, s[32:35], s50 offen offset:1024 sc1
    ds_read_b64_tr_b16 v[128:129], v2 offset:2048
    ds_read_b64_tr_b16 v[130:131], v2 offset:2304
    s_waitcnt lgkmcnt(10)
    v_mfma_f32_32x32x16_bf16 v[72:87], v[156:159], v[196:199], v[72:87]
    ds_read_b64_tr_b16 v[132:133], v2 offset:3072
    ds_read_b64_tr_b16 v[134:135], v2 offset:3328
    s_waitcnt lgkmcnt(10)
    v_mfma_f32_32x32x16_bf16 v[88:103], v[160:163], v[196:199], v[88:103]
    ds_read_b64_tr_b16 v[136:137], v2 offset:4096
    ds_read_b64_tr_b16 v[138:139], v2 offset:4352
    s_waitcnt lgkmcnt(10)
    v_mfma_f32_32x32x16_bf16 v[104:119], v[164:167], v[196:199], v[104:119]
    ds_read_b64_tr_b16 v[140:141], v2 offset:5120
    ds_read_b64_tr_b16 v[142:143], v2 offset:5376
    s_waitcnt vmcnt(9) lgkmcnt(10)
    v_mfma_f32_32x32x16_bf16 v[24:39], v[120:123], v[200:203], v[24:39]
    ds_read_b64_tr_b16 v[144:145], v2 offset:6144
    ds_read_b64_tr_b16 v[146:147], v2 offset:6400
    s_waitcnt lgkmcnt(10)
    v_mfma_f32_32x32x16_bf16 v[40:55], v[124:127], v[200:203], v[40:55]
    ds_read_b64_tr_b16 v[148:149], v2 offset:7168
    ds_read_b64_tr_b16 v[150:151], v2 offset:7424
    s_waitcnt lgkmcnt(10)
    v_mfma_f32_32x32x16_bf16 v[56:71], v[128:131], v[200:203], v[56:71]
    buffer_load_dwordx4 v[176:179], v3, s[32:35], s50 offen offset:2048 sc1
    ds_read_b64_tr_b16 v[152:153], v2 offset:8192
    ds_read_b64_tr_b16 v[154:155], v2 offset:8448
    s_waitcnt lgkmcnt(10)
    v_mfma_f32_32x32x16_bf16 v[72:87], v[132:135], v[200:203], v[72:87]
    ds_read_b64_tr_b16 v[156:157], v2 offset:9216
    ds_read_b64_tr_b16 v[158:159], v2 offset:9472
    s_waitcnt lgkmcnt(10)
    v_mfma_f32_32x32x16_bf16 v[88:103], v[136:139], v[200:203], v[88:103]
    ds_read_b64_tr_b16 v[160:161], v2 offset:10240
    ds_read_b64_tr_b16 v[162:163], v2 offset:10496
    s_waitcnt lgkmcnt(10)
    v_mfma_f32_32x32x16_bf16 v[104:119], v[140:143], v[200:203], v[104:119]
    ds_read_b64_tr_b16 v[164:165], v2 offset:11264
    ds_read_b64_tr_b16 v[166:167], v2 offset:11520
    s_waitcnt vmcnt(9) lgkmcnt(10)
    v_mfma_f32_32x32x16_bf16 v[24:39], v[144:147], v[204:207], v[24:39]
    ds_read_b64_tr_b16 v[120:121], v2 offset:12288
    ds_read_b64_tr_b16 v[122:123], v2 offset:12544
    s_waitcnt lgkmcnt(10)
    v_mfma_f32_32x32x16_bf16 v[40:55], v[148:151], v[204:207], v[40:55]
    ds_read_b64_tr_b16 v[124:125], v2 offset:13312
    ds_read_b64_tr_b16 v[126:127], v2 offset:13568
    s_waitcnt lgkmcnt(10)
    v_mfma_f32_32x32x16_bf16 v[56:71], v[152:155], v[204:207], v[56:71]
    buffer_load_dwordx4 v[180:183], v3, s[32:35], s50 offen offset:3072 sc1
    ds_read_b64_tr_b16 v[128:129], v2 offset:14336
    ds_read_b64_tr_b16 v[130:131], v2 offset:14592
    s_waitcnt lgkmcnt(10)
    v_mfma_f32_32x32x16_bf16 v[72:87], v[156:159], v[204:207], v[72:87]
    ds_read_b64_tr_b16 v[132:133], v2 offset:15360
    ds_read_b64_tr_b16 v[134:135], v2 offset:15616
    s_waitcnt lgkmcnt(10)
    v_mfma_f32_32x32x16_bf16 v[88:103], v[160:163], v[204:207], v[88:103]
    ds_read_b64_tr_b16 v[136:137], v2 offset:16384
L_pad14:
    s_cbranch_execz L_pad18
    ds_read_b64_tr_b16 v[138:139], v2 offset:16640
    s_waitcnt lgkmcnt(10)
    v_mfma_f32_32x32x16_bf16 v[104:119], v[164:167], v[204:207], v[104:119]
    ds_read_b64_tr_b16 v[140:141], v2 offset:17408
    ds_read_b64_tr_b16 v[142:143], v2 offset:17664
    s_waitcnt vmcnt(9) lgkmcnt(10)
    v_mfma_f32_32x32x16_bf16 v[24:39], v[120:123], v[208:211], v[24:39]
    ds_read_b64_tr_b16 v[144:145], v2 offset:18432
    ds_read_b64_tr_b16 v[146:147], v2 offset:18688
    s_waitcnt lgkmcnt(10)
    v_mfma_f32_32x32x16_bf16 v[40:55], v[124:127], v[208:211], v[40:55]
    ds_read_b64_tr_b16 v[148:149], v2 offset:19456
    ds_read_b64_tr_b16 v[150:151], v2 offset:19712
    s_waitcnt lgkmcnt(10)
    v_mfma_f32_32x32x16_bf16 v[56:71], v[128:131], v[208:211], v[56:71]
    s_add_u32 s50, s48, 36864
    buffer_load_dwordx4 v[184:187], v3, s[32:35], s50 offen offset:0 sc1
    ds_read_b64_tr_b16 v[152:153], v2 offset:20480
    ds_read_b64_tr_b16 v[154:155], v2 offset:20736
    s_waitcnt lgkmcnt(10)
    v_mfma_f32_32x32x16_bf16 v[72:87], v[132:135], v[208:211], v[72:87]
    ds_read_b64_tr_b16 v[156:157], v2 offset:21504
    ds_read_b64_tr_b16 v[158:159], v2 offset:21760
    s_waitcnt lgkmcnt(10)
    v_mfma_f32_32x32x16_bf16 v[88:103], v[136:139], v[208:211], v[88:103]
    ds_read_b64_tr_b16 v[160:161], v2 offset:22528
    ds_read_b64_tr_b16 v[162:163], v2 offset:22784
    s_waitcnt lgkmcnt(10)
    v_mfma_f32_32x32x16_bf16 v[104:119], v[140:143], v[208:211], v[104:119]
    ds_read_b64_tr_b16 v[164:165], v2 offset:23552
    ds_read_b64_tr_b16 v[166:167], v2 offset:23808
    v_add_u32 v2, 0x6000, v2
    s_waitcnt vmcnt(9) lgkmcnt(10)
    v_mfma_f32_32x32x16_bf16 v[24:39], v[144:147], v[212:215], v[24:39]
    ds_read_b64_tr_b16 v[120:121], v2 offset:0
    ds_read_b64_tr_b16 v[122:123], v2 offset:256
    s_waitcnt lgkmcnt(10)
    v_mfma_f32_32x32x16_bf16 v[40:55], v[148:151], v[212:215], v[40:55]
    ds_read_b64_tr_b16 v[124:125], v2 offset:1024
    ds_read_b64_tr_b16 v[126:127], v2 offset:1280
    s_waitcnt lgkmcnt(10)
    v_mfma_f32_32x32x16_bf16 v[56:71], v[152:155], v[212:215], v[56:71]
    buffer_load_dwordx4 v[188:191], v3, s[32:35], s50 offen offset:1024 sc1
    ds_read_b64_tr_b16 v[128:129], v2 offset:2048
    ds_read_b64_tr_b16 v[130:131], v2 offset:2304
    s_waitcnt lgkmcnt(10)
    v_mfma_f32_32x32x16_bf16 v[72:87], v[156:159], v[212:215], v[72:87]
    ds_read_b64_tr_b16 v[132:133], v2 offset:3072
    ds_read_b64_tr_b16 v[134:135], v2 offset:3328
    s_waitcnt lgkmcnt(10)
    v_mfma_f32_32x32x16_bf16 v[88:103], v[160:163], v[212:215], v[88:103]
    ds_read_b64_tr_b16 v[136:137], v2 offset:4096
    ds_read_b64_tr_b16 v[138:139], v2 offset:4352
    s_waitcnt lgkmcnt(10)
    v_mfma_f32_32x32x16_bf16 v[104:119], v[164:167], v[212:215], v[104:119]
    ds_read_b64_tr_b16 v[140:141], v2 offset:5120
    ds_read_b64_tr_b16 v[142:143], v2 offset:5376
    s_waitcnt vmcnt(9) lgkmcnt(10)
    v_mfma_f32_32x32x16_bf16 v[24:39], v[120:123], v[216:219], v[24:39]
    ds_read_b64_tr_b16 v[144:145], v2 offset:6144
    ds_read_b64_tr_b16 v[146:147], v2 offset:6400
    s_waitcnt lgkmcnt(10)
    v_mfma_f32_32x32x16_bf16 v[40:55], v[124:127], v[216:219], v[40:55]
    ds_read_b64_tr_b16 v[148:149], v2 offset:7168
    ds_read_b64_tr_b16 v[150:151], v2 offset:7424
    s_waitcnt lgkmcnt(10)
    v_mfma_f32_32x32x16_bf16 v[56:71], v[128:131], v[216:219], v[56:71]
    buffer_load_dwordx4 v[192:195], v3, s[32:35], s50 offen offset:2048 sc1
    ds_read_b64_tr_b16 v[152:153], v2 offset:8192
    ds_read_b64_tr_b16 v[154:155], v2 offset:8448
    s_waitcnt lgkmcnt(10)
    v_mfma_f32_32x32x16_bf16 v[72:87], v[132:135], v[216:219], v[72:87]
    ds_read_b64_tr_b16 v[156:157], v2 offset:9216
    ds_read_b64_tr_b16 v[158:159], v2 offset:9472
    s_waitcnt lgkmcnt(10)
    v_mfma_f32_32x32x16_bf16 v[88:103], v[136:139], v[216:219], v[88:103]
    ds_read_b64_tr_b16 v[160:161], v2 offset:10240
    ds_read_b64_tr_b16 v[162:163], v2 offset:10496
    s_waitcnt lgkmcnt(10)
    v_mfma_f32_32x32x16_bf16 v[104:119], v[140:143], v[216:219], v[104:119]
    ds_read_b64_tr_b16 v[164:165], v2 offset:11264
    ds_read_b64_tr_b16 v[166:167], v2 offset:11520
    s_waitcnt vmcnt(9) lgkmcnt(10)
    v_mfma_f32_32x32x16_bf16 v[24:39], v[144:147], v[220:223], v[24:39]
    ds_read_b64_tr_b16 v[120:121], v2 offset:12288
    ds_read_b64_tr_b16 v[122:123], v2 offset:12544
    s_waitcnt lgkmcnt(10)
    v_mfma_f32_32x32x16_bf16 v[40:55], v[148:151], v[220:223], v[40:55]
    ds_read_b64_tr_b16 v[124:125], v2 offset:13312
    ds_read_b64_tr_b16 v[126:127], v2 offset:13568
    s_waitcnt lgkmcnt(10)
    v_mfma_f32_32x32x16_bf16 v[56:71], v[152:155], v[220:223], v[56:71]
    buffer_load_dwordx4 v[196:199], v3, s[32:35], s50 offen offset:3072 sc1
    ds_read_b64_tr_b16 v[128:129], v2 offset:14336
    ds_read_b64_tr_b16 v[130:131], v2 offset:14592
    s_waitcnt lgkmcnt(10)
    v_mfma_f32_32x32x16_bf16 v[72:87], v[156:159], v[220:223], v[72:87]
    ds_read_b64_tr_b16 v[132:133], v2 offset:15360
    ds_read_b64_tr_b16 v[134:135], v2 offset:15616
    s_waitcnt lgkmcnt(10)
    v_mfma_f32_32x32x16_bf16 v[88:103], v[160:163], v[220:223], v[88:103]
    ds_read_b64_tr_b16 v[136:137], v2 offset:16384
    ds_read_b64_tr_b16 v[138:139], v2 offset:16640
    s_waitcnt lgkmcnt(10)
    v_mfma_f32_32x32x16_bf16 v[104:119], v[164:167], v[220:223], v[104:119]
    ds_read_b64_tr_b16 v[140:141], v2 offset:17408
    ds_read_b64_tr_b16 v[142:143], v2 offset:17664
    s_waitcnt vmcnt(9) lgkmcnt(10)
    v_mfma_f32_32x32x16_bf16 v[24:39], v[120:123], v[224:227], v[24:39]
    ds_read_b64_tr_b16 v[144:145], v2 offset:18432
    ds_read_b64_tr_b16 v[146:147], v2 offset:18688
    s_waitcnt lgkmcnt(10)
    v_mfma_f32_32x32x16_bf16 v[40:55], v[124:127], v[224:227], v[40:55]
    ds_read_b64_tr_b16 v[148:149], v2 offset:19456
    ds_read_b64_tr_b16 v[150:151], v2 offset:19712
    s_waitcnt lgkmcnt(10)
    v_mfma_f32_32x32x16_bf16 v[56:71], v[128:131], v[224:227], v[56:71]
    ds_read_b64_tr_b16 v[152:153], v2 offset:20480
    ds_read_b64_tr_b16 v[154:155], v2 offset:20736
    s_waitcnt lgkmcnt(10)
    v_mfma_f32_32x32x16_bf16 v[72:87], v[132:135], v[224:227], v[72:87]
    ds_read_b64_tr_b16 v[156:157], v2 offset:21504
    ds_read_b64_tr_b16 v[158:159], v2 offset:21760
    s_waitcnt lgkmcnt(10)
    v_mfma_f32_32x32x16_bf16 v[88:103], v[136:139], v[224:227], v[88:103]
    ds_read_b64_tr_b16 v[160:161], v2 offset:22528
    ds_read_b64_tr_b16 v[162:163], v2 offset:22784
    s_waitcnt lgkmcnt(10)
    v_mfma_f32_32x32x16_bf16 v[104:119], v[140:143], v[224:227], v[104:119]
    ds_read_b64_tr_b16 v[164:165], v2 offset:23552
    ds_read_b64_tr_b16 v[166:167], v2 offset:23808
    v_add_u32 v2, 0x6000, v2
    s_barrier
    s_waitcnt vmcnt(8) lgkmcnt(10)
    v_mfma_f32_32x32x16_bf16 v[24:39], v[144:147], v[228:231], v[24:39]
    ds_read_b64_tr_b16 v[120:121], v2 offset:0
    ds_read_b64_tr_b16 v[122:123], v2 offset:256
    s_waitcnt lgkmcnt(10)
    v_mfma_f32_32x32x16_bf16 v[40:55], v[148:151], v[228:231], v[40:55]
    ds_read_b64_tr_b16 v[124:125], v2 offset:1024
    ds_read_b64_tr_b16 v[126:127], v2 offset:1280
    s_waitcnt lgkmcnt(10)
    v_mfma_f32_32x32x16_bf16 v[56:71], v[152:155], v[228:231], v[56:71]
    ds_read_b64_tr_b16 v[128:129], v2 offset:2048
    ds_read_b64_tr_b16 v[130:131], v2 offset:2304
L_pad15:
    s_cbranch_execz L_pad19
    s_waitcnt lgkmcnt(10)
    v_mfma_f32_32x32x16_bf16 v[72:87], v[156:159], v[228:231], v[72:87]
    ds_read_b64_tr_b16 v[132:133], v2 offset:3072
    ds_read_b64_tr_b16 v[134:135], v2 offset:3328
    s_waitcnt lgkmcnt(10)
    v_mfma_f32_32x32x16_bf16 v[88:103], v[160:163], v[228:231], v[88:103]
    ds_read_b64_tr_b16 v[136:137], v2 offset:4096
    ds_read_b64_tr_b16 v[138:139], v2 offset:4352
    s_waitcnt lgkmcnt(10)
    v_mfma_f32_32x32x16_bf16 v[104:119], v[164:167], v[228:231], v[104:119]
    ds_read_b64_tr_b16 v[140:141], v2 offset:5120
    ds_read_b64_tr_b16 v[142:143], v2 offset:5376
    s_waitcnt vmcnt(7) lgkmcnt(10)
    v_mfma_f32_32x32x16_bf16 v[24:39], v[120:123], v[168:171], v[24:39]
    ds_read_b64_tr_b16 v[144:145], v2 offset:6144
    ds_read_b64_tr_b16 v[146:147], v2 offset:6400
    s_waitcnt lgkmcnt(10)
    v_mfma_f32_32x32x16_bf16 v[40:55], v[124:127], v[168:171], v[40:55]
    ds_read_b64_tr_b16 v[148:149], v2 offset:7168
    ds_read_b64_tr_b16 v[150:151], v2 offset:7424
    s_waitcnt lgkmcnt(10)
    v_mfma_f32_32x32x16_bf16 v[56:71], v[128:131], v[168:171], v[56:71]
    ds_read_b64_tr_b16 v[152:153], v2 offset:8192
    ds_read_b64_tr_b16 v[154:155], v2 offset:8448
    s_waitcnt lgkmcnt(10)
    v_mfma_f32_32x32x16_bf16 v[72:87], v[132:135], v[168:171], v[72:87]
    ds_read_b64_tr_b16 v[156:157], v2 offset:9216
    ds_read_b64_tr_b16 v[158:159], v2 offset:9472
    s_waitcnt lgkmcnt(10)
    v_mfma_f32_32x32x16_bf16 v[88:103], v[136:139], v[168:171], v[88:103]
    ds_read_b64_tr_b16 v[160:161], v2 offset:10240
    ds_read_b64_tr_b16 v[162:163], v2 offset:10496
    s_waitcnt lgkmcnt(10)
    v_mfma_f32_32x32x16_bf16 v[104:119], v[140:143], v[168:171], v[104:119]
    ds_read_b64_tr_b16 v[164:165], v2 offset:11264
    ds_read_b64_tr_b16 v[166:167], v2 offset:11520
    s_waitcnt vmcnt(6) lgkmcnt(10)
    v_mfma_f32_32x32x16_bf16 v[24:39], v[144:147], v[172:175], v[24:39]
    ds_read_b64_tr_b16 v[120:121], v2 offset:12288
    ds_read_b64_tr_b16 v[122:123], v2 offset:12544
    s_waitcnt lgkmcnt(10)
    v_mfma_f32_32x32x16_bf16 v[40:55], v[148:151], v[172:175], v[40:55]
    ds_read_b64_tr_b16 v[124:125], v2 offset:13312
    ds_read_b64_tr_b16 v[126:127], v2 offset:13568
    s_waitcnt lgkmcnt(10)
    v_mfma_f32_32x32x16_bf16 v[56:71], v[152:155], v[172:175], v[56:71]
    ds_read_b64_tr_b16 v[128:129], v2 offset:14336
    ds_read_b64_tr_b16 v[130:131], v2 offset:14592
    s_waitcnt lgkmcnt(10)
    v_mfma_f32_32x32x16_bf16 v[72:87], v[156:159], v[172:175], v[72:87]
    ds_read_b64_tr_b16 v[132:133], v2 offset:15360
    ds_read_b64_tr_b16 v[134:135], v2 offset:15616
    s_waitcnt lgkmcnt(10)
    v_mfma_f32_32x32x16_bf16 v[88:103], v[160:163], v[172:175], v[88:103]
    ds_read_b64_tr_b16 v[136:137], v2 offset:16384
    ds_read_b64_tr_b16 v[138:139], v2 offset:16640
    s_waitcnt lgkmcnt(10)
    v_mfma_f32_32x32x16_bf16 v[104:119], v[164:167], v[172:175], v[104:119]
    ds_read_b64_tr_b16 v[140:141], v2 offset:17408
    ds_read_b64_tr_b16 v[142:143], v2 offset:17664
    s_waitcnt vmcnt(5) lgkmcnt(10)
    v_mfma_f32_32x32x16_bf16 v[24:39], v[120:123], v[176:179], v[24:39]
    ds_read_b64_tr_b16 v[144:145], v2 offset:18432
    ds_read_b64_tr_b16 v[146:147], v2 offset:18688
    s_waitcnt lgkmcnt(10)
    v_mfma_f32_32x32x16_bf16 v[40:55], v[124:127], v[176:179], v[40:55]
    ds_read_b64_tr_b16 v[148:149], v2 offset:19456
    ds_read_b64_tr_b16 v[150:151], v2 offset:19712
    s_waitcnt lgkmcnt(10)
    v_mfma_f32_32x32x16_bf16 v[56:71], v[128:131], v[176:179], v[56:71]
    ds_read_b64_tr_b16 v[152:153], v2 offset:20480
    ds_read_b64_tr_b16 v[154:155], v2 offset:20736
    s_waitcnt lgkmcnt(10)
    v_mfma_f32_32x32x16_bf16 v[72:87], v[132:135], v[176:179], v[72:87]
    ds_read_b64_tr_b16 v[156:157], v2 offset:21504
    ds_read_b64_tr_b16 v[158:159], v2 offset:21760
    s_waitcnt lgkmcnt(10)
    v_mfma_f32_32x32x16_bf16 v[88:103], v[136:139], v[176:179], v[88:103]
    ds_read_b64_tr_b16 v[160:161], v2 offset:22528
    ds_read_b64_tr_b16 v[162:163], v2 offset:22784
    s_waitcnt lgkmcnt(10)
    v_mfma_f32_32x32x16_bf16 v[104:119], v[140:143], v[176:179], v[104:119]
    ds_read_b64_tr_b16 v[164:165], v2 offset:23552
    ds_read_b64_tr_b16 v[166:167], v2 offset:23808
    v_add_u32 v2, 0x6000, v2
    s_waitcnt vmcnt(4) lgkmcnt(10)
    v_mfma_f32_32x32x16_bf16 v[24:39], v[144:147], v[180:183], v[24:39]
    ds_read_b64_tr_b16 v[120:121], v2 offset:0
    ds_read_b64_tr_b16 v[122:123], v2 offset:256
    s_waitcnt lgkmcnt(10)
    v_mfma_f32_32x32x16_bf16 v[40:55], v[148:151], v[180:183], v[40:55]
    ds_read_b64_tr_b16 v[124:125], v2 offset:1024
    ds_read_b64_tr_b16 v[126:127], v2 offset:1280
    s_waitcnt lgkmcnt(10)
    v_mfma_f32_32x32x16_bf16 v[56:71], v[152:155], v[180:183], v[56:71]
    ds_read_b64_tr_b16 v[128:129], v2 offset:2048
    ds_read_b64_tr_b16 v[130:131], v2 offset:2304
    s_waitcnt lgkmcnt(10)
    v_mfma_f32_32x32x16_bf16 v[72:87], v[156:159], v[180:183], v[72:87]
    ds_read_b64_tr_b16 v[132:133], v2 offset:3072
    ds_read_b64_tr_b16 v[134:135], v2 offset:3328
    s_waitcnt lgkmcnt(10)
    v_mfma_f32_32x32x16_bf16 v[88:103], v[160:163], v[180:183], v[88:103]
    ds_read_b64_tr_b16 v[136:137], v2 offset:4096
    ds_read_b64_tr_b16 v[138:139], v2 offset:4352
    s_waitcnt lgkmcnt(10)
    v_mfma_f32_32x32x16_bf16 v[104:119], v[164:167], v[180:183], v[104:119]
    ds_read_b64_tr_b16 v[140:141], v2 offset:5120
    ds_read_b64_tr_b16 v[142:143], v2 offset:5376
    s_waitcnt vmcnt(3) lgkmcnt(10)
    v_mfma_f32_32x32x16_bf16 v[24:39], v[120:123], v[184:187], v[24:39]
    ds_read_b64_tr_b16 v[144:145], v2 offset:6144
    ds_read_b64_tr_b16 v[146:147], v2 offset:6400
    s_waitcnt lgkmcnt(10)
    v_mfma_f32_32x32x16_bf16 v[40:55], v[124:127], v[184:187], v[40:55]
    ds_read_b64_tr_b16 v[148:149], v2 offset:7168
    ds_read_b64_tr_b16 v[150:151], v2 offset:7424
    s_waitcnt lgkmcnt(10)
    v_mfma_f32_32x32x16_bf16 v[56:71], v[128:131], v[184:187], v[56:71]
    ds_read_b64_tr_b16 v[152:153], v2 offset:8192
    ds_read_b64_tr_b16 v[154:155], v2 offset:8448
    s_waitcnt lgkmcnt(10)
    v_mfma_f32_32x32x16_bf16 v[72:87], v[132:135], v[184:187], v[72:87]
    ds_read_b64_tr_b16 v[156:157], v2 offset:9216
    ds_read_b64_tr_b16 v[158:159], v2 offset:9472
    s_waitcnt lgkmcnt(10)
    v_mfma_f32_32x32x16_bf16 v[88:103], v[136:139], v[184:187], v[88:103]
    ds_read_b64_tr_b16 v[160:161], v2 offset:10240
    ds_read_b64_tr_b16 v[162:163], v2 offset:10496
    s_waitcnt lgkmcnt(10)
    v_mfma_f32_32x32x16_bf16 v[104:119], v[140:143], v[184:187], v[104:119]
    ds_read_b64_tr_b16 v[164:165], v2 offset:11264
    ds_read_b64_tr_b16 v[166:167], v2 offset:11520
    s_waitcnt vmcnt(2) lgkmcnt(10)
    v_mfma_f32_32x32x16_bf16 v[24:39], v[144:147], v[188:191], v[24:39]
    ds_read_b64_tr_b16 v[120:121], v2 offset:12288
    ds_read_b64_tr_b16 v[122:123], v2 offset:12544
    s_waitcnt lgkmcnt(10)
    v_mfma_f32_32x32x16_bf16 v[40:55], v[148:151], v[188:191], v[40:55]
    ds_read_b64_tr_b16 v[124:125], v2 offset:13312
    ds_read_b64_tr_b16 v[126:127], v2 offset:13568
    s_waitcnt lgkmcnt(10)
    v_mfma_f32_32x32x16_bf16 v[56:71], v[152:155], v[188:191], v[56:71]
    ds_read_b64_tr_b16 v[128:129], v2 offset:14336
    ds_read_b64_tr_b16 v[130:131], v2 offset:14592
    s_waitcnt lgkmcnt(10)
L_pad16:
    s_cbranch_execz L_warm1
    v_mfma_f32_32x32x16_bf16 v[72:87], v[156:159], v[188:191], v[72:87]
    ds_read_b64_tr_b16 v[132:133], v2 offset:15360
    ds_read_b64_tr_b16 v[134:135], v2 offset:15616
    s_waitcnt lgkmcnt(10)
    v_mfma_f32_32x32x16_bf16 v[88:103], v[160:163], v[188:191], v[88:103]
    ds_read_b64_tr_b16 v[136:137], v2 offset:16384
    ds_read_b64_tr_b16 v[138:139], v2 offset:16640
    s_waitcnt lgkmcnt(10)
    v_mfma_f32_32x32x16_bf16 v[104:119], v[164:167], v[188:191], v[104:119]
    ds_read_b64_tr_b16 v[140:141], v2 offset:17408
    ds_read_b64_tr_b16 v[142:143], v2 offset:17664
    s_waitcnt vmcnt(1) lgkmcnt(10)
    v_mfma_f32_32x32x16_bf16 v[24:39], v[120:123], v[192:195], v[24:39]
    ds_read_b64_tr_b16 v[144:145], v2 offset:18432
    ds_read_b64_tr_b16 v[146:147], v2 offset:18688
    s_waitcnt lgkmcnt(10)
    v_mfma_f32_32x32x16_bf16 v[40:55], v[124:127], v[192:195], v[40:55]
    ds_read_b64_tr_b16 v[148:149], v2 offset:19456
    ds_read_b64_tr_b16 v[150:151], v2 offset:19712
    s_waitcnt lgkmcnt(10)
    v_mfma_f32_32x32x16_bf16 v[56:71], v[128:131], v[192:195], v[56:71]
    ds_read_b64_tr_b16 v[152:153], v2 offset:20480
    ds_read_b64_tr_b16 v[154:155], v2 offset:20736
    s_waitcnt lgkmcnt(10)
    v_mfma_f32_32x32x16_bf16 v[72:87], v[132:135], v[192:195], v[72:87]
    ds_read_b64_tr_b16 v[156:157], v2 offset:21504
    ds_read_b64_tr_b16 v[158:159], v2 offset:21760
    s_waitcnt lgkmcnt(10)
    v_mfma_f32_32x32x16_bf16 v[88:103], v[136:139], v[192:195], v[88:103]
    ds_read_b64_tr_b16 v[160:161], v2 offset:22528
    ds_read_b64_tr_b16 v[162:163], v2 offset:22784
    s_waitcnt lgkmcnt(10)
    v_mfma_f32_32x32x16_bf16 v[104:119], v[140:143], v[192:195], v[104:119]
    ds_read_b64_tr_b16 v[164:165], v2 offset:23552
    ds_read_b64_tr_b16 v[166:167], v2 offset:23808
    s_waitcnt vmcnt(0) lgkmcnt(10)
    v_mfma_f32_32x32x16_bf16 v[24:39], v[144:147], v[196:199], v[24:39]
    s_waitcnt lgkmcnt(8)
    v_mfma_f32_32x32x16_bf16 v[40:55], v[148:151], v[196:199], v[40:55]
    s_waitcnt lgkmcnt(6)
    v_mfma_f32_32x32x16_bf16 v[56:71], v[152:155], v[196:199], v[56:71]
    s_waitcnt lgkmcnt(4)
    v_mfma_f32_32x32x16_bf16 v[72:87], v[156:159], v[196:199], v[72:87]
    s_waitcnt lgkmcnt(2)
    v_mfma_f32_32x32x16_bf16 v[88:103], v[160:163], v[196:199], v[88:103]
    s_waitcnt lgkmcnt(0)
    s_barrier
    v_mfma_f32_32x32x16_bf16 v[104:119], v[164:167], v[196:199], v[104:119]
    s_nop 9
L_padg0:
    v_pk_mul_f32 v[168:169], v[24:25], v[24:25]
    v_pk_mul_f32 v[170:171], v[26:27], v[26:27]
    v_pk_mul_f32 v[172:173], v[28:29], v[28:29]
    v_pk_mul_f32 v[174:175], v[30:31], v[30:31]
    v_pk_fma_f32 v[168:169], v[168:169], v[14:15], v[12:13]
    v_pk_fma_f32 v[170:171], v[170:171], v[14:15], v[12:13]
    v_pk_fma_f32 v[172:173], v[172:173], v[14:15], v[12:13]
    v_pk_fma_f32 v[174:175], v[174:175], v[14:15], v[12:13]
    v_pk_mul_f32 v[168:169], v[168:169], v[24:25]
    v_pk_mul_f32 v[170:171], v[170:171], v[26:27]
    v_pk_mul_f32 v[172:173], v[172:173], v[28:29]
    v_pk_mul_f32 v[174:175], v[174:175], v[30:31]
    v_exp_f32 v168, v168
    v_exp_f32 v169, v169
    v_exp_f32 v170, v170
    v_exp_f32 v171, v171
    v_exp_f32 v172, v172
    v_exp_f32 v173, v173
    v_exp_f32 v174, v174
    v_exp_f32 v175, v175
    v_pk_mul_f32 v[24:25], v[24:25], v[72:73]
    v_pk_mul_f32 v[26:27], v[26:27], v[74:75]
    v_pk_mul_f32 v[28:29], v[28:29], v[76:77]
    v_pk_mul_f32 v[30:31], v[30:31], v[78:79]
    v_pk_fma_f32 v[168:169], v[168:169], v[10:11], v[10:11]
    v_pk_fma_f32 v[170:171], v[170:171], v[10:11], v[10:11]
    v_pk_fma_f32 v[172:173], v[172:173], v[10:11], v[10:11]
    v_pk_fma_f32 v[174:175], v[174:175], v[10:11], v[10:11]
    v_rcp_f32 v168, v168
    v_rcp_f32 v169, v169
    v_rcp_f32 v170, v170
    v_rcp_f32 v171, v171
    v_rcp_f32 v172, v172
    v_rcp_f32 v173, v173
    v_rcp_f32 v174, v174
    v_rcp_f32 v175, v175
    s_nop 0
    v_pk_mul_f32 v[24:25], v[24:25], v[168:169]
    v_pk_mul_f32 v[26:27], v[26:27], v[170:171]
    v_pk_mul_f32 v[28:29], v[28:29], v[172:173]
    v_pk_mul_f32 v[30:31], v[30:31], v[174:175]
    v_cvt_pk_bf16_f32 v200, v24, v25
    v_cvt_pk_bf16_f32 v201, v26, v27
    v_cvt_pk_bf16_f32 v202, v28, v29
    v_cvt_pk_bf16_f32 v203, v30, v31
    s_cbranch_execz L_warmg0
    buffer_store_dwordx4 v[200:203], v5, s[32:35], s49 offen offset:0 sc1
L_padg1:
    v_pk_mul_f32 v[168:169], v[32:33], v[32:33]
    v_pk_mul_f32 v[170:171], v[34:35], v[34:35]
    v_pk_mul_f32 v[172:173], v[36:37], v[36:37]
    v_pk_mul_f32 v[174:175], v[38:39], v[38:39]
    v_pk_fma_f32 v[168:169], v[168:169], v[14:15], v[12:13]
    v_pk_fma_f32 v[170:171], v[170:171], v[14:15], v[12:13]
    v_pk_fma_f32 v[172:173], v[172:173], v[14:15], v[12:13]
    v_pk_fma_f32 v[174:175], v[174:175], v[14:15], v[12:13]
    v_pk_mul_f32 v[168:169], v[168:169], v[32:33]
    v_pk_mul_f32 v[170:171], v[170:171], v[34:35]
    v_pk_mul_f32 v[172:173], v[172:173], v[36:37]
    v_pk_mul_f32 v[174:175], v[174:175], v[38:39]
    v_exp_f32 v168, v168
    v_exp_f32 v169, v169
    v_exp_f32 v170, v170
    v_exp_f32 v171, v171
    v_exp_f32 v172, v172
    v_exp_f32 v173, v173
    v_exp_f32 v174, v174
    v_exp_f32 v175, v175
    v_pk_mul_f32 v[32:33], v[32:33], v[80:81]
    v_pk_mul_f32 v[34:35], v[34:35], v[82:83]
    v_pk_mul_f32 v[36:37], v[36:37], v[84:85]
    v_pk_mul_f32 v[38:39], v[38:39], v[86:87]
    v_pk_fma_f32 v[168:169], v[168:169], v[10:11], v[10:11]
    v_pk_fma_f32 v[170:171], v[170:171], v[10:11], v[10:11]
    v_pk_fma_f32 v[172:173], v[172:173], v[10:11], v[10:11]
    v_pk_fma_f32 v[174:175], v[174:175], v[10:11], v[10:11]
    v_rcp_f32 v168, v168
    v_rcp_f32 v169, v169
    v_rcp_f32 v170, v170
    v_rcp_f32 v171, v171
    v_rcp_f32 v172, v172
    v_rcp_f32 v173, v173
    v_rcp_f32 v174, v174
    v_rcp_f32 v175, v175
    s_nop 0
    v_pk_mul_f32 v[32:33], v[32:33], v[168:169]
    v_pk_mul_f32 v[34:35], v[34:35], v[170:171]
    v_pk_mul_f32 v[36:37], v[36:37], v[172:173]
    v_pk_mul_f32 v[38:39], v[38:39], v[174:175]
    v_cvt_pk_bf16_f32 v204, v32, v33
    v_cvt_pk_bf16_f32 v205, v34, v35
    v_cvt_pk_bf16_f32 v206, v36, v37
    v_cvt_pk_bf16_f32 v207, v38, v39
    s_cbranch_execz L_warmg0
    buffer_store_dwordx4 v[204:207], v5, s[32:35], s49 offen offset:512 sc1
L_padg2:
    v_pk_mul_f32 v[168:169], v[40:41], v[40:41]
    v_pk_mul_f32 v[170:171], v[42:43], v[42:43]
    v_pk_mul_f32 v[172:173], v[44:45], v[44:45]
    v_pk_mul_f32 v[174:175], v[46:47], v[46:47]
    v_pk_fma_f32 v[168:169], v[168:169], v[14:15], v[12:13]
    v_pk_fma_f32 v[170:171], v[170:171], v[14:15], v[12:13]
    v_pk_fma_f32 v[172:173], v[172:173], v[14:15], v[12:13]
    v_pk_fma_f32 v[174:175], v[174:175], v[14:15], v[12:13]
    v_pk_mul_f32 v[168:169], v[168:169], v[40:41]
    v_pk_mul_f32 v[170:171], v[170:171], v[42:43]
    v_pk_mul_f32 v[172:173], v[172:173], v[44:45]
    v_pk_mul_f32 v[174:175], v[174:175], v[46:47]
    v_exp_f32 v168, v168
    v_exp_f32 v169, v169
    v_exp_f32 v170, v170
    v_exp_f32 v171, v171
    v_exp_f32 v172, v172
    v_exp_f32 v173, v173
    v_exp_f32 v174, v174
    v_exp_f32 v175, v175
    v_pk_mul_f32 v[40:41], v[40:41], v[88:89]
    v_pk_mul_f32 v[42:43], v[42:43], v[90:91]
    v_pk_mul_f32 v[44:45], v[44:45], v[92:93]
    v_pk_mul_f32 v[46:47], v[46:47], v[94:95]
    v_pk_fma_f32 v[168:169], v[168:169], v[10:11], v[10:11]
    v_pk_fma_f32 v[170:171], v[170:171], v[10:11], v[10:11]
    v_pk_fma_f32 v[172:173], v[172:173], v[10:11], v[10:11]
    v_pk_fma_f32 v[174:175], v[174:175], v[10:11], v[10:11]
    v_rcp_f32 v168, v168
    v_rcp_f32 v169, v169
    v_rcp_f32 v170, v170
    v_rcp_f32 v171, v171
    v_rcp_f32 v172, v172
    v_rcp_f32 v173, v173
    v_rcp_f32 v174, v174
    v_rcp_f32 v175, v175
    s_nop 0
    v_pk_mul_f32 v[40:41], v[40:41], v[168:169]
    v_pk_mul_f32 v[42:43], v[42:43], v[170:171]
    v_pk_mul_f32 v[44:45], v[44:45], v[172:173]
    v_pk_mul_f32 v[46:47], v[46:47], v[174:175]
    v_cvt_pk_bf16_f32 v208, v40, v41
    v_cvt_pk_bf16_f32 v209, v42, v43
    v_cvt_pk_bf16_f32 v210, v44, v45
    v_cvt_pk_bf16_f32 v211, v46, v47
    s_cbranch_execz L_warmg0
L_pad17:
    s_cbranch_execz L_warm1
    buffer_store_dwordx4 v[208:211], v5, s[32:35], s49 offen offset:1024 sc1
L_padg3:
    v_pk_mul_f32 v[168:169], v[48:49], v[48:49]
    v_pk_mul_f32 v[170:171], v[50:51], v[50:51]
    v_pk_mul_f32 v[172:173], v[52:53], v[52:53]
    v_pk_mul_f32 v[174:175], v[54:55], v[54:55]
    v_pk_fma_f32 v[168:169], v[168:169], v[14:15], v[12:13]
    v_pk_fma_f32 v[170:171], v[170:171], v[14:15], v[12:13]
    v_pk_fma_f32 v[172:173], v[172:173], v[14:15], v[12:13]
    v_pk_fma_f32 v[174:175], v[174:175], v[14:15], v[12:13]
    v_pk_mul_f32 v[168:169], v[168:169], v[48:49]
    v_pk_mul_f32 v[170:171], v[170:171], v[50:51]
    v_pk_mul_f32 v[172:173], v[172:173], v[52:53]
    v_pk_mul_f32 v[174:175], v[174:175], v[54:55]
    v_exp_f32 v168, v168
    v_exp_f32 v169, v169
    v_exp_f32 v170, v170
    v_exp_f32 v171, v171
    v_exp_f32 v172, v172
    v_exp_f32 v173, v173
    v_exp_f32 v174, v174
    v_exp_f32 v175, v175
    v_pk_mul_f32 v[48:49], v[48:49], v[96:97]
    v_pk_mul_f32 v[50:51], v[50:51], v[98:99]
    v_pk_mul_f32 v[52:53], v[52:53], v[100:101]
    v_pk_mul_f32 v[54:55], v[54:55], v[102:103]
    v_pk_fma_f32 v[168:169], v[168:169], v[10:11], v[10:11]
    v_pk_fma_f32 v[170:171], v[170:171], v[10:11], v[10:11]
    v_pk_fma_f32 v[172:173], v[172:173], v[10:11], v[10:11]
    v_pk_fma_f32 v[174:175], v[174:175], v[10:11], v[10:11]
    v_rcp_f32 v168, v168
    v_rcp_f32 v169, v169
    v_rcp_f32 v170, v170
    v_rcp_f32 v171, v171
    v_rcp_f32 v172, v172
    v_rcp_f32 v173, v173
    v_rcp_f32 v174, v174
    v_rcp_f32 v175, v175
    s_nop 0
    v_pk_mul_f32 v[48:49], v[48:49], v[168:169]
    v_pk_mul_f32 v[50:51], v[50:51], v[170:171]
    v_pk_mul_f32 v[52:53], v[52:53], v[172:173]
    v_pk_mul_f32 v[54:55], v[54:55], v[174:175]
    v_cvt_pk_bf16_f32 v212, v48, v49
    v_cvt_pk_bf16_f32 v213, v50, v51
    v_cvt_pk_bf16_f32 v214, v52, v53
    v_cvt_pk_bf16_f32 v215, v54, v55
    s_cbranch_execz L_warmg0
    buffer_store_dwordx4 v[212:215], v5, s[32:35], s49 offen offset:1536 sc1
L_padg4:
    v_pk_mul_f32 v[168:169], v[56:57], v[56:57]
    v_pk_mul_f32 v[170:171], v[58:59], v[58:59]
    v_pk_mul_f32 v[172:173], v[60:61], v[60:61]
    v_pk_mul_f32 v[174:175], v[62:63], v[62:63]
    v_pk_fma_f32 v[168:169], v[168:169], v[14:15], v[12:13]
    v_pk_fma_f32 v[170:171], v[170:171], v[14:15], v[12:13]
    v_pk_fma_f32 v[172:173], v[172:173], v[14:15], v[12:13]
    v_pk_fma_f32 v[174:175], v[174:175], v[14:15], v[12:13]
    v_pk_mul_f32 v[168:169], v[168:169], v[56:57]
    v_pk_mul_f32 v[170:171], v[170:171], v[58:59]
    v_pk_mul_f32 v[172:173], v[172:173], v[60:61]
    v_pk_mul_f32 v[174:175], v[174:175], v[62:63]
    v_exp_f32 v168, v168
    v_exp_f32 v169, v169
    v_exp_f32 v170, v170
    v_exp_f32 v171, v171
    v_exp_f32 v172, v172
    v_exp_f32 v173, v173
    v_exp_f32 v174, v174
    v_exp_f32 v175, v175
    v_pk_mul_f32 v[56:57], v[56:57], v[104:105]
    v_pk_mul_f32 v[58:59], v[58:59], v[106:107]
    v_pk_mul_f32 v[60:61], v[60:61], v[108:109]
    v_pk_mul_f32 v[62:63], v[62:63], v[110:111]
    v_pk_fma_f32 v[168:169], v[168:169], v[10:11], v[10:11]
    v_pk_fma_f32 v[170:171], v[170:171], v[10:11], v[10:11]
    v_pk_fma_f32 v[172:173], v[172:173], v[10:11], v[10:11]
    v_pk_fma_f32 v[174:175], v[174:175], v[10:11], v[10:11]
    v_rcp_f32 v168, v168
    v_rcp_f32 v169, v169
    v_rcp_f32 v170, v170
    v_rcp_f32 v171, v171
    v_rcp_f32 v172, v172
    v_rcp_f32 v173, v173
    v_rcp_f32 v174, v174
    v_rcp_f32 v175, v175
    s_nop 0
    v_pk_mul_f32 v[56:57], v[56:57], v[168:169]
    v_pk_mul_f32 v[58:59], v[58:59], v[170:171]
    v_pk_mul_f32 v[60:61], v[60:61], v[172:173]
    v_pk_mul_f32 v[62:63], v[62:63], v[174:175]
    v_cvt_pk_bf16_f32 v216, v56, v57
    v_cvt_pk_bf16_f32 v217, v58, v59
    v_cvt_pk_bf16_f32 v218, v60, v61
    v_cvt_pk_bf16_f32 v219, v62, v63
    s_cbranch_execz L_warmg1
    buffer_store_dwordx4 v[216:219], v5, s[32:35], s49 offen offset:2048 sc1
L_padg5:
    v_pk_mul_f32 v[168:169], v[64:65], v[64:65]
    v_pk_mul_f32 v[170:171], v[66:67], v[66:67]
    v_pk_mul_f32 v[172:173], v[68:69], v[68:69]
    v_pk_mul_f32 v[174:175], v[70:71], v[70:71]
    v_pk_fma_f32 v[168:169], v[168:169], v[14:15], v[12:13]
    v_pk_fma_f32 v[170:171], v[170:171], v[14:15], v[12:13]
    v_pk_fma_f32 v[172:173], v[172:173], v[14:15], v[12:13]
    v_pk_fma_f32 v[174:175], v[174:175], v[14:15], v[12:13]
    v_pk_mul_f32 v[168:169], v[168:169], v[64:65]
    v_pk_mul_f32 v[170:171], v[170:171], v[66:67]
    v_pk_mul_f32 v[172:173], v[172:173], v[68:69]
    v_pk_mul_f32 v[174:175], v[174:175], v[70:71]
    v_exp_f32 v168, v168
    v_exp_f32 v169, v169
    v_exp_f32 v170, v170
    v_exp_f32 v171, v171
    v_exp_f32 v172, v172
    v_exp_f32 v173, v173
    v_exp_f32 v174, v174
    v_exp_f32 v175, v175
    v_pk_mul_f32 v[64:65], v[64:65], v[112:113]
    v_pk_mul_f32 v[66:67], v[66:67], v[114:115]
    v_pk_mul_f32 v[68:69], v[68:69], v[116:117]
    v_pk_mul_f32 v[70:71], v[70:71], v[118:119]
    v_pk_fma_f32 v[168:169], v[168:169], v[10:11], v[10:11]
    v_pk_fma_f32 v[170:171], v[170:171], v[10:11], v[10:11]
    v_pk_fma_f32 v[172:173], v[172:173], v[10:11], v[10:11]
    v_pk_fma_f32 v[174:175], v[174:175], v[10:11], v[10:11]
    v_rcp_f32 v168, v168
    v_rcp_f32 v169, v169
    v_rcp_f32 v170, v170
    v_rcp_f32 v171, v171
    v_rcp_f32 v172, v172
    v_rcp_f32 v173, v173
    v_rcp_f32 v174, v174
    v_rcp_f32 v175, v175
    s_nop 0
    v_pk_mul_f32 v[64:65], v[64:65], v[168:169]
    v_pk_mul_f32 v[66:67], v[66:67], v[170:171]
    v_pk_mul_f32 v[68:69], v[68:69], v[172:173]
    v_pk_mul_f32 v[70:71], v[70:71], v[174:175]
    v_cvt_pk_bf16_f32 v220, v64, v65
    v_cvt_pk_bf16_f32 v221, v66, v67
    v_cvt_pk_bf16_f32 v222, v68, v69
    v_cvt_pk_bf16_f32 v223, v70, v71
    s_cbranch_execz L_warmg1
    buffer_store_dwordx4 v[220:223], v5, s[32:35], s49 offen offset:2560 sc1
    s_lshl_b32 s45, s44, 4
    s_add_u32 s45, s45, s39
    s_lshl_b32 s45, s45, 5
    s_add_u32 s45, s45, 0x2280000
    v_mov_b32 v244, s36
    v_mov_b32 v245, s37
    v_lshlrev_b32 v246, 20, v1
    s_waitcnt vmcnt(0)
    s_mov_b64 exec, 0x1
    buffer_store_dwordx2 v[244:245], v246, s[32:35], s45 offen sc1
    s_mov_b64 exec, -1
    s_barrier
    s_branch P4_done
P4_loader:
    s_and_b32 s44, s2, 7
    s_lshr_b32 s45, s2, 3
    s_lshr_b32 s41, s44, 0
    s_lshl_b32 s41, s41, 2
    s_and_b32 s42, s44, 0
    s_lshl_b32 s42, s42, 3
    s_and_b32 s44, s45, 3
    s_add_u32 s41, s41, s44
    s_lshr_b32 s44, s45, 2
    s_add_u32 s42, s42, s44
L_pad18:
    s_cbranch_execz L_warm1
    v_lshlrev_b32 v4, 4, v1
    s_mul_i32 s51, s40, 6144
    s_mul_i32 s50, s39, 245760
    s_add_u32 s50, s50, s51
    s_add_u32 s50, s50, 0x1b00000
    s_add_u32 s51, s51, 2048
    s_mul_i32 s49, s42, 245760
    s_mul_i32 s44, s40, 5120
    s_add_u32 s49, s49, s44
    s_add_u32 s49, s49, 0x1f00000
    s_lshr_b32 s44, s2, 3
    s_lshl_b32 s44, s44, 2
    s_add_u32 s44, s44, s40
    s_lshr_b32 s45, s44, 4
    s_and_b32 s44, s44, 15
    s_mul_i32 s45, s45, 1920
    s_mul_i32 s44, s44, 40
    s_add_u32 s44, s44, s45
    s_add_u32 s44, s44, 0x3e000
    v_add_lshl_u32 v9, v1, s44, 7
    s_add_u32 m0, s51, 0
    s_add_u32 s46, s50, 0
    s_waitcnt vmcnt(2)
    buffer_load_dwordx4 v4, s[32:35], s46 offen offset:0 sc1 lds
    s_waitcnt vmcnt(2)
    buffer_load_dwordx4 v4, s[32:35], s46 offen offset:1024 sc1 lds
    s_waitcnt vmcnt(2)
    buffer_load_dwordx4 v4, s[32:35], s46 offen offset:2048 sc1 lds
    s_add_u32 m0, s51, 3072
    s_add_u32 s46, s50, 3072
    s_waitcnt vmcnt(2)
    buffer_load_dwordx4 v4, s[32:35], s46 offen offset:0 sc1 lds
    s_waitcnt vmcnt(2)
    buffer_load_dwordx4 v4, s[32:35], s46 offen offset:1024 sc1 lds
    s_waitcnt vmcnt(2)
    buffer_load_dwordx4 v4, s[32:35], s46 offen offset:2048 sc1 lds
    s_mov_b64 exec, 0x3ff
    buffer_load_dword v8, v9, s[32:35], 0 offen sc1
    s_mov_b64 exec, -1
    v_add_u32 v9, 1280, v9
    s_mov_b64 exec, 0
    s_cmp_eq_u32 s3, 4
    s_cbranch_scc1 L_pad12
    s_cmp_eq_u32 s3, 5
    s_cbranch_scc1 L_pad13
    s_cmp_eq_u32 s3, 6
    s_cbranch_scc1 L_pad14
    s_cmp_eq_u32 s3, 7
    s_cbranch_scc1 L_pad15
L_warm1:
    s_mov_b64 exec, -1
    s_barrier
    s_add_u32 m0, s51, 24576
    s_add_u32 s46, s50, 24576
    s_waitcnt vmcnt(2)
    buffer_load_dwordx4 v4, s[32:35], s46 offen offset:0 sc1 lds
    s_waitcnt vmcnt(2)
    buffer_load_dwordx4 v4, s[32:35], s46 offen offset:1024 sc1 lds
    s_waitcnt vmcnt(2)
    buffer_load_dwordx4 v4, s[32:35], s46 offen offset:2048 sc1 lds
    s_add_u32 m0, s51, 27648
    s_add_u32 s46, s50, 27648
    s_waitcnt vmcnt(2)
    buffer_load_dwordx4 v4, s[32:35], s46 offen offset:0 sc1 lds
    s_waitcnt vmcnt(2)
    buffer_load_dwordx4 v4, s[32:35], s46 offen offset:1024 sc1 lds
    s_waitcnt vmcnt(2)
    buffer_load_dwordx4 v4, s[32:35], s46 offen offset:2048 sc1 lds
    s_waitcnt vmcnt(0)
    s_barrier
    s_add_u32 m0, s51, 49152
    s_add_u32 s46, s50, 49152
    buffer_load_dwordx4 v4, s[32:35], s46 offen offset:0 sc1 lds
    buffer_load_dwordx4 v4, s[32:35], s46 offen offset:1024 sc1 lds
    buffer_load_dwordx4 v4, s[32:35], s46 offen offset:2048 sc1 lds
    s_add_u32 m0, s51, 52224
    s_add_u32 s46, s50, 52224
    buffer_load_dwordx4 v4, s[32:35], s46 offen offset:0 sc1 lds
    buffer_load_dwordx4 v4, s[32:35], s46 offen offset:1024 sc1 lds
    buffer_load_dwordx4 v4, s[32:35], s46 offen offset:2048 sc1 lds
    s_add_u32 m0, s51, 73728
    s_add_u32 s46, s50, 73728
    buffer_load_dwordx4 v4, s[32:35], s46 offen offset:0 sc1 lds
    buffer_load_dwordx4 v4, s[32:35], s46 offen offset:1024 sc1 lds
    buffer_load_dwordx4 v4, s[32:35], s46 offen offset:2048 sc1 lds
    s_add_u32 m0, s51, 76800
    s_add_u32 s46, s50, 76800
    buffer_load_dwordx4 v4, s[32:35], s46 offen offset:0 sc1 lds
    buffer_load_dwordx4 v4, s[32:35], s46 offen offset:1024 sc1 lds
    buffer_load_dwordx4 v4, s[32:35], s46 offen offset:2048 sc1 lds
    s_add_u32 m0, s51, 98304
    s_add_u32 s46, s50, 98304
    buffer_load_dwordx4 v4, s[32:35], s46 offen offset:0 sc1 lds
    buffer_load_dwordx4 v4, s[32:35], s46 offen offset:1024 sc1 lds
    buffer_load_dwordx4 v4, s[32:35], s46 offen offset:2048 sc1 lds
    s_add_u32 m0, s51, 101376
    s_add_u32 s46, s50, 101376
    buffer_load_dwordx4 v4, s[32:35], s46 offen offset:0 sc1 lds
    buffer_load_dwordx4 v4, s[32:35], s46 offen offset:1024 sc1 lds
    buffer_load_dwordx4 v4, s[32:35], s46 offen offset:2048 sc1 lds
    s_add_u32 m0, s51, 122880
    s_add_u32 s46, s50, 122880
    buffer_load_dwordx4 v4, s[32:35], s46 offen offset:0 sc1 lds
    buffer_load_dwordx4 v4, s[32:35], s46 offen offset:1024 sc1 lds
    buffer_load_dwordx4 v4, s[32:35], s46 offen offset:2048 sc1 lds
    s_add_u32 m0, s51, 125952
    s_add_u32 s46, s50, 125952
    buffer_load_dwordx4 v4, s[32:35], s46 offen offset:0 sc1 lds
    buffer_load_dwordx4 v4, s[32:35], s46 offen offset:1024 sc1 lds
    buffer_load_dwordx4 v4, s[32:35], s46 offen offset:2048 sc1 lds
    s_waitcnt vmcnt(12)
    s_barrier
    s_mov_b64 exec, 0x3ff
    buffer_load_dword v8, v9, s[32:35], 0 offen sc1
    s_mov_b64 exec, -1
    v_add_u32 v9, 1280, v9
    s_mov_b64 exec, 0
    s_cmp_eq_u32 s3, 4
    s_cbranch_scc1 L_pad20
    s_cmp_eq_u32 s3, 5
    s_cbranch_scc1 L_pad21
    s_cmp_eq_u32 s3, 6
    s_cbranch_scc1 L_pad22
    s_cmp_eq_u32 s3, 7
    s_cbranch_scc1 L_pad23
L_warm2:
    s_mov_b64 exec, -1
    s_waitcnt vmcnt(1)
    s_barrier
    s_add_u32 m0, s51, 0
    s_add_u32 s46, s50, 147456
    buffer_load_dwordx4 v4, s[32:35], s46 offen offset:0 sc1 lds
    buffer_load_dwordx4 v4, s[32:35], s46 offen offset:1024 sc1 lds
    buffer_load_dwordx4 v4, s[32:35], s46 offen offset:2048 sc1 lds
    s_add_u32 m0, s51, 3072
    s_add_u32 s46, s50, 150528
    buffer_load_dwordx4 v4, s[32:35], s46 offen offset:0 sc1 lds
    buffer_load_dwordx4 v4, s[32:35], s46 offen offset:1024 sc1 lds
    buffer_load_dwordx4 v4, s[32:35], s46 offen offset:2048 sc1 lds
    s_add_u32 m0, s51, 24576
    s_add_u32 s46, s50, 172032
    buffer_load_dwordx4 v4, s[32:35], s46 offen offset:0 sc1 lds
    buffer_load_dwordx4 v4, s[32:35], s46 offen offset:1024 sc1 lds
    buffer_load_dwordx4 v4, s[32:35], s46 offen offset:2048 sc1 lds
    s_add_u32 m0, s51, 27648
    s_add_u32 s46, s50, 175104
    buffer_load_dwordx4 v4, s[32:35], s46 offen offset:0 sc1 lds
    buffer_load_dwordx4 v4, s[32:35], s46 offen offset:1024 sc1 lds
    buffer_load_dwordx4 v4, s[32:35], s46 offen offset:2048 sc1 lds
    s_add_u32 m0, s51, 49152
    s_add_u32 s46, s50, 196608
    buffer_load_dwordx4 v4, s[32:35], s46 offen offset:0 sc1 lds
    buffer_load_dwordx4 v4, s[32:35], s46 offen offset:1024 sc1 lds
    buffer_load_dwordx4 v4, s[32:35], s46 offen offset:2048 sc1 lds
    s_add_u32 m0, s51, 52224
    s_add_u32 s46, s50, 199680
    buffer_load_dwordx4 v4, s[32:35], s46 offen offset:0 sc1 lds
L_pad19:
    s_cbranch_execz L_warm1
    buffer_load_dwordx4 v4, s[32:35], s46 offen offset:1024 sc1 lds
    buffer_load_dwordx4 v4, s[32:35], s46 offen offset:2048 sc1 lds
    s_mov_b64 exec, 0x3ff
    buffer_load_dword v8, v9, s[32:35], 0 offen sc1
    s_mov_b64 exec, -1
    v_add_u32 v9, 1280, v9
    s_waitcnt vmcnt(7)
    s_barrier
    s_add_u32 m0, s51, 73728
    s_add_u32 s46, s50, 221184
    buffer_load_dwordx4 v4, s[32:35], s46 offen offset:0 sc1 lds
    buffer_load_dwordx4 v4, s[32:35], s46 offen offset:1024 sc1 lds
    buffer_load_dwordx4 v4, s[32:35], s46 offen offset:2048 sc1 lds
    s_add_u32 m0, s51, 76800
    s_add_u32 s46, s50, 224256
    buffer_load_dwordx4 v4, s[32:35], s46 offen offset:0 sc1 lds
    buffer_load_dwordx4 v4, s[32:35], s46 offen offset:1024 sc1 lds
    buffer_load_dwordx4 v4, s[32:35], s46 offen offset:2048 sc1 lds
    s_mov_b64 exec, 0x3ff
    buffer_load_dword v8, v9, s[32:35], 0 offen sc1
    s_mov_b64 exec, -1
    v_add_u32 v9, 1280, v9
    s_waitcnt vmcnt(1)
    s_barrier
    s_add_u32 s47, s49, 163840
    buffer_load_dwordx4 v[176:179], v4, s[32:35], s47 offen offset:0 sc1
    buffer_load_dwordx4 v[180:183], v4, s[32:35], s47 offen offset:1024 sc1
    buffer_load_dwordx4 v[184:187], v4, s[32:35], s47 offen offset:2048 sc1
    buffer_load_dwordx4 v[188:191], v4, s[32:35], s47 offen offset:3072 sc1
    s_add_u32 s47, s49, 167936
    buffer_load_dwordx4 v[192:195], v4, s[32:35], s47 offen offset:0 sc1
    s_add_u32 s47, s49, 184320
    buffer_load_dwordx4 v[196:199], v4, s[32:35], s47 offen offset:0 sc1
    buffer_load_dwordx4 v[200:203], v4, s[32:35], s47 offen offset:1024 sc1
    buffer_load_dwordx4 v[204:207], v4, s[32:35], s47 offen offset:2048 sc1
    buffer_load_dwordx4 v[208:211], v4, s[32:35], s47 offen offset:3072 sc1
    s_add_u32 s47, s49, 188416
    buffer_load_dwordx4 v[212:215], v4, s[32:35], s47 offen offset:0 sc1
    s_add_u32 s47, s49, 204800
    buffer_load_dwordx4 v[216:219], v4, s[32:35], s47 offen offset:0 sc1
    buffer_load_dwordx4 v[220:223], v4, s[32:35], s47 offen offset:1024 sc1
    buffer_load_dwordx4 v[224:227], v4, s[32:35], s47 offen offset:2048 sc1
    buffer_load_dwordx4 v[228:231], v4, s[32:35], s47 offen offset:3072 sc1
    s_add_u32 s47, s49, 208896
    buffer_load_dwordx4 v[232:235], v4, s[32:35], s47 offen offset:0 sc1
    s_add_u32 s47, s49, 225280
    buffer_load_dwordx4 v[236:239], v4, s[32:35], s47 offen offset:0 sc1
    buffer_load_dwordx4 v[240:243], v4, s[32:35], s47 offen offset:1024 sc1
    buffer_load_dwordx4 v[244:247], v4, s[32:35], s47 offen offset:2048 sc1
    buffer_load_dwordx4 v[248:251], v4, s[32:35], s47 offen offset:3072 sc1
    s_add_u32 s47, s49, 229376
    buffer_load_dwordx4 v[252:255], v4, s[32:35], s47 offen offset:0 sc1
P4_done:
    s_and_b32 s44, s2, 7
    s_lshr_b32 s45, s2, 3
    s_lshr_b32 s38, s44, 0
    s_lshl_b32 s38, s38, 2
    s_and_b32 s39, s44, 0
    s_lshl_b32 s39, s39, 3
    s_and_b32 s44, s45, 3
    s_add_u32 s38, s38, s44
    s_lshr_b32 s44, s45, 2
    s_add_u32 s39, s39, s44
    s_and_b32 s42, s3, 3
    s_and_b32 s40, s3, 1
    s_lshr_b32 s41, s42, 1
    s_cmp_ge_u32 s3, 4
    s_cbranch_scc1 P5_loader
    v_and_b32 v10, 15, v1
    v_lshrrev_b32 v11, 4, v1
    s_lshl_b32 s44, s38, 1
    s_add_u32 s44, s44, s40
    v_lshlrev_b32 v5, 4, v1
    v_lshrrev_b32 v2, 1, v11
    v_lshlrev_b32 v2, 4, v2
    v_and_b32 v3, 1, v11
    v_lshl_add_u32 v2, v3, 2, v2
    v_bfe_u32 v3, v1, 2, 2
    v_add_u32 v2, v2, v3
    v_mul_u32_u24 v2, 160, v2
    v_and_b32 v3, 3, v1
    v_lshl_add_u32 v2, v3, 3, v2
    s_mul_i32 s45, s41, 5120
    s_add_u32 s45, s45, 0
    v_add_u32 v2, s45, v2
    v_add_u32 v3, 61440, v2
    v_add_u32 v4, 61440, v3
    v_and_b32 v60, 1, v11
    v_lshrrev_b32 v9, 1, v11
    v_lshlrev_b32 v9, 4, v9
    v_mul_u32_u24 v8, 1280, v10
    v_add_u32 v9, v9, v8
    v_lshl_add_u32 v8, v60, 5, v9
    v_mul_u32_u24 v60, 20480, v60
    v_add3_u32 v9, v9, v60, 64
    v_add_u32 v9, 64, v9
    s_mul_i32 s49, s44, 40960
    s_mul_i32 s46, s39, 160
    s_add_u32 s49, s49, s46
    s_add_u32 s47, s49, 20480
    s_lshl_b32 s45, s44, 9
    s_lshl_b32 s46, s41, 8
    s_add_u32 s45, s45, s46
    s_add_u32 s45, s45, 0x2280000
    v_mov_b32 v24, 0
    v_mov_b32 v25, 0
    v_mov_b32 v26, 0
    v_mov_b32 v27, 0
    v_mov_b32 v28, 0
    v_mov_b32 v29, 0
    v_mov_b32 v30, 0
    v_mov_b32 v31, 0
    v_mov_b32 v32, 0
    v_mov_b32 v33, 0
    v_mov_b32 v34, 0
    v_mov_b32 v35, 0
    v_mov_b32 v36, 0
    v_mov_b32 v37, 0
    v_mov_b32 v38, 0
    v_mov_b32 v39, 0
    v_mov_b32 v40, 0
    v_mov_b32 v41, 0
    v_mov_b32 v42, 0
    v_mov_b32 v43, 0
    v_mov_b32 v44, 0
    v_mov_b32 v45, 0
    v_mov_b32 v46, 0
    v_mov_b32 v47, 0
    v_mov_b32 v48, 0
    v_mov_b32 v49, 0
    v_mov_b32 v50, 0
    v_mov_b32 v51, 0
    v_mov_b32 v52, 0
    v_mov_b32 v53, 0
    v_mov_b32 v54, 0
    v_mov_b32 v55, 0
    v_mov_b32 v56, 0
    v_mov_b32 v57, 0
    v_mov_b32 v58, 0
    v_mov_b32 v59, 0
    v_mov_b32 v60, 0
    v_mov_b32 v61, 0
    v_mov_b32 v62, 0
    v_mov_b32 v63, 0
    v_lshlrev_b32 v246, 5, v1
    v_add_u32 v247, 49152, v5
    s_mul_i32 s48, s44, 98304
    s_add_u32 s48, s48, 0x1000000
    s_mul_i32 s46, s41, 24576
    s_add_u32 s48, s48, s46
    ds_read_b64_tr_b16 v[152:153], v2 offset:0
    ds_read_b64_tr_b16 v[154:155], v2 offset:1280
    ds_read_b64_tr_b16 v[156:157], v2 offset:32
    ds_read_b64_tr_b16 v[158:159], v2 offset:1312
    ds_read_b64_tr_b16 v[160:161], v2 offset:64
    ds_read_b64_tr_b16 v[162:163], v2 offset:1344
    ds_read_b64_tr_b16 v[164:165], v2 offset:96
    ds_read_b64_tr_b16 v[166:167], v2 offset:1376
    ds_read_b64_tr_b16 v[168:169], v2 offset:128
    ds_read_b64_tr_b16 v[170:171], v2 offset:1408
    ds_read_b64_tr_b16 v[172:173], v2 offset:10240
    ds_read_b64_tr_b16 v[174:175], v2 offset:11520
    ds_read_b64_tr_b16 v[176:177], v2 offset:10272
    ds_read_b64_tr_b16 v[178:179], v2 offset:11552
    ds_read_b64_tr_b16 v[180:181], v2 offset:10304
    ds_read_b64_tr_b16 v[182:183], v2 offset:11584
    ds_read_b64_tr_b16 v[184:185], v2 offset:10336
    ds_read_b64_tr_b16 v[186:187], v2 offset:11616
    ds_read_b64_tr_b16 v[188:189], v2 offset:10368
    ds_read_b64_tr_b16 v[190:191], v2 offset:11648
    ds_read_b64_tr_b16 v[192:193], v2 offset:20480
L_pad20:
    s_cbranch_execz L_pad24
    ds_read_b64_tr_b16 v[194:195], v2 offset:21760
    ds_read_b64_tr_b16 v[196:197], v2 offset:20512
    ds_read_b64_tr_b16 v[198:199], v2 offset:21792
    ds_read_b64_tr_b16 v[200:201], v2 offset:20544
    ds_read_b64_tr_b16 v[202:203], v2 offset:21824
    ds_read_b64_tr_b16 v[204:205], v2 offset:20576
    ds_read_b64_tr_b16 v[206:207], v2 offset:21856
    ds_read_b64_tr_b16 v[208:209], v2 offset:20608
    ds_read_b64_tr_b16 v[210:211], v2 offset:21888
    ds_read_b64_tr_b16 v[212:213], v2 offset:30720
    ds_read_b64_tr_b16 v[214:215], v2 offset:32000
    ds_read_b64_tr_b16 v[216:217], v2 offset:30752
    ds_read_b64_tr_b16 v[218:219], v2 offset:32032
    ds_read_b64_tr_b16 v[220:221], v2 offset:30784
    ds_read_b64_tr_b16 v[222:223], v2 offset:32064
    ds_read_b64_tr_b16 v[224:225], v2 offset:30816
    ds_read_b64_tr_b16 v[226:227], v2 offset:32096
    ds_read_b64_tr_b16 v[228:229], v2 offset:30848
    ds_read_b64_tr_b16 v[230:231], v2 offset:32128
    ds_read_b64_tr_b16 v[64:65], v2 offset:40960
    ds_read_b64_tr_b16 v[66:67], v2 offset:42240
    ds_read_b64_tr_b16 v[68:69], v2 offset:40992
    ds_read_b64_tr_b16 v[70:71], v2 offset:42272
    ds_read_b64_tr_b16 v[72:73], v2 offset:41024
    ds_read_b64_tr_b16 v[74:75], v2 offset:42304
    ds_read_b64_tr_b16 v[76:77], v2 offset:41056
    ds_read_b64_tr_b16 v[78:79], v2 offset:42336
    ds_read_b64_tr_b16 v[80:81], v2 offset:41088
    ds_read_b64_tr_b16 v[82:83], v2 offset:42368
    ds_read_b64_tr_b16 v[84:85], v2 offset:51200
    ds_read_b64_tr_b16 v[86:87], v2 offset:52480
    ds_read_b64_tr_b16 v[88:89], v2 offset:51232
    ds_read_b64_tr_b16 v[90:91], v2 offset:52512
    ds_read_b64_tr_b16 v[92:93], v2 offset:51264
    ds_read_b64_tr_b16 v[94:95], v2 offset:52544
    ds_read_b64_tr_b16 v[96:97], v2 offset:51296
    ds_read_b64_tr_b16 v[98:99], v2 offset:52576
    ds_read_b64_tr_b16 v[100:101], v2 offset:51328
    ds_read_b64_tr_b16 v[102:103], v2 offset:52608
    s_waitcnt lgkmcnt(0)
    s_barrier
    s_waitcnt vmcnt(0)
    s_mov_b32 exec_lo, 0xff
    s_mov_b32 exec_hi, 0x0
    s_mov_b32 s99, 0x80000
    s_add_u32 s97, s45, 0x0
L_poll_11:
    buffer_load_dwordx2 v[248:249], v246, s[32:35], s45 offen sc1
    s_waitcnt vmcnt(0)
    v_xor_b32 v248, s36, v248
    v_xor_b32 v249, s37, v249
    v_or_b32 v248, v248, v249
    v_cmp_ne_u32 vcc, 0, v248
    s_nop 1
    s_and_b64 exec, exec, vcc
    s_cbranch_execz L_polld_12
    s_add_u32 s45, s45, 0x100000
    s_min_u32 s45, s45, s97
    s_sleep 1
    s_sub_u32 s99, s99, 1
    s_cbranch_scc0 L_poll_11
L_polld_12:
    s_mov_b64 exec, -1
    s_add_u32 s52, s48, 0
    buffer_load_dwordx4 v[104:107], v5, s[32:35], s52 offen offset:0 sc1
    buffer_load_dwordx4 v[108:111], v247, s[32:35], s52 offen offset:0 sc1
    buffer_load_dwordx4 v[112:115], v5, s[32:35], s52 offen offset:1024 sc1
    buffer_load_dwordx4 v[116:119], v247, s[32:35], s52 offen offset:1024 sc1
    buffer_load_dwordx4 v[120:123], v5, s[32:35], s52 offen offset:2048 sc1
    buffer_load_dwordx4 v[124:127], v247, s[32:35], s52 offen offset:2048 sc1
    buffer_load_dwordx4 v[128:131], v5, s[32:35], s52 offen offset:3072 sc1
    buffer_load_dwordx4 v[132:135], v247, s[32:35], s52 offen offset:3072 sc1
    s_waitcnt vmcnt(6) lgkmcnt(0)
    v_mfma_f32_16x16x32_bf16 v[24:27], v[152:155], v[104:107], v[24:27]
    v_mfma_f32_16x16x32_bf16 v[44:47], v[152:155], v[108:111], v[44:47]
    s_add_u32 s52, s48, 4096
    buffer_load_dwordx4 v[136:139], v5, s[32:35], s52 offen offset:0 sc1
    v_mfma_f32_16x16x32_bf16 v[28:31], v[156:159], v[104:107], v[28:31]
    v_mfma_f32_16x16x32_bf16 v[48:51], v[156:159], v[108:111], v[48:51]
    buffer_load_dwordx4 v[140:143], v247, s[32:35], s52 offen offset:0 sc1
    v_mfma_f32_16x16x32_bf16 v[32:35], v[160:163], v[104:107], v[32:35]
    v_mfma_f32_16x16x32_bf16 v[52:55], v[160:163], v[108:111], v[52:55]
    buffer_load_dwordx4 v[144:147], v5, s[32:35], s52 offen offset:1024 sc1
    v_mfma_f32_16x16x32_bf16 v[36:39], v[164:167], v[104:107], v[36:39]
    v_mfma_f32_16x16x32_bf16 v[56:59], v[164:167], v[108:111], v[56:59]
    buffer_load_dwordx4 v[148:151], v247, s[32:35], s52 offen offset:1024 sc1
    v_mfma_f32_16x16x32_bf16 v[40:43], v[168:171], v[104:107], v[40:43]
    v_mfma_f32_16x16x32_bf16 v[60:63], v[168:171], v[108:111], v[60:63]
    s_waitcnt vmcnt(8) lgkmcnt(0)
    v_mfma_f32_16x16x32_bf16 v[24:27], v[172:175], v[112:115], v[24:27]
    v_mfma_f32_16x16x32_bf16 v[44:47], v[172:175], v[116:119], v[44:47]
    buffer_load_dwordx4 v[104:107], v5, s[32:35], s52 offen offset:2048 sc1
    v_mfma_f32_16x16x32_bf16 v[28:31], v[176:179], v[112:115], v[28:31]
    v_mfma_f32_16x16x32_bf16 v[48:51], v[176:179], v[116:119], v[48:51]
    buffer_load_dwordx4 v[108:111], v247, s[32:35], s52 offen offset:2048 sc1
    v_mfma_f32_16x16x32_bf16 v[32:35], v[180:183], v[112:115], v[32:35]
    v_mfma_f32_16x16x32_bf16 v[52:55], v[180:183], v[116:119], v[52:55]
    v_mfma_f32_16x16x32_bf16 v[36:39], v[184:187], v[112:115], v[36:39]
    v_mfma_f32_16x16x32_bf16 v[56:59], v[184:187], v[116:119], v[56:59]
    v_mfma_f32_16x16x32_bf16 v[40:43], v[188:191], v[112:115], v[40:43]
    v_mfma_f32_16x16x32_bf16 v[60:63], v[188:191], v[116:119], v[60:63]
    s_waitcnt vmcnt(8) lgkmcnt(0)
    v_mfma_f32_16x16x32_bf16 v[24:27], v[192:195], v[120:123], v[24:27]
    v_mfma_f32_16x16x32_bf16 v[44:47], v[192:195], v[124:127], v[44:47]
    buffer_load_dwordx4 v[112:115], v5, s[32:35], s52 offen offset:3072 sc1
    v_mfma_f32_16x16x32_bf16 v[28:31], v[196:199], v[120:123], v[28:31]
    v_mfma_f32_16x16x32_bf16 v[48:51], v[196:199], v[124:127], v[48:51]
    buffer_load_dwordx4 v[116:119], v247, s[32:35], s52 offen offset:3072 sc1
    v_mfma_f32_16x16x32_bf16 v[32:35], v[200:203], v[120:123], v[32:35]
    v_mfma_f32_16x16x32_bf16 v[52:55], v[200:203], v[124:127], v[52:55]
    v_mfma_f32_16x16x32_bf16 v[36:39], v[204:207], v[120:123], v[36:39]
    v_mfma_f32_16x16x32_bf16 v[56:59], v[204:207], v[124:127], v[56:59]
    v_mfma_f32_16x16x32_bf16 v[40:43], v[208:211], v[120:123], v[40:43]
    v_mfma_f32_16x16x32_bf16 v[60:63], v[208:211], v[124:127], v[60:63]
    s_waitcnt vmcnt(8) lgkmcnt(0)
    v_mfma_f32_16x16x32_bf16 v[24:27], v[212:215], v[128:131], v[24:27]
    v_mfma_f32_16x16x32_bf16 v[44:47], v[212:215], v[132:135], v[44:47]
    s_add_u32 s52, s48, 8192
    buffer_load_dwordx4 v[120:123], v5, s[32:35], s52 offen offset:0 sc1
    v_mfma_f32_16x16x32_bf16 v[28:31], v[216:219], v[128:131], v[28:31]
    v_mfma_f32_16x16x32_bf16 v[48:51], v[216:219], v[132:135], v[48:51]
    buffer_load_dwordx4 v[124:127], v247, s[32:35], s52 offen offset:0 sc1
    v_mfma_f32_16x16x32_bf16 v[32:35], v[220:223], v[128:131], v[32:35]
    v_mfma_f32_16x16x32_bf16 v[52:55], v[220:223], v[132:135], v[52:55]
    v_mfma_f32_16x16x32_bf16 v[36:39], v[224:227], v[128:131], v[36:39]
    v_mfma_f32_16x16x32_bf16 v[56:59], v[224:227], v[132:135], v[56:59]
    v_mfma_f32_16x16x32_bf16 v[40:43], v[228:231], v[128:131], v[40:43]
    v_mfma_f32_16x16x32_bf16 v[60:63], v[228:231], v[132:135], v[60:63]
    s_waitcnt vmcnt(8) lgkmcnt(0)
    v_mfma_f32_16x16x32_bf16 v[24:27], v[64:67], v[136:139], v[24:27]
    v_mfma_f32_16x16x32_bf16 v[44:47], v[64:67], v[140:143], v[44:47]
    buffer_load_dwordx4 v[128:131], v5, s[32:35], s52 offen offset:1024 sc1
    v_mfma_f32_16x16x32_bf16 v[28:31], v[68:71], v[136:139], v[28:31]
    v_mfma_f32_16x16x32_bf16 v[48:51], v[68:71], v[140:143], v[48:51]
    buffer_load_dwordx4 v[132:135], v247, s[32:35], s52 offen offset:1024 sc1
    v_mfma_f32_16x16x32_bf16 v[32:35], v[72:75], v[136:139], v[32:35]
    v_mfma_f32_16x16x32_bf16 v[52:55], v[72:75], v[140:143], v[52:55]
    v_mfma_f32_16x16x32_bf16 v[36:39], v[76:79], v[136:139], v[36:39]
    v_mfma_f32_16x16x32_bf16 v[56:59], v[76:79], v[140:143], v[56:59]
    v_mfma_f32_16x16x32_bf16 v[40:43], v[80:83], v[136:139], v[40:43]
    v_mfma_f32_16x16x32_bf16 v[60:63], v[80:83], v[140:143], v[60:63]
    s_barrier
L_pad21:
    s_cbranch_execz L_pad25
    s_waitcnt vmcnt(8) lgkmcnt(0)
    v_mfma_f32_16x16x32_bf16 v[24:27], v[84:87], v[144:147], v[24:27]
    ds_read_b64_tr_b16 v[64:65], v3 offset:0
    v_mfma_f32_16x16x32_bf16 v[44:47], v[84:87], v[148:151], v[44:47]
    ds_read_b64_tr_b16 v[66:67], v3 offset:1280
    s_add_u32 s52, s48, 8192
    buffer_load_dwordx4 v[136:139], v5, s[32:35], s52 offen offset:2048 sc1
    v_mfma_f32_16x16x32_bf16 v[28:31], v[88:91], v[144:147], v[28:31]
    ds_read_b64_tr_b16 v[68:69], v3 offset:32
    v_mfma_f32_16x16x32_bf16 v[48:51], v[88:91], v[148:151], v[48:51]
    ds_read_b64_tr_b16 v[70:71], v3 offset:1312
    buffer_load_dwordx4 v[140:143], v247, s[32:35], s52 offen offset:2048 sc1
    v_mfma_f32_16x16x32_bf16 v[32:35], v[92:95], v[144:147], v[32:35]
    ds_read_b64_tr_b16 v[72:73], v3 offset:64
    v_mfma_f32_16x16x32_bf16 v[52:55], v[92:95], v[148:151], v[52:55]
    ds_read_b64_tr_b16 v[74:75], v3 offset:1344
    v_mfma_f32_16x16x32_bf16 v[36:39], v[96:99], v[144:147], v[36:39]
    ds_read_b64_tr_b16 v[76:77], v3 offset:96
    v_mfma_f32_16x16x32_bf16 v[56:59], v[96:99], v[148:151], v[56:59]
    ds_read_b64_tr_b16 v[78:79], v3 offset:1376
    v_mfma_f32_16x16x32_bf16 v[40:43], v[100:103], v[144:147], v[40:43]
    ds_read_b64_tr_b16 v[80:81], v3 offset:128
    v_mfma_f32_16x16x32_bf16 v[60:63], v[100:103], v[148:151], v[60:63]
    ds_read_b64_tr_b16 v[82:83], v3 offset:1408
    s_waitcnt vmcnt(8) lgkmcnt(8)
    v_mfma_f32_16x16x32_bf16 v[24:27], v[64:67], v[104:107], v[24:27]
    ds_read_b64_tr_b16 v[84:85], v3 offset:10240
    v_mfma_f32_16x16x32_bf16 v[44:47], v[64:67], v[108:111], v[44:47]
    ds_read_b64_tr_b16 v[86:87], v3 offset:11520
    buffer_load_dwordx4 v[144:147], v5, s[32:35], s52 offen offset:3072 sc1
    s_waitcnt lgkmcnt(8)
    v_mfma_f32_16x16x32_bf16 v[28:31], v[68:71], v[104:107], v[28:31]
    ds_read_b64_tr_b16 v[88:89], v3 offset:10272
    v_mfma_f32_16x16x32_bf16 v[48:51], v[68:71], v[108:111], v[48:51]
    ds_read_b64_tr_b16 v[90:91], v3 offset:11552
    buffer_load_dwordx4 v[148:151], v247, s[32:35], s52 offen offset:3072 sc1
    s_waitcnt lgkmcnt(8)
    v_mfma_f32_16x16x32_bf16 v[32:35], v[72:75], v[104:107], v[32:35]
    ds_read_b64_tr_b16 v[92:93], v3 offset:10304
    v_mfma_f32_16x16x32_bf16 v[52:55], v[72:75], v[108:111], v[52:55]
    ds_read_b64_tr_b16 v[94:95], v3 offset:11584
    s_waitcnt lgkmcnt(8)
    v_mfma_f32_16x16x32_bf16 v[36:39], v[76:79], v[104:107], v[36:39]
    ds_read_b64_tr_b16 v[96:97], v3 offset:10336
    v_mfma_f32_16x16x32_bf16 v[56:59], v[76:79], v[108:111], v[56:59]
    ds_read_b64_tr_b16 v[98:99], v3 offset:11616
    s_waitcnt lgkmcnt(8)
    v_mfma_f32_16x16x32_bf16 v[40:43], v[80:83], v[104:107], v[40:43]
    ds_read_b64_tr_b16 v[100:101], v3 offset:10368
    v_mfma_f32_16x16x32_bf16 v[60:63], v[80:83], v[108:111], v[60:63]
    ds_read_b64_tr_b16 v[102:103], v3 offset:11648
    s_waitcnt vmcnt(8) lgkmcnt(8)
    v_mfma_f32_16x16x32_bf16 v[24:27], v[84:87], v[112:115], v[24:27]
    ds_read_b64_tr_b16 v[64:65], v3 offset:20480
    v_mfma_f32_16x16x32_bf16 v[44:47], v[84:87], v[116:119], v[44:47]
    ds_read_b64_tr_b16 v[66:67], v3 offset:21760
    s_add_u32 s52, s48, 12288
    buffer_load_dwordx4 v[104:107], v5, s[32:35], s52 offen offset:0 sc1
    s_waitcnt lgkmcnt(8)
    v_mfma_f32_16x16x32_bf16 v[28:31], v[88:91], v[112:115], v[28:31]
    ds_read_b64_tr_b16 v[68:69], v3 offset:20512
    v_mfma_f32_16x16x32_bf16 v[48:51], v[88:91], v[116:119], v[48:51]
    ds_read_b64_tr_b16 v[70:71], v3 offset:21792
    buffer_load_dwordx4 v[108:111], v247, s[32:35], s52 offen offset:0 sc1
    s_waitcnt lgkmcnt(8)
    v_mfma_f32_16x16x32_bf16 v[32:35], v[92:95], v[112:115], v[32:35]
    ds_read_b64_tr_b16 v[72:73], v3 offset:20544
    v_mfma_f32_16x16x32_bf16 v[52:55], v[92:95], v[116:119], v[52:55]
    ds_read_b64_tr_b16 v[74:75], v3 offset:21824
    s_waitcnt lgkmcnt(8)
    v_mfma_f32_16x16x32_bf16 v[36:39], v[96:99], v[112:115], v[36:39]
    ds_read_b64_tr_b16 v[76:77], v3 offset:20576
    v_mfma_f32_16x16x32_bf16 v[56:59], v[96:99], v[116:119], v[56:59]
    ds_read_b64_tr_b16 v[78:79], v3 offset:21856
    s_waitcnt lgkmcnt(8)
    v_mfma_f32_16x16x32_bf16 v[40:43], v[100:103], v[112:115], v[40:43]
    ds_read_b64_tr_b16 v[80:81], v3 offset:20608
    v_mfma_f32_16x16x32_bf16 v[60:63], v[100:103], v[116:119], v[60:63]
    ds_read_b64_tr_b16 v[82:83], v3 offset:21888
    s_barrier
    s_waitcnt vmcnt(8) lgkmcnt(8)
    v_mfma_f32_16x16x32_bf16 v[24:27], v[64:67], v[120:123], v[24:27]
    ds_read_b64_tr_b16 v[84:85], v3 offset:30720
    v_mfma_f32_16x16x32_bf16 v[44:47], v[64:67], v[124:127], v[44:47]
    ds_read_b64_tr_b16 v[86:87], v3 offset:32000
    buffer_load_dwordx4 v[112:115], v5, s[32:35], s52 offen offset:1024 sc1
    s_waitcnt lgkmcnt(8)
    v_mfma_f32_16x16x32_bf16 v[28:31], v[68:71], v[120:123], v[28:31]
    ds_read_b64_tr_b16 v[88:89], v3 offset:30752
    v_mfma_f32_16x16x32_bf16 v[48:51], v[68:71], v[124:127], v[48:51]
    ds_read_b64_tr_b16 v[90:91], v3 offset:32032
    buffer_load_dwordx4 v[116:119], v247, s[32:35], s52 offen offset:1024 sc1
    s_waitcnt lgkmcnt(8)
    v_mfma_f32_16x16x32_bf16 v[32:35], v[72:75], v[120:123], v[32:35]
    ds_read_b64_tr_b16 v[92:93], v3 offset:30784
    v_mfma_f32_16x16x32_bf16 v[52:55], v[72:75], v[124:127], v[52:55]
    ds_read_b64_tr_b16 v[94:95], v3 offset:32064
    s_waitcnt lgkmcnt(8)
    v_mfma_f32_16x16x32_bf16 v[36:39], v[76:79], v[120:123], v[36:39]
    ds_read_b64_tr_b16 v[96:97], v3 offset:30816
    v_mfma_f32_16x16x32_bf16 v[56:59], v[76:79], v[124:127], v[56:59]
    ds_read_b64_tr_b16 v[98:99], v3 offset:32096
    s_waitcnt lgkmcnt(8)
    v_mfma_f32_16x16x32_bf16 v[40:43], v[80:83], v[120:123], v[40:43]
    ds_read_b64_tr_b16 v[100:101], v3 offset:30848
    v_mfma_f32_16x16x32_bf16 v[60:63], v[80:83], v[124:127], v[60:63]
    ds_read_b64_tr_b16 v[102:103], v3 offset:32128
    s_waitcnt vmcnt(8) lgkmcnt(8)
    v_mfma_f32_16x16x32_bf16 v[24:27], v[84:87], v[128:131], v[24:27]
    ds_read_b64_tr_b16 v[64:65], v3 offset:40960
    v_mfma_f32_16x16x32_bf16 v[44:47], v[84:87], v[132:135], v[44:47]
    ds_read_b64_tr_b16 v[66:67], v3 offset:42240
    buffer_load_dwordx4 v[120:123], v5, s[32:35], s52 offen offset:2048 sc1
    s_waitcnt lgkmcnt(8)
    v_mfma_f32_16x16x32_bf16 v[28:31], v[88:91], v[128:131], v[28:31]
    ds_read_b64_tr_b16 v[68:69], v3 offset:40992
    v_mfma_f32_16x16x32_bf16 v[48:51], v[88:91], v[132:135], v[48:51]
    ds_read_b64_tr_b16 v[70:71], v3 offset:42272
    buffer_load_dwordx4 v[124:127], v247, s[32:35], s52 offen offset:2048 sc1
    s_waitcnt lgkmcnt(8)
    v_mfma_f32_16x16x32_bf16 v[32:35], v[92:95], v[128:131], v[32:35]
    ds_read_b64_tr_b16 v[72:73], v3 offset:41024
    v_mfma_f32_16x16x32_bf16 v[52:55], v[92:95], v[132:135], v[52:55]
    ds_read_b64_tr_b16 v[74:75], v3 offset:42304
    s_waitcnt lgkmcnt(8)
    v_mfma_f32_16x16x32_bf16 v[36:39], v[96:99], v[128:131], v[36:39]
    ds_read_b64_tr_b16 v[76:77], v3 offset:41056
    v_mfma_f32_16x16x32_bf16 v[56:59], v[96:99], v[132:135], v[56:59]
    ds_read_b64_tr_b16 v[78:79], v3 offset:42336
    s_waitcnt lgkmcnt(8)
    v_mfma_f32_16x16x32_bf16 v[40:43], v[100:103], v[128:131], v[40:43]
    ds_read_b64_tr_b16 v[80:81], v3 offset:41088
    v_mfma_f32_16x16x32_bf16 v[60:63], v[100:103], v[132:135], v[60:63]
    ds_read_b64_tr_b16 v[82:83], v3 offset:42368
    s_waitcnt vmcnt(8) lgkmcnt(8)
    v_mfma_f32_16x16x32_bf16 v[24:27], v[64:67], v[136:139], v[24:27]
    ds_read_b64_tr_b16 v[84:85], v3 offset:51200
    v_mfma_f32_16x16x32_bf16 v[44:47], v[64:67], v[140:143], v[44:47]
    ds_read_b64_tr_b16 v[86:87], v3 offset:52480
L_pad22:
    s_cbranch_execz L_pad26
    buffer_load_dwordx4 v[128:131], v5, s[32:35], s52 offen offset:3072 sc1
    s_waitcnt lgkmcnt(8)
    v_mfma_f32_16x16x32_bf16 v[28:31], v[68:71], v[136:139], v[28:31]
    ds_read_b64_tr_b16 v[88:89], v3 offset:51232
    v_mfma_f32_16x16x32_bf16 v[48:51], v[68:71], v[140:143], v[48:51]
    ds_read_b64_tr_b16 v[90:91], v3 offset:52512
    buffer_load_dwordx4 v[132:135], v247, s[32:35], s52 offen offset:3072 sc1
    s_waitcnt lgkmcnt(8)
    v_mfma_f32_16x16x32_bf16 v[32:35], v[72:75], v[136:139], v[32:35]
    ds_read_b64_tr_b16 v[92:93], v3 offset:51264
    v_mfma_f32_16x16x32_bf16 v[52:55], v[72:75], v[140:143], v[52:55]
    ds_read_b64_tr_b16 v[94:95], v3 offset:52544
    s_waitcnt lgkmcnt(8)
    v_mfma_f32_16x16x32_bf16 v[36:39], v[76:79], v[136:139], v[36:39]
    ds_read_b64_tr_b16 v[96:97], v3 offset:51296
    v_mfma_f32_16x16x32_bf16 v[56:59], v[76:79], v[140:143], v[56:59]
    ds_read_b64_tr_b16 v[98:99], v3 offset:52576
    s_waitcnt lgkmcnt(8)
    v_mfma_f32_16x16x32_bf16 v[40:43], v[80:83], v[136:139], v[40:43]
    ds_read_b64_tr_b16 v[100:101], v3 offset:51328
    v_mfma_f32_16x16x32_bf16 v[60:63], v[80:83], v[140:143], v[60:63]
    ds_read_b64_tr_b16 v[102:103], v3 offset:52608
    s_waitcnt vmcnt(8) lgkmcnt(8)
    v_mfma_f32_16x16x32_bf16 v[24:27], v[84:87], v[144:147], v[24:27]
    ds_read_b64_tr_b16 v[64:65], v4 offset:0
    v_mfma_f32_16x16x32_bf16 v[44:47], v[84:87], v[148:151], v[44:47]
    ds_read_b64_tr_b16 v[66:67], v4 offset:1280
    s_add_u32 s52, s48, 16384
    buffer_load_dwordx4 v[136:139], v5, s[32:35], s52 offen offset:0 sc1
    s_waitcnt lgkmcnt(8)
    v_mfma_f32_16x16x32_bf16 v[28:31], v[88:91], v[144:147], v[28:31]
    ds_read_b64_tr_b16 v[68:69], v4 offset:32
    v_mfma_f32_16x16x32_bf16 v[48:51], v[88:91], v[148:151], v[48:51]
    ds_read_b64_tr_b16 v[70:71], v4 offset:1312
    buffer_load_dwordx4 v[140:143], v247, s[32:35], s52 offen offset:0 sc1
    s_waitcnt lgkmcnt(8)
    v_mfma_f32_16x16x32_bf16 v[32:35], v[92:95], v[144:147], v[32:35]
    ds_read_b64_tr_b16 v[72:73], v4 offset:64
    v_mfma_f32_16x16x32_bf16 v[52:55], v[92:95], v[148:151], v[52:55]
    ds_read_b64_tr_b16 v[74:75], v4 offset:1344
    s_waitcnt lgkmcnt(8)
    v_mfma_f32_16x16x32_bf16 v[36:39], v[96:99], v[144:147], v[36:39]
    ds_read_b64_tr_b16 v[76:77], v4 offset:96
    v_mfma_f32_16x16x32_bf16 v[56:59], v[96:99], v[148:151], v[56:59]
    ds_read_b64_tr_b16 v[78:79], v4 offset:1376
    s_waitcnt lgkmcnt(8)
    v_mfma_f32_16x16x32_bf16 v[40:43], v[100:103], v[144:147], v[40:43]
    ds_read_b64_tr_b16 v[80:81], v4 offset:128
    v_mfma_f32_16x16x32_bf16 v[60:63], v[100:103], v[148:151], v[60:63]
    ds_read_b64_tr_b16 v[82:83], v4 offset:1408
    s_waitcnt vmcnt(8) lgkmcnt(8)
    v_mfma_f32_16x16x32_bf16 v[24:27], v[64:67], v[104:107], v[24:27]
    ds_read_b64_tr_b16 v[84:85], v4 offset:10240
    v_mfma_f32_16x16x32_bf16 v[44:47], v[64:67], v[108:111], v[44:47]
    ds_read_b64_tr_b16 v[86:87], v4 offset:11520
    buffer_load_dwordx4 v[144:147], v5, s[32:35], s52 offen offset:1024 sc1
    s_waitcnt lgkmcnt(8)
    v_mfma_f32_16x16x32_bf16 v[28:31], v[68:71], v[104:107], v[28:31]
    ds_read_b64_tr_b16 v[88:89], v4 offset:10272
    v_mfma_f32_16x16x32_bf16 v[48:51], v[68:71], v[108:111], v[48:51]
    ds_read_b64_tr_b16 v[90:91], v4 offset:11552
    buffer_load_dwordx4 v[148:151], v247, s[32:35], s52 offen offset:1024 sc1
    s_waitcnt lgkmcnt(8)
    v_mfma_f32_16x16x32_bf16 v[32:35], v[72:75], v[104:107], v[32:35]
    ds_read_b64_tr_b16 v[92:93], v4 offset:10304
    v_mfma_f32_16x16x32_bf16 v[52:55], v[72:75], v[108:111], v[52:55]
    ds_read_b64_tr_b16 v[94:95], v4 offset:11584
    s_waitcnt lgkmcnt(8)
    v_mfma_f32_16x16x32_bf16 v[36:39], v[76:79], v[104:107], v[36:39]
    ds_read_b64_tr_b16 v[96:97], v4 offset:10336
    v_mfma_f32_16x16x32_bf16 v[56:59], v[76:79], v[108:111], v[56:59]
    ds_read_b64_tr_b16 v[98:99], v4 offset:11616
    s_waitcnt lgkmcnt(8)
    v_mfma_f32_16x16x32_bf16 v[40:43], v[80:83], v[104:107], v[40:43]
    ds_read_b64_tr_b16 v[100:101], v4 offset:10368
    v_mfma_f32_16x16x32_bf16 v[60:63], v[80:83], v[108:111], v[60:63]
    ds_read_b64_tr_b16 v[102:103], v4 offset:11648
    s_waitcnt vmcnt(8) lgkmcnt(8)
    v_mfma_f32_16x16x32_bf16 v[24:27], v[84:87], v[112:115], v[24:27]
    ds_read_b64_tr_b16 v[64:65], v4 offset:20480
    v_mfma_f32_16x16x32_bf16 v[44:47], v[84:87], v[116:119], v[44:47]
    ds_read_b64_tr_b16 v[66:67], v4 offset:21760
    buffer_load_dwordx4 v[104:107], v5, s[32:35], s52 offen offset:2048 sc1
    s_waitcnt lgkmcnt(8)
    v_mfma_f32_16x16x32_bf16 v[28:31], v[88:91], v[112:115], v[28:31]
    ds_read_b64_tr_b16 v[68:69], v4 offset:20512
    v_mfma_f32_16x16x32_bf16 v[48:51], v[88:91], v[116:119], v[48:51]
    ds_read_b64_tr_b16 v[70:71], v4 offset:21792
    buffer_load_dwordx4 v[108:111], v247, s[32:35], s52 offen offset:2048 sc1
    s_waitcnt lgkmcnt(8)
    v_mfma_f32_16x16x32_bf16 v[32:35], v[92:95], v[112:115], v[32:35]
    ds_read_b64_tr_b16 v[72:73], v4 offset:20544
    v_mfma_f32_16x16x32_bf16 v[52:55], v[92:95], v[116:119], v[52:55]
    ds_read_b64_tr_b16 v[74:75], v4 offset:21824
    s_waitcnt lgkmcnt(8)
    v_mfma_f32_16x16x32_bf16 v[36:39], v[96:99], v[112:115], v[36:39]
    ds_read_b64_tr_b16 v[76:77], v4 offset:20576
    v_mfma_f32_16x16x32_bf16 v[56:59], v[96:99], v[116:119], v[56:59]
    ds_read_b64_tr_b16 v[78:79], v4 offset:21856
    s_waitcnt lgkmcnt(8)
    v_mfma_f32_16x16x32_bf16 v[40:43], v[100:103], v[112:115], v[40:43]
    ds_read_b64_tr_b16 v[80:81], v4 offset:20608
    v_mfma_f32_16x16x32_bf16 v[60:63], v[100:103], v[116:119], v[60:63]
    ds_read_b64_tr_b16 v[82:83], v4 offset:21888
    s_waitcnt vmcnt(8) lgkmcnt(8)
    v_mfma_f32_16x16x32_bf16 v[24:27], v[64:67], v[120:123], v[24:27]
    ds_read_b64_tr_b16 v[84:85], v4 offset:30720
    v_mfma_f32_16x16x32_bf16 v[44:47], v[64:67], v[124:127], v[44:47]
    ds_read_b64_tr_b16 v[86:87], v4 offset:32000
    buffer_load_dwordx4 v[112:115], v5, s[32:35], s52 offen offset:3072 sc1
    s_waitcnt lgkmcnt(8)
    v_mfma_f32_16x16x32_bf16 v[28:31], v[68:71], v[120:123], v[28:31]
    ds_read_b64_tr_b16 v[88:89], v4 offset:30752
    v_mfma_f32_16x16x32_bf16 v[48:51], v[68:71], v[124:127], v[48:51]
    ds_read_b64_tr_b16 v[90:91], v4 offset:32032
    buffer_load_dwordx4 v[116:119], v247, s[32:35], s52 offen offset:3072 sc1
    s_waitcnt lgkmcnt(8)
    v_mfma_f32_16x16x32_bf16 v[32:35], v[72:75], v[120:123], v[32:35]
    ds_read_b64_tr_b16 v[92:93], v4 offset:30784
    v_mfma_f32_16x16x32_bf16 v[52:55], v[72:75], v[124:127], v[52:55]
    ds_read_b64_tr_b16 v[94:95], v4 offset:32064
    s_waitcnt lgkmcnt(8)
    v_mfma_f32_16x16x32_bf16 v[36:39], v[76:79], v[120:123], v[36:39]
    ds_read_b64_tr_b16 v[96:97], v4 offset:30816
    v_mfma_f32_16x16x32_bf16 v[56:59], v[76:79], v[124:127], v[56:59]
    ds_read_b64_tr_b16 v[98:99], v4 offset:32096
    s_waitcnt lgkmcnt(8)
    v_mfma_f32_16x16x32_bf16 v[40:43], v[80:83], v[120:123], v[40:43]
    ds_read_b64_tr_b16 v[100:101], v4 offset:30848
    v_mfma_f32_16x16x32_bf16 v[60:63], v[80:83], v[124:127], v[60:63]
    ds_read_b64_tr_b16 v[102:103], v4 offset:32128
    s_barrier
    s_waitcnt vmcnt(8) lgkmcnt(8)
    v_mfma_f32_16x16x32_bf16 v[24:27], v[84:87], v[128:131], v[24:27]
    ds_read_b64_tr_b16 v[64:65], v2 offset:0
    v_mfma_f32_16x16x32_bf16 v[44:47], v[84:87], v[132:135], v[44:47]
    ds_read_b64_tr_b16 v[66:67], v2 offset:1280
    s_add_u32 s52, s48, 20480
    buffer_load_dwordx4 v[120:123], v5, s[32:35], s52 offen offset:0 sc1
    s_waitcnt lgkmcnt(8)
    v_mfma_f32_16x16x32_bf16 v[28:31], v[88:91], v[128:131], v[28:31]
L_pad23:
    s_cbranch_execz L_warm2
    ds_read_b64_tr_b16 v[68:69], v2 offset:32
    v_mfma_f32_16x16x32_bf16 v[48:51], v[88:91], v[132:135], v[48:51]
    ds_read_b64_tr_b16 v[70:71], v2 offset:1312
    buffer_load_dwordx4 v[124:127], v247, s[32:35], s52 offen offset:0 sc1
    s_waitcnt lgkmcnt(8)
    v_mfma_f32_16x16x32_bf16 v[32:35], v[92:95], v[128:131], v[32:35]
    ds_read_b64_tr_b16 v[72:73], v2 offset:64
    v_mfma_f32_16x16x32_bf16 v[52:55], v[92:95], v[132:135], v[52:55]
    ds_read_b64_tr_b16 v[74:75], v2 offset:1344
    s_waitcnt lgkmcnt(8)
    v_mfma_f32_16x16x32_bf16 v[36:39], v[96:99], v[128:131], v[36:39]
    ds_read_b64_tr_b16 v[76:77], v2 offset:96
    v_mfma_f32_16x16x32_bf16 v[56:59], v[96:99], v[132:135], v[56:59]
    ds_read_b64_tr_b16 v[78:79], v2 offset:1376
    s_waitcnt lgkmcnt(8)
    v_mfma_f32_16x16x32_bf16 v[40:43], v[100:103], v[128:131], v[40:43]
    ds_read_b64_tr_b16 v[80:81], v2 offset:128
    v_mfma_f32_16x16x32_bf16 v[60:63], v[100:103], v[132:135], v[60:63]
    ds_read_b64_tr_b16 v[82:83], v2 offset:1408
    s_waitcnt vmcnt(8) lgkmcnt(8)
    v_mfma_f32_16x16x32_bf16 v[24:27], v[64:67], v[136:139], v[24:27]
    ds_read_b64_tr_b16 v[84:85], v2 offset:10240
    v_mfma_f32_16x16x32_bf16 v[44:47], v[64:67], v[140:143], v[44:47]
    ds_read_b64_tr_b16 v[86:87], v2 offset:11520
    buffer_load_dwordx4 v[128:131], v5, s[32:35], s52 offen offset:1024 sc1
    s_waitcnt lgkmcnt(8)
    v_mfma_f32_16x16x32_bf16 v[28:31], v[68:71], v[136:139], v[28:31]
    ds_read_b64_tr_b16 v[88:89], v2 offset:10272
    v_mfma_f32_16x16x32_bf16 v[48:51], v[68:71], v[140:143], v[48:51]
    ds_read_b64_tr_b16 v[90:91], v2 offset:11552
    buffer_load_dwordx4 v[132:135], v247, s[32:35], s52 offen offset:1024 sc1
    s_waitcnt lgkmcnt(8)
    v_mfma_f32_16x16x32_bf16 v[32:35], v[72:75], v[136:139], v[32:35]
    ds_read_b64_tr_b16 v[92:93], v2 offset:10304
    v_mfma_f32_16x16x32_bf16 v[52:55], v[72:75], v[140:143], v[52:55]
    ds_read_b64_tr_b16 v[94:95], v2 offset:11584
    s_waitcnt lgkmcnt(8)
    v_mfma_f32_16x16x32_bf16 v[36:39], v[76:79], v[136:139], v[36:39]
    ds_read_b64_tr_b16 v[96:97], v2 offset:10336
    v_mfma_f32_16x16x32_bf16 v[56:59], v[76:79], v[140:143], v[56:59]
    ds_read_b64_tr_b16 v[98:99], v2 offset:11616
    s_waitcnt lgkmcnt(8)
    v_mfma_f32_16x16x32_bf16 v[40:43], v[80:83], v[136:139], v[40:43]
    ds_read_b64_tr_b16 v[100:101], v2 offset:10368
    v_mfma_f32_16x16x32_bf16 v[60:63], v[80:83], v[140:143], v[60:63]
    ds_read_b64_tr_b16 v[102:103], v2 offset:11648
    s_waitcnt vmcnt(8) lgkmcnt(8)
    v_mfma_f32_16x16x32_bf16 v[24:27], v[84:87], v[144:147], v[24:27]
    ds_read_b64_tr_b16 v[64:65], v2 offset:20480
    v_mfma_f32_16x16x32_bf16 v[44:47], v[84:87], v[148:151], v[44:47]
    ds_read_b64_tr_b16 v[66:67], v2 offset:21760
    buffer_load_dwordx4 v[136:139], v5, s[32:35], s52 offen offset:2048 sc1
    s_waitcnt lgkmcnt(8)
    v_mfma_f32_16x16x32_bf16 v[28:31], v[88:91], v[144:147], v[28:31]
    ds_read_b64_tr_b16 v[68:69], v2 offset:20512
    v_mfma_f32_16x16x32_bf16 v[48:51], v[88:91], v[148:151], v[48:51]
    ds_read_b64_tr_b16 v[70:71], v2 offset:21792
    buffer_load_dwordx4 v[140:143], v247, s[32:35], s52 offen offset:2048 sc1
    s_waitcnt lgkmcnt(8)
    v_mfma_f32_16x16x32_bf16 v[32:35], v[92:95], v[144:147], v[32:35]
    ds_read_b64_tr_b16 v[72:73], v2 offset:20544
    v_mfma_f32_16x16x32_bf16 v[52:55], v[92:95], v[148:151], v[52:55]
    ds_read_b64_tr_b16 v[74:75], v2 offset:21824
    s_waitcnt lgkmcnt(8)
    v_mfma_f32_16x16x32_bf16 v[36:39], v[96:99], v[144:147], v[36:39]
    ds_read_b64_tr_b16 v[76:77], v2 offset:20576
    v_mfma_f32_16x16x32_bf16 v[56:59], v[96:99], v[148:151], v[56:59]
    ds_read_b64_tr_b16 v[78:79], v2 offset:21856
    s_waitcnt lgkmcnt(8)
    v_mfma_f32_16x16x32_bf16 v[40:43], v[100:103], v[144:147], v[40:43]
    ds_read_b64_tr_b16 v[80:81], v2 offset:20608
    v_mfma_f32_16x16x32_bf16 v[60:63], v[100:103], v[148:151], v[60:63]
    ds_read_b64_tr_b16 v[82:83], v2 offset:21888
    s_waitcnt vmcnt(8) lgkmcnt(8)
    v_mfma_f32_16x16x32_bf16 v[24:27], v[64:67], v[104:107], v[24:27]
    ds_read_b64_tr_b16 v[84:85], v2 offset:30720
    v_mfma_f32_16x16x32_bf16 v[44:47], v[64:67], v[108:111], v[44:47]
    ds_read_b64_tr_b16 v[86:87], v2 offset:32000
    buffer_load_dwordx4 v[144:147], v5, s[32:35], s52 offen offset:3072 sc1
    s_waitcnt lgkmcnt(8)
    v_mfma_f32_16x16x32_bf16 v[28:31], v[68:71], v[104:107], v[28:31]
    ds_read_b64_tr_b16 v[88:89], v2 offset:30752
    v_mfma_f32_16x16x32_bf16 v[48:51], v[68:71], v[108:111], v[48:51]
    ds_read_b64_tr_b16 v[90:91], v2 offset:32032
    buffer_load_dwordx4 v[148:151], v247, s[32:35], s52 offen offset:3072 sc1
    s_waitcnt lgkmcnt(8)
    v_mfma_f32_16x16x32_bf16 v[32:35], v[72:75], v[104:107], v[32:35]
    ds_read_b64_tr_b16 v[92:93], v2 offset:30784
    v_mfma_f32_16x16x32_bf16 v[52:55], v[72:75], v[108:111], v[52:55]
    ds_read_b64_tr_b16 v[94:95], v2 offset:32064
    s_waitcnt lgkmcnt(8)
    v_mfma_f32_16x16x32_bf16 v[36:39], v[76:79], v[104:107], v[36:39]
    ds_read_b64_tr_b16 v[96:97], v2 offset:30816
    v_mfma_f32_16x16x32_bf16 v[56:59], v[76:79], v[108:111], v[56:59]
    ds_read_b64_tr_b16 v[98:99], v2 offset:32096
    s_waitcnt lgkmcnt(8)
    v_mfma_f32_16x16x32_bf16 v[40:43], v[80:83], v[104:107], v[40:43]
    ds_read_b64_tr_b16 v[100:101], v2 offset:30848
    v_mfma_f32_16x16x32_bf16 v[60:63], v[80:83], v[108:111], v[60:63]
    ds_read_b64_tr_b16 v[102:103], v2 offset:32128
    s_waitcnt vmcnt(8) lgkmcnt(8)
    v_mfma_f32_16x16x32_bf16 v[24:27], v[84:87], v[112:115], v[24:27]
    ds_read_b64_tr_b16 v[64:65], v2 offset:40960
    v_mfma_f32_16x16x32_bf16 v[44:47], v[84:87], v[116:119], v[44:47]
    ds_read_b64_tr_b16 v[66:67], v2 offset:42240
    s_waitcnt lgkmcnt(8)
    v_mfma_f32_16x16x32_bf16 v[28:31], v[88:91], v[112:115], v[28:31]
    ds_read_b64_tr_b16 v[68:69], v2 offset:40992
    v_mfma_f32_16x16x32_bf16 v[48:51], v[88:91], v[116:119], v[48:51]
    ds_read_b64_tr_b16 v[70:71], v2 offset:42272
    s_waitcnt lgkmcnt(8)
    v_mfma_f32_16x16x32_bf16 v[32:35], v[92:95], v[112:115], v[32:35]
    ds_read_b64_tr_b16 v[72:73], v2 offset:41024
    v_mfma_f32_16x16x32_bf16 v[52:55], v[92:95], v[116:119], v[52:55]
    ds_read_b64_tr_b16 v[74:75], v2 offset:42304
    s_waitcnt lgkmcnt(8)
    v_mfma_f32_16x16x32_bf16 v[36:39], v[96:99], v[112:115], v[36:39]
    ds_read_b64_tr_b16 v[76:77], v2 offset:41056
    v_mfma_f32_16x16x32_bf16 v[56:59], v[96:99], v[116:119], v[56:59]
    ds_read_b64_tr_b16 v[78:79], v2 offset:42336
    s_waitcnt lgkmcnt(8)
    v_mfma_f32_16x16x32_bf16 v[40:43], v[100:103], v[112:115], v[40:43]
    ds_read_b64_tr_b16 v[80:81], v2 offset:41088
    v_mfma_f32_16x16x32_bf16 v[60:63], v[100:103], v[116:119], v[60:63]
    ds_read_b64_tr_b16 v[82:83], v2 offset:42368
    s_waitcnt vmcnt(6) lgkmcnt(8)
    v_mfma_f32_16x16x32_bf16 v[24:27], v[64:67], v[120:123], v[24:27]
    ds_read_b64_tr_b16 v[84:85], v2 offset:51200
    v_mfma_f32_16x16x32_bf16 v[44:47], v[64:67], v[124:127], v[44:47]
    ds_read_b64_tr_b16 v[86:87], v2 offset:52480
    s_waitcnt lgkmcnt(8)
    v_mfma_f32_16x16x32_bf16 v[28:31], v[68:71], v[120:123], v[28:31]
    ds_read_b64_tr_b16 v[88:89], v2 offset:51232
    v_mfma_f32_16x16x32_bf16 v[48:51], v[68:71], v[124:127], v[48:51]
    ds_read_b64_tr_b16 v[90:91], v2 offset:52512
    s_waitcnt lgkmcnt(8)
    v_mfma_f32_16x16x32_bf16 v[32:35], v[72:75], v[120:123], v[32:35]
    ds_read_b64_tr_b16 v[92:93], v2 offset:51264
    v_mfma_f32_16x16x32_bf16 v[52:55], v[72:75], v[124:127], v[52:55]
    ds_read_b64_tr_b16 v[94:95], v2 offset:52544
    s_waitcnt lgkmcnt(8)
L_pad24:
    s_cbranch_execz L_warm2
    v_mfma_f32_16x16x32_bf16 v[36:39], v[76:79], v[120:123], v[36:39]
    ds_read_b64_tr_b16 v[96:97], v2 offset:51296
    v_mfma_f32_16x16x32_bf16 v[56:59], v[76:79], v[124:127], v[56:59]
    ds_read_b64_tr_b16 v[98:99], v2 offset:52576
    s_waitcnt lgkmcnt(8)
    v_mfma_f32_16x16x32_bf16 v[40:43], v[80:83], v[120:123], v[40:43]
    ds_read_b64_tr_b16 v[100:101], v2 offset:51328
    v_mfma_f32_16x16x32_bf16 v[60:63], v[80:83], v[124:127], v[60:63]
    ds_read_b64_tr_b16 v[102:103], v2 offset:52608
    s_waitcnt vmcnt(4) lgkmcnt(8)
    v_mfma_f32_16x16x32_bf16 v[24:27], v[84:87], v[128:131], v[24:27]
    ds_read_b64_tr_b16 v[64:65], v3 offset:0
    v_mfma_f32_16x16x32_bf16 v[44:47], v[84:87], v[132:135], v[44:47]
    ds_read_b64_tr_b16 v[66:67], v3 offset:1280
    s_waitcnt lgkmcnt(8)
    v_mfma_f32_16x16x32_bf16 v[28:31], v[88:91], v[128:131], v[28:31]
    ds_read_b64_tr_b16 v[68:69], v3 offset:32
    v_mfma_f32_16x16x32_bf16 v[48:51], v[88:91], v[132:135], v[48:51]
    ds_read_b64_tr_b16 v[70:71], v3 offset:1312
    s_waitcnt lgkmcnt(8)
    v_mfma_f32_16x16x32_bf16 v[32:35], v[92:95], v[128:131], v[32:35]
    ds_read_b64_tr_b16 v[72:73], v3 offset:64
    v_mfma_f32_16x16x32_bf16 v[52:55], v[92:95], v[132:135], v[52:55]
    ds_read_b64_tr_b16 v[74:75], v3 offset:1344
    s_waitcnt lgkmcnt(8)
    v_mfma_f32_16x16x32_bf16 v[36:39], v[96:99], v[128:131], v[36:39]
    ds_read_b64_tr_b16 v[76:77], v3 offset:96
    v_mfma_f32_16x16x32_bf16 v[56:59], v[96:99], v[132:135], v[56:59]
    ds_read_b64_tr_b16 v[78:79], v3 offset:1376
    s_waitcnt lgkmcnt(8)
    v_mfma_f32_16x16x32_bf16 v[40:43], v[100:103], v[128:131], v[40:43]
    ds_read_b64_tr_b16 v[80:81], v3 offset:128
    v_mfma_f32_16x16x32_bf16 v[60:63], v[100:103], v[132:135], v[60:63]
    ds_read_b64_tr_b16 v[82:83], v3 offset:1408
    s_waitcnt vmcnt(2) lgkmcnt(8)
    v_mfma_f32_16x16x32_bf16 v[24:27], v[64:67], v[136:139], v[24:27]
    ds_read_b64_tr_b16 v[84:85], v3 offset:10240
    v_mfma_f32_16x16x32_bf16 v[44:47], v[64:67], v[140:143], v[44:47]
    ds_read_b64_tr_b16 v[86:87], v3 offset:11520
    s_waitcnt lgkmcnt(8)
    v_mfma_f32_16x16x32_bf16 v[28:31], v[68:71], v[136:139], v[28:31]
    ds_read_b64_tr_b16 v[88:89], v3 offset:10272
    v_mfma_f32_16x16x32_bf16 v[48:51], v[68:71], v[140:143], v[48:51]
    ds_read_b64_tr_b16 v[90:91], v3 offset:11552
    s_waitcnt lgkmcnt(8)
    v_mfma_f32_16x16x32_bf16 v[32:35], v[72:75], v[136:139], v[32:35]
    ds_read_b64_tr_b16 v[92:93], v3 offset:10304
    v_mfma_f32_16x16x32_bf16 v[52:55], v[72:75], v[140:143], v[52:55]
    ds_read_b64_tr_b16 v[94:95], v3 offset:11584
    s_waitcnt lgkmcnt(8)
    v_mfma_f32_16x16x32_bf16 v[36:39], v[76:79], v[136:139], v[36:39]
    ds_read_b64_tr_b16 v[96:97], v3 offset:10336
    v_mfma_f32_16x16x32_bf16 v[56:59], v[76:79], v[140:143], v[56:59]
    ds_read_b64_tr_b16 v[98:99], v3 offset:11616
    s_waitcnt lgkmcnt(8)
    v_mfma_f32_16x16x32_bf16 v[40:43], v[80:83], v[136:139], v[40:43]
    ds_read_b64_tr_b16 v[100:101], v3 offset:10368
    v_mfma_f32_16x16x32_bf16 v[60:63], v[80:83], v[140:143], v[60:63]
    ds_read_b64_tr_b16 v[102:103], v3 offset:11648
    s_waitcnt vmcnt(0) lgkmcnt(8)
    v_mfma_f32_16x16x32_bf16 v[24:27], v[84:87], v[144:147], v[24:27]
    v_mfma_f32_16x16x32_bf16 v[44:47], v[84:87], v[148:151], v[44:47]
    s_waitcnt lgkmcnt(6)
    v_mfma_f32_16x16x32_bf16 v[28:31], v[88:91], v[144:147], v[28:31]
    v_mfma_f32_16x16x32_bf16 v[48:51], v[88:91], v[148:151], v[48:51]
    s_waitcnt lgkmcnt(4)
    v_mfma_f32_16x16x32_bf16 v[32:35], v[92:95], v[144:147], v[32:35]
    v_mfma_f32_16x16x32_bf16 v[52:55], v[92:95], v[148:151], v[52:55]
    s_waitcnt lgkmcnt(2)
    v_mfma_f32_16x16x32_bf16 v[36:39], v[96:99], v[144:147], v[36:39]
    v_mfma_f32_16x16x32_bf16 v[56:59], v[96:99], v[148:151], v[56:59]
    s_waitcnt lgkmcnt(0)
    v_mfma_f32_16x16x32_bf16 v[40:43], v[100:103], v[144:147], v[40:43]
    v_mfma_f32_16x16x32_bf16 v[60:63], v[100:103], v[148:151], v[60:63]
    s_mul_i32 s45, s40, 10240
    s_add_u32 s45, s45, 81920
    s_lshl_b32 s46, s41, 12
    s_add_u32 s45, s45, s46
    s_xor_b32 s46, s41, 1
    s_sub_u32 s46, s46, s41
    s_lshl_b32 s46, s46, 12
    s_add_u32 s46, s46, s45
    v_add_u32 v2, s45, v5
    v_add_u32 v3, s46, v5
    s_cmp_eq_u32 s41, 0
    s_cbranch_scc0 P5_e1
    ds_write_b128 v2, v[32:35] offset:0
    ds_write_b128 v2, v[36:39] offset:1024
    ds_write_b128 v2, v[52:55] offset:2048
    ds_write_b128 v2, v[56:59] offset:3072
    s_waitcnt lgkmcnt(0)
    s_barrier
    ds_read_b128 v[64:67], v3 offset:0
    ds_read_b128 v[68:71], v3 offset:1024
    ds_read_b128 v[72:75], v3 offset:2048
    ds_read_b128 v[76:79], v3 offset:3072
    ds_read_b128 v[80:83], v3 offset:4096
    ds_read_b128 v[84:87], v3 offset:5120
    v_lshlrev_b32 v100, 16, v232
    v_and_b32 v101, 0xffff0000, v232
    v_pk_add_f32 v[24:25], v[24:25], v[100:101]
    v_lshlrev_b32 v100, 16, v233
    v_and_b32 v101, 0xffff0000, v233
    v_pk_add_f32 v[26:27], v[26:27], v[100:101]
    v_lshlrev_b32 v100, 16, v234
    v_and_b32 v101, 0xffff0000, v234
    v_pk_add_f32 v[28:29], v[28:29], v[100:101]
    v_lshlrev_b32 v100, 16, v235
    v_and_b32 v101, 0xffff0000, v235
    v_pk_add_f32 v[30:31], v[30:31], v[100:101]
    v_lshlrev_b32 v100, 16, v236
    v_and_b32 v101, 0xffff0000, v236
    v_pk_add_f32 v[44:45], v[44:45], v[100:101]
    v_lshlrev_b32 v100, 16, v237
    v_and_b32 v101, 0xffff0000, v237
    v_pk_add_f32 v[46:47], v[46:47], v[100:101]
    v_lshlrev_b32 v100, 16, v238
    v_and_b32 v101, 0xffff0000, v238
    v_pk_add_f32 v[48:49], v[48:49], v[100:101]
    v_lshlrev_b32 v100, 16, v239
    v_and_b32 v101, 0xffff0000, v239
    v_pk_add_f32 v[50:51], v[50:51], v[100:101]
    v_lshlrev_b32 v100, 16, v240
    v_and_b32 v101, 0xffff0000, v240
    v_pk_add_f32 v[40:41], v[40:41], v[100:101]
    v_lshlrev_b32 v100, 16, v241
    v_and_b32 v101, 0xffff0000, v241
    v_pk_add_f32 v[42:43], v[42:43], v[100:101]
    v_lshlrev_b32 v100, 16, v242
    v_and_b32 v101, 0xffff0000, v242
    v_pk_add_f32 v[60:61], v[60:61], v[100:101]
    v_lshlrev_b32 v100, 16, v243
    v_and_b32 v101, 0xffff0000, v243
    v_pk_add_f32 v[62:63], v[62:63], v[100:101]
    s_waitcnt lgkmcnt(5)
    v_pk_add_f32 v[24:25], v[24:25], v[64:65]
    v_pk_add_f32 v[26:27], v[26:27], v[66:67]
    v_cvt_pk_bf16_f32 v104, v24, v25
    v_cvt_pk_bf16_f32 v105, v26, v27
    s_waitcnt lgkmcnt(4)
    v_pk_add_f32 v[28:29], v[28:29], v[68:69]
    v_pk_add_f32 v[30:31], v[30:31], v[70:71]
    v_cvt_pk_bf16_f32 v106, v28, v29
    v_cvt_pk_bf16_f32 v107, v30, v31
    s_waitcnt lgkmcnt(3)
    v_pk_add_f32 v[44:45], v[44:45], v[72:73]
    v_pk_add_f32 v[46:47], v[46:47], v[74:75]
    v_cvt_pk_bf16_f32 v108, v44, v45
    v_cvt_pk_bf16_f32 v109, v46, v47
L_pad25:
    s_cbranch_execz L_warm2
    s_waitcnt lgkmcnt(2)
    v_pk_add_f32 v[48:49], v[48:49], v[76:77]
    v_pk_add_f32 v[50:51], v[50:51], v[78:79]
    v_cvt_pk_bf16_f32 v110, v48, v49
    v_cvt_pk_bf16_f32 v111, v50, v51
    s_waitcnt lgkmcnt(1)
    v_pk_add_f32 v[40:41], v[40:41], v[80:81]
    v_pk_add_f32 v[42:43], v[42:43], v[82:83]
    v_cvt_pk_bf16_f32 v112, v40, v41
    v_cvt_pk_bf16_f32 v113, v42, v43
    s_waitcnt lgkmcnt(0)
    v_pk_add_f32 v[60:61], v[60:61], v[84:85]
    v_pk_add_f32 v[62:63], v[62:63], v[86:87]
    v_cvt_pk_bf16_f32 v114, v60, v61
    v_cvt_pk_bf16_f32 v115, v62, v63
    s_nop 0
    v_permlane16_swap_b32 v104, v106
    v_permlane16_swap_b32 v105, v107
    v_permlane16_swap_b32 v108, v110
    v_permlane16_swap_b32 v109, v111
    v_permlane16_swap_b32 v112, v114
    v_permlane16_swap_b32 v113, v115
    buffer_store_dwordx4 v[104:107], v8, s[28:31], s49 offen offset:0
    buffer_store_dwordx4 v[108:111], v8, s[28:31], s47 offen offset:0
    buffer_store_dwordx4 v[112:115], v9, s[28:31], s49 offen
    s_branch P5_done
P5_e1:
    ds_write_b128 v2, v[24:27] offset:0
    ds_write_b128 v2, v[28:31] offset:1024
    ds_write_b128 v2, v[44:47] offset:2048
    ds_write_b128 v2, v[48:51] offset:3072
    ds_write_b128 v2, v[40:43] offset:4096
    ds_write_b128 v2, v[60:63] offset:5120
    s_waitcnt lgkmcnt(0)
    s_barrier
    ds_read_b128 v[64:67], v3 offset:0
    ds_read_b128 v[68:71], v3 offset:1024
    ds_read_b128 v[72:75], v3 offset:2048
    ds_read_b128 v[76:79], v3 offset:3072
    v_lshlrev_b32 v100, 16, v232
    v_and_b32 v101, 0xffff0000, v232
    v_pk_add_f32 v[32:33], v[32:33], v[100:101]
    v_lshlrev_b32 v100, 16, v233
    v_and_b32 v101, 0xffff0000, v233
    v_pk_add_f32 v[34:35], v[34:35], v[100:101]
    v_lshlrev_b32 v100, 16, v234
    v_and_b32 v101, 0xffff0000, v234
    v_pk_add_f32 v[36:37], v[36:37], v[100:101]
    v_lshlrev_b32 v100, 16, v235
    v_and_b32 v101, 0xffff0000, v235
    v_pk_add_f32 v[38:39], v[38:39], v[100:101]
    v_lshlrev_b32 v100, 16, v236
    v_and_b32 v101, 0xffff0000, v236
    v_pk_add_f32 v[52:53], v[52:53], v[100:101]
    v_lshlrev_b32 v100, 16, v237
    v_and_b32 v101, 0xffff0000, v237
    v_pk_add_f32 v[54:55], v[54:55], v[100:101]
    v_lshlrev_b32 v100, 16, v238
    v_and_b32 v101, 0xffff0000, v238
    v_pk_add_f32 v[56:57], v[56:57], v[100:101]
    v_lshlrev_b32 v100, 16, v239
    v_and_b32 v101, 0xffff0000, v239
    v_pk_add_f32 v[58:59], v[58:59], v[100:101]
    s_waitcnt lgkmcnt(3)
    v_pk_add_f32 v[32:33], v[32:33], v[64:65]
    v_pk_add_f32 v[34:35], v[34:35], v[66:67]
    v_cvt_pk_bf16_f32 v104, v32, v33
    v_cvt_pk_bf16_f32 v105, v34, v35
    s_waitcnt lgkmcnt(2)
    v_pk_add_f32 v[36:37], v[36:37], v[68:69]
    v_pk_add_f32 v[38:39], v[38:39], v[70:71]
    v_cvt_pk_bf16_f32 v106, v36, v37
    v_cvt_pk_bf16_f32 v107, v38, v39
    s_waitcnt lgkmcnt(1)
    v_pk_add_f32 v[52:53], v[52:53], v[72:73]
    v_pk_add_f32 v[54:55], v[54:55], v[74:75]
    v_cvt_pk_bf16_f32 v108, v52, v53
    v_cvt_pk_bf16_f32 v109, v54, v55
    s_waitcnt lgkmcnt(0)
    v_pk_add_f32 v[56:57], v[56:57], v[76:77]
    v_pk_add_f32 v[58:59], v[58:59], v[78:79]
    v_cvt_pk_bf16_f32 v110, v56, v57
    v_cvt_pk_bf16_f32 v111, v58, v59
    s_nop 0
    v_permlane16_swap_b32 v104, v106
    v_permlane16_swap_b32 v105, v107
    v_permlane16_swap_b32 v108, v110
    v_permlane16_swap_b32 v109, v111
    buffer_store_dwordx4 v[104:107], v8, s[28:31], s49 offen offset:64
    buffer_store_dwordx4 v[108:111], v8, s[28:31], s47 offen offset:64
    s_branch P5_done
P5_loader:
    s_mul_i32 s51, s42, 5120
    s_mul_i32 s50, s39, 245760
    s_add_u32 s50, s50, s51
    s_add_u32 s50, s50, 0x1f00000
    v_lshlrev_b32 v4, 4, v1
    v_add_u32 v5, s51, v4
    v_add_u32 v6, 61440, v5
    v_add_u32 v7, 61440, v6
    s_barrier
    s_add_u32 m0, s51, 0
    s_add_u32 s44, s50, 0
    buffer_load_dwordx4 v4, s[32:35], s44 offen offset:0 sc1 lds
    buffer_load_dwordx4 v4, s[32:35], s44 offen offset:1024 sc1 lds
    buffer_load_dwordx4 v4, s[32:35], s44 offen offset:2048 sc1 lds
    buffer_load_dwordx4 v4, s[32:35], s44 offen offset:3072 sc1 lds
    s_add_u32 m0, s51, 4096
    s_add_u32 s44, s44, 4096
    buffer_load_dwordx4 v4, s[32:35], s44 offen offset:0 sc1 lds
    s_add_u32 m0, s51, 20480
    s_add_u32 s44, s50, 20480
    buffer_load_dwordx4 v4, s[32:35], s44 offen offset:0 sc1 lds
    buffer_load_dwordx4 v4, s[32:35], s44 offen offset:1024 sc1 lds
    buffer_load_dwordx4 v4, s[32:35], s44 offen offset:2048 sc1 lds
    buffer_load_dwordx4 v4, s[32:35], s44 offen offset:3072 sc1 lds
    s_add_u32 m0, s51, 24576
    s_add_u32 s44, s44, 4096
    buffer_load_dwordx4 v4, s[32:35], s44 offen offset:0 sc1 lds
    s_add_u32 m0, s51, 40960
    s_add_u32 s44, s50, 40960
    buffer_load_dwordx4 v4, s[32:35], s44 offen offset:0 sc1 lds
    buffer_load_dwordx4 v4, s[32:35], s44 offen offset:1024 sc1 lds
    buffer_load_dwordx4 v4, s[32:35], s44 offen offset:2048 sc1 lds
    buffer_load_dwordx4 v4, s[32:35], s44 offen offset:3072 sc1 lds
    s_add_u32 m0, s51, 45056
    s_add_u32 s44, s44, 4096
    buffer_load_dwordx4 v4, s[32:35], s44 offen offset:0 sc1 lds
    s_add_u32 m0, s51, 61440
    s_add_u32 s44, s50, 61440
    buffer_load_dwordx4 v4, s[32:35], s44 offen offset:0 sc1 lds
    buffer_load_dwordx4 v4, s[32:35], s44 offen offset:1024 sc1 lds
    buffer_load_dwordx4 v4, s[32:35], s44 offen offset:2048 sc1 lds
    buffer_load_dwordx4 v4, s[32:35], s44 offen offset:3072 sc1 lds
    s_add_u32 m0, s51, 65536
    s_add_u32 s44, s44, 4096
    buffer_load_dwordx4 v4, s[32:35], s44 offen offset:0 sc1 lds
    s_waitcnt vmcnt(5)
    s_barrier
    s_add_u32 m0, s51, 81920
    s_add_u32 s44, s50, 81920
    buffer_load_dwordx4 v4, s[32:35], s44 offen offset:0 sc1 lds
    buffer_load_dwordx4 v4, s[32:35], s44 offen offset:1024 sc1 lds
    buffer_load_dwordx4 v4, s[32:35], s44 offen offset:2048 sc1 lds
    buffer_load_dwordx4 v4, s[32:35], s44 offen offset:3072 sc1 lds
    s_add_u32 m0, s51, 86016
    s_add_u32 s44, s44, 4096
    buffer_load_dwordx4 v4, s[32:35], s44 offen offset:0 sc1 lds
    s_add_u32 m0, s51, 102400
L_pad26:
    s_cbranch_execz L_warm2
    s_add_u32 s44, s50, 102400
    buffer_load_dwordx4 v4, s[32:35], s44 offen offset:0 sc1 lds
    buffer_load_dwordx4 v4, s[32:35], s44 offen offset:1024 sc1 lds
    buffer_load_dwordx4 v4, s[32:35], s44 offen offset:2048 sc1 lds
    buffer_load_dwordx4 v4, s[32:35], s44 offen offset:3072 sc1 lds
    s_add_u32 m0, s51, 106496
    s_add_u32 s44, s44, 4096
    buffer_load_dwordx4 v4, s[32:35], s44 offen offset:0 sc1 lds
    s_barrier
    s_add_u32 m0, s51, 122880
    s_add_u32 s44, s50, 122880
    buffer_load_dwordx4 v4, s[32:35], s44 offen offset:0 sc1 lds
    buffer_load_dwordx4 v4, s[32:35], s44 offen offset:1024 sc1 lds
    buffer_load_dwordx4 v4, s[32:35], s44 offen offset:2048 sc1 lds
    buffer_load_dwordx4 v4, s[32:35], s44 offen offset:3072 sc1 lds
    s_add_u32 m0, s51, 126976
    s_add_u32 s44, s44, 4096
    buffer_load_dwordx4 v4, s[32:35], s44 offen offset:0 sc1 lds
    s_add_u32 m0, s51, 143360
    s_add_u32 s44, s50, 143360
    buffer_load_dwordx4 v4, s[32:35], s44 offen offset:0 sc1 lds
    buffer_load_dwordx4 v4, s[32:35], s44 offen offset:1024 sc1 lds
    buffer_load_dwordx4 v4, s[32:35], s44 offen offset:2048 sc1 lds
    buffer_load_dwordx4 v4, s[32:35], s44 offen offset:3072 sc1 lds
    s_add_u32 m0, s51, 147456
    s_add_u32 s44, s44, 4096
    buffer_load_dwordx4 v4, s[32:35], s44 offen offset:0 sc1 lds
    ds_write_b128 v5, v[176:179] offset:0
    ds_write_b128 v5, v[180:183] offset:1024
    ds_write_b128 v5, v[184:187] offset:2048
    ds_write_b128 v5, v[188:191] offset:3072
    ds_write_b128 v5, v[192:195] offset:4096
    ds_write_b128 v5, v[196:199] offset:20480
    ds_write_b128 v5, v[200:203] offset:21504
    ds_write_b128 v5, v[204:207] offset:22528
    ds_write_b128 v5, v[208:211] offset:23552
    ds_write_b128 v5, v[212:215] offset:24576
    ds_write_b128 v5, v[216:219] offset:40960
    ds_write_b128 v5, v[220:223] offset:41984
    ds_write_b128 v5, v[224:227] offset:43008
    ds_write_b128 v5, v[228:231] offset:44032
    ds_write_b128 v5, v[232:235] offset:45056
    s_waitcnt vmcnt(0) lgkmcnt(0)
    s_barrier
    s_barrier
    ds_write_b128 v6, v[236:239] offset:0
    ds_write_b128 v6, v[240:243] offset:1024
    ds_write_b128 v6, v[244:247] offset:2048
    ds_write_b128 v6, v[248:251] offset:3072
    ds_write_b128 v6, v[252:255] offset:4096
    s_waitcnt vmcnt(0) lgkmcnt(0)
    s_barrier
    s_barrier
P5_done:
    s_or_b32 s38, s2, s3
    s_cbranch_scc1 L_end
    v_mov_b32 v2, 0
    v_mov_b32 v3, s36
    s_mov_b64 exec, 1
    buffer_store_dword v3, v2, s[32:35], 0 offen sc1
L_end:
    s_endpgm
.section .rodata,"a"
.p2align 6
.amdhsa_kernel sequential_preLN__softmax_full_mha__glu_gated_geglu__prompt_kernel
  .amdhsa_next_free_vgpr 256
  .amdhsa_next_free_sgpr 102
  .amdhsa_accum_offset 256
  .amdhsa_group_segment_fixed_size 0
  .amdhsa_kernarg_size 80
  .amdhsa_user_sgpr_count 2
  .amdhsa_user_sgpr_kernarg_segment_ptr 1
  .amdhsa_system_sgpr_workgroup_id_x 1
.end_amdhsa_kernel
```
